```python
import torch

def _softmax(x, axis=-1):
    return torch.softmax(x, dim=axis)
def _gelu(x):
    return torch.nn.functional.gelu(x, approximate="tanh")
def _silu(x):
    return torch.nn.functional.silu(x)
def _sigmoid(x):
    return torch.sigmoid(x)
def _layernorm(x, axis=-1, eps=1e-5):
    m = x.mean(dim=axis, keepdim=True)
    v = x.var(dim=axis, keepdim=True, unbiased=False)
    return (x - m) / torch.sqrt(v + eps)
def _scatter_add(tgt, idx, src, axis=0):
    return tgt.clone().index_add_(axis, idx, src)
def _segment_sum(src, seg, n):
    out = torch.zeros((n,) + src.shape[1:], dtype=src.dtype)
    return out.index_add_(0, seg, src)
def _pad(x, pw):
    flat = tuple(v for pair in reversed(pw) for v in pair)
    return torch.nn.functional.pad(x, flat)

kernel_name = 'concat_heads__mha_block_cached__mha_block_cached__near_ridge'

def setup_inputs():

    _w = (lambda a: (lambda t: t.to(torch.bfloat16) if t.is_floating_point() else t)(torch.as_tensor(a)))
    def _A_setup():
        B, Sq, D = 8, 240, 640
        H, Sk, Dh = 32, 1024, 128
        return {
            "x": _w((lambda *s: torch.randn(*s, dtype=torch.bfloat16) * 0.8)(B, Sq, D)),
            "k_cache": _w((lambda *s: torch.randn(*s, dtype=torch.bfloat16) * 0.8)(B, H, Sk, Dh)),
            "v_cache": _w((lambda *s: torch.randn(*s, dtype=torch.bfloat16) * 0.05)(B, H, Sk, Dh)),
            "wq": _w((lambda *s: torch.randn(*s, dtype=torch.bfloat16) * 0.8)(D, H * Dh) * (D ** -0.5)),
            "wo": _w((lambda *s: torch.randn(*s, dtype=torch.bfloat16) * 0.05)(H * Dh, D) * ((H * Dh) ** -0.5)),
        }
    _A_in = _A_setup()

    def _B_setup():
        B, Sq, D = 8, 240, 640
        H, Sk, Dh = 32, 1024, 128
        return {
            "x": _w((lambda *s: torch.randn(*s, dtype=torch.bfloat16) * 0.8)(B, Sq, D)),
            "k_cache": _w((lambda *s: torch.randn(*s, dtype=torch.bfloat16) * 0.8)(B, H, Sk, Dh)),
            "v_cache": _w((lambda *s: torch.randn(*s, dtype=torch.bfloat16) * 0.05)(B, H, Sk, Dh)),
            "wq": _w((lambda *s: torch.randn(*s, dtype=torch.bfloat16) * 0.8)(D, H * Dh) * (D ** -0.5)),
            "wo": _w((lambda *s: torch.randn(*s, dtype=torch.bfloat16) * 0.05)(H * Dh, D) * ((H * Dh) ** -0.5)),
        }
    _B_in = _B_setup()

    return {
        "A_x": _A_in["x"],
        "A_k_cache": _A_in["k_cache"],
        "A_v_cache": _A_in["v_cache"],
        "A_wq": _A_in["wq"],
        "A_wo": _A_in["wo"],
        "B_x": _B_in["x"],
        "B_k_cache": _B_in["k_cache"],
        "B_v_cache": _B_in["v_cache"],
        "B_wq": _B_in["wq"],
        "B_wo": _B_in["wo"],
    }

def reference(A_x, A_k_cache, A_v_cache, A_wq, A_wo, B_x, B_k_cache, B_v_cache, B_wq, B_wo):
    def _A_ref(x, k_cache, v_cache, wq, wo):
        B, Sq, D = x.shape
        H, Dh = 32, 128
        q = (lambda x, *d: x.permute(*d))((x @ wq).reshape(B, Sq, H, Dh), 0, 2, 1, 3)
        scores = torch.einsum("bhqd,bhkd->bhqk", q, k_cache) * (Dh ** -0.5)
        p = _softmax(scores, axis=-1)
        o = torch.einsum("bhqk,bhkd->bhqd", p, v_cache)
        return (lambda x, *d: x.permute(*d))(o, 0, 2, 1, 3).reshape(B, Sq, H * Dh) @ wo

    def _B_ref(x, k_cache, v_cache, wq, wo):
        B, Sq, D = x.shape
        H, Dh = 32, 128
        q = (lambda x, *d: x.permute(*d))((x @ wq).reshape(B, Sq, H, Dh), 0, 2, 1, 3)
        scores = torch.einsum("bhqd,bhkd->bhqk", q, k_cache) * (Dh ** -0.5)
        p = _softmax(scores, axis=-1)
        o = torch.einsum("bhqk,bhkd->bhqd", p, v_cache)
        return (lambda x, *d: x.permute(*d))(o, 0, 2, 1, 3).reshape(B, Sq, H * Dh) @ wo

    a = _A_ref(A_x, A_k_cache, A_v_cache, A_wq, A_wo)
    b = _B_ref(B_x, B_k_cache, B_v_cache, B_wq, B_wo)
    return torch.concatenate([a, b], axis=-1)
```

```asm
; @launch kernel=attn_kernel grid=(512,1,1) block=(256,1,1) lds=131072
; @launch kernel=oproj_kernel grid=(256,1,1) block=(256,1,1) lds=122880
.amdgcn_target "amdgcn-amd-amdhsa--gfx950"
.text
.globl attn_kernel
.p2align 8
.type attn_kernel,@function
attn_kernel:
    s_cmp_ge_u32 s2, 512
    s_cbranch_scc1 L_end
    s_lshr_b32 s33, s2, 8
    s_mul_i32 s34, s33, 40
    s_load_dwordx2 s[40:41], s[0:1], s34
    s_add_u32 s34, s34, 8
    s_load_dwordx2 s[4:5], s[0:1], s34
    s_add_u32 s34, s34, 8
    s_load_dwordx2 s[6:7], s[0:1], s34
    s_add_u32 s34, s34, 8
    s_load_dwordx2 s[42:43], s[0:1], s34
    s_load_dwordx2 s[8:9], s[0:1], 96
    s_waitcnt lgkmcnt(0)
    s_and_b32 s34, s2, 255
    s_lshl_b32 s36, s34, 18
    s_add_u32 s12, s4, s36
    s_addc_u32 s13, s5, 0
    s_mov_b32 s14, 262144
    s_mov_b32 s15, 131072
    s_add_u32 s16, s6, s36
    s_addc_u32 s17, s7, 0
    s_mov_b32 s18, 262144
    s_mov_b32 s19, 131072
    s_lshr_b32 s36, s2, 5
    s_and_b32 s36, s36, 7
    s_mul_i32 s37, s36, 307200
    s_add_u32 s44, s40, s37
    s_addc_u32 s45, s41, 0
    s_mov_b32 s46, 307200
    s_mov_b32 s47, 131072
    s_mul_i32 s36, s36, 240
    s_mul_i32 s37, s33, 1920
    s_add_u32 s36, s36, s37
    s_lshl_b32 s36, s36, 13
    s_and_b32 s37, s2, 31
    s_lshl_b32 s38, s37, 11
    s_lshl_b32 s37, s37, 8
    s_add_u32 s36, s36, s38
    s_add_u32 s24, s8, s36
    s_addc_u32 s25, s9, 0
    s_mov_b32 s26, 1902592
    s_mov_b32 s27, 131072
    s_add_u32 s48, s42, s37
    s_addc_u32 s49, s43, 0
    s_mov_b32 s50, 5234944
    s_mov_b32 s51, 131072
    s_mov_b32 s32, 1040356334
    s_mov_b32 s39, 1115353651
    v_and_b32 v232, 63, v0
    v_lshrrev_b32 v233, 6, v0
    s_nop 0
    v_readfirstlane_b32 s33, v233
    s_nop 0
    s_lshl_b32 s31, s33, 12
    v_and_b32 v234, 31, v232
    v_lshlrev_b32 v234, 8, v234
    v_lshrrev_b32 v235, 5, v232
    v_and_b32 v236, 1, v232
    v_xor_b32 v235, v235, v236
    v_lshlrev_b32 v235, 4, v235
    v_add_u32 v234, v234, v235
    v_and_b32 v235, 15, v232
    v_lshrrev_b32 v235, 1, v235
    v_lshlrev_b32 v235, 5, v235
    v_add_u32 v234, v234, v235
    v_xor_b32 v208, 0, v234
    v_xor_b32 v209, 32, v234
    v_xor_b32 v210, 64, v234
    v_xor_b32 v211, 96, v234
    v_xor_b32 v212, 128, v234
    v_xor_b32 v213, 160, v234
    v_xor_b32 v214, 192, v234
    v_xor_b32 v215, 224, v234
    v_bfe_u32 v235, v232, 2, 2
    v_bfe_u32 v236, v232, 4, 1
    v_lshlrev_b32 v236, 5, v236
    v_and_b32 v237, 3, v232
    v_lshlrev_b32 v237, 3, v237
    v_add_u32 v236, v236, v237
    v_add_u32 v236, 65536, v236
    v_lshrrev_b32 v234, 5, v232
    v_lshlrev_b32 v234, 2, v234
    v_add_u32 v234, v234, v235
    v_lshlrev_b32 v234, 8, v234
    v_add_u32 v234, v234, v236
    v_lshrrev_b32 v237, 5, v232
    v_lshlrev_b32 v237, 3, v237
    v_add_u32 v237, v237, v235
    v_lshlrev_b32 v237, 8, v237
    v_add_u32 v237, v237, v236
    v_xor_b32 v236, 0, v235
    v_lshlrev_b32 v236, 6, v236
    v_add_u32 v216, v234, v236
    v_add_u32 v176, v237, v236
    v_xor_b32 v236, 1, v235
    v_lshlrev_b32 v236, 6, v236
    v_add_u32 v217, v234, v236
    v_add_u32 v177, v237, v236
    v_xor_b32 v236, 2, v235
    v_lshlrev_b32 v236, 6, v236
    v_add_u32 v218, v234, v236
    v_add_u32 v178, v237, v236
    v_xor_b32 v236, 3, v235
    v_lshlrev_b32 v236, 6, v236
    v_add_u32 v219, v234, v236
    v_add_u32 v179, v237, v236
    v_lshlrev_b32 v234, 4, v233
    v_lshrrev_b32 v235, 4, v232
    v_add_u32 v234, v234, v235
    v_and_b32 v235, 15, v232
    v_lshlrev_b32 v237, 8, v234
    v_add_u32 v236, 0, v234
    v_and_b32 v236, 15, v236
    v_xor_b32 v236, v236, v235
    v_lshlrev_b32 v236, 4, v236
    v_add_u32 v220, v237, v236
    v_add_u32 v236, 4, v234
    v_and_b32 v236, 15, v236
    v_xor_b32 v236, v236, v235
    v_lshlrev_b32 v236, 4, v236
    v_add_u32 v221, v237, v236
    v_add_u32 v236, 8, v234
    v_and_b32 v236, 15, v236
    v_xor_b32 v236, v236, v235
    v_lshlrev_b32 v236, 4, v236
    v_add_u32 v222, v237, v236
    v_add_u32 v236, 12, v234
    v_and_b32 v236, 15, v236
    v_xor_b32 v236, v236, v235
    v_lshlrev_b32 v236, 4, v236
    v_add_u32 v223, v237, v236
    v_and_b32 v236, 3, v234
    v_lshlrev_b32 v236, 2, v236
    v_xor_b32 v236, v236, v235
    v_lshlrev_b32 v236, 4, v236
    v_add_u32 v224, v237, v236
    v_lshlrev_b32 v237, 13, v234
    v_add_u32 v180, v237, v236
    v_lshlrev_b32 v234, 6, v233
    v_and_b32 v235, 31, v232
    v_add_u32 v234, v234, v235
    v_mul_u32_u24 v235, 1280, v234
    v_lshrrev_b32 v236, 5, v232
    v_lshlrev_b32 v236, 4, v236
    v_add_u32 v181, v235, v236
    v_lshrrev_b32 v235, 3, v234
    v_lshlrev_b32 v235, 16, v235
    v_lshlrev_b32 v236, 3, v236
    v_add_u32 v235, v235, v236
    v_and_b32 v236, 7, v234
    v_lshlrev_b32 v236, 4, v236
    v_add_u32 v231, v235, v236
    s_add_u32 s33, s31, 16384
    s_mov_b32 s29, 0
    s_mov_b32 m0, s33
    s_nop 0
    buffer_load_dwordx4 v220, s[12:15], s29 offen offset:0 lds
    buffer_load_dwordx4 v221, s[12:15], s29 offen offset:1024 lds
    buffer_load_dwordx4 v222, s[12:15], s29 offen offset:2048 lds
    buffer_load_dwordx4 v223, s[12:15], s29 offen offset:3072 lds
    s_add_u32 s33, s31, 32768
    s_mov_b32 s29, 16384
    s_mov_b32 m0, s33
    s_nop 0
    buffer_load_dwordx4 v220, s[12:15], s29 offen offset:0 lds
    buffer_load_dwordx4 v221, s[12:15], s29 offen offset:1024 lds
    buffer_load_dwordx4 v222, s[12:15], s29 offen offset:2048 lds
    buffer_load_dwordx4 v223, s[12:15], s29 offen offset:3072 lds
    s_add_u32 s33, s31, 49152
    s_mov_b32 s29, 32768
    s_mov_b32 m0, s33
    s_nop 0
    buffer_load_dwordx4 v220, s[12:15], s29 offen offset:0 lds
    buffer_load_dwordx4 v221, s[12:15], s29 offen offset:1024 lds
    buffer_load_dwordx4 v222, s[12:15], s29 offen offset:2048 lds
    buffer_load_dwordx4 v223, s[12:15], s29 offen offset:3072 lds
    s_add_u32 s33, s31, 0
    s_mov_b32 s29, 49152
    s_mov_b32 m0, s33
    s_nop 0
    buffer_load_dwordx4 v220, s[12:15], s29 offen offset:0 lds
    buffer_load_dwordx4 v221, s[12:15], s29 offen offset:1024 lds
    buffer_load_dwordx4 v222, s[12:15], s29 offen offset:2048 lds
    buffer_load_dwordx4 v223, s[12:15], s29 offen offset:3072 lds
    s_add_u32 s33, s31, 65536
    s_mov_b32 m0, s33
    s_mov_b32 s34, 0
    buffer_load_dwordx4 v180, s[48:51], s34 offen lds
    s_add_u32 s33, s33, 1024
    s_mov_b32 m0, s33
    s_add_u32 s34, s34, 32768
    buffer_load_dwordx4 v180, s[48:51], s34 offen lds
    s_add_u32 s33, s33, 1024
    s_mov_b32 m0, s33
    s_add_u32 s34, s34, 32768
    buffer_load_dwordx4 v180, s[48:51], s34 offen lds
    s_add_u32 s33, s33, 1024
    s_mov_b32 m0, s33
    s_add_u32 s34, s34, 32768
    buffer_load_dwordx4 v180, s[48:51], s34 offen lds
    s_add_u32 s33, s31, 81920
    s_mov_b32 m0, s33
    s_mov_b32 s34, 524288
    buffer_load_dwordx4 v180, s[48:51], s34 offen lds
    s_add_u32 s33, s33, 1024
    s_mov_b32 m0, s33
    s_add_u32 s34, s34, 32768
    buffer_load_dwordx4 v180, s[48:51], s34 offen lds
    s_add_u32 s33, s33, 1024
    s_mov_b32 m0, s33
    s_add_u32 s34, s34, 32768
    buffer_load_dwordx4 v180, s[48:51], s34 offen lds
    s_add_u32 s33, s33, 1024
    s_mov_b32 m0, s33
    s_add_u32 s34, s34, 32768
    buffer_load_dwordx4 v180, s[48:51], s34 offen lds
    s_add_u32 s33, s31, 98304
    s_mov_b32 m0, s33
    s_mov_b32 s34, 1048576
    buffer_load_dwordx4 v180, s[48:51], s34 offen lds
    s_add_u32 s33, s33, 1024
    s_mov_b32 m0, s33
    s_add_u32 s34, s34, 32768
    buffer_load_dwordx4 v180, s[48:51], s34 offen lds
    s_add_u32 s33, s33, 1024
    s_mov_b32 m0, s33
    s_add_u32 s34, s34, 32768
    buffer_load_dwordx4 v180, s[48:51], s34 offen lds
    s_add_u32 s33, s33, 1024
    s_mov_b32 m0, s33
    s_add_u32 s34, s34, 32768
    buffer_load_dwordx4 v180, s[48:51], s34 offen lds
    s_mov_b32 s60, 0
    buffer_load_dwordx4 v[16:19], v181, s[44:47], s60 offen offset:0
    buffer_load_dwordx4 v[20:23], v181, s[44:47], s60 offen offset:32
    buffer_load_dwordx4 v[24:27], v181, s[44:47], s60 offen offset:64
    buffer_load_dwordx4 v[28:31], v181, s[44:47], s60 offen offset:96
    s_mov_b32 s60, 40960
    buffer_load_dwordx4 v[32:35], v181, s[44:47], s60 offen offset:0
    buffer_load_dwordx4 v[36:39], v181, s[44:47], s60 offen offset:32
    buffer_load_dwordx4 v[40:43], v181, s[44:47], s60 offen offset:64
    buffer_load_dwordx4 v[44:47], v181, s[44:47], s60 offen offset:96
    s_mov_b32 s60, 0
    buffer_load_dwordx4 v[48:51], v181, s[44:47], s60 offen offset:128
    buffer_load_dwordx4 v[52:55], v181, s[44:47], s60 offen offset:160
    buffer_load_dwordx4 v[56:59], v181, s[44:47], s60 offen offset:192
    buffer_load_dwordx4 v[60:63], v181, s[44:47], s60 offen offset:224
    s_mov_b32 s60, 40960
    buffer_load_dwordx4 v[64:67], v181, s[44:47], s60 offen offset:128
    buffer_load_dwordx4 v[68:71], v181, s[44:47], s60 offen offset:160
    buffer_load_dwordx4 v[72:75], v181, s[44:47], s60 offen offset:192
    buffer_load_dwordx4 v[76:79], v181, s[44:47], s60 offen offset:224
    s_mov_b32 s60, 0
    buffer_load_dwordx4 v[80:83], v181, s[44:47], s60 offen offset:256
    buffer_load_dwordx4 v[84:87], v181, s[44:47], s60 offen offset:288
    buffer_load_dwordx4 v[88:91], v181, s[44:47], s60 offen offset:320
    buffer_load_dwordx4 v[92:95], v181, s[44:47], s60 offen offset:352
    s_mov_b32 s60, 40960
    buffer_load_dwordx4 v[96:99], v181, s[44:47], s60 offen offset:256
    buffer_load_dwordx4 v[100:103], v181, s[44:47], s60 offen offset:288
    buffer_load_dwordx4 v[104:107], v181, s[44:47], s60 offen offset:320
    buffer_load_dwordx4 v[108:111], v181, s[44:47], s60 offen offset:352
    s_waitcnt vmcnt(32)
    s_barrier
    s_add_u32 s33, s31, 114688
    s_mov_b32 m0, s33
    s_mov_b32 s34, 1572864
    buffer_load_dwordx4 v180, s[48:51], s34 offen lds
    s_add_u32 s33, s33, 1024
    s_mov_b32 m0, s33
    s_add_u32 s34, s34, 32768
    buffer_load_dwordx4 v180, s[48:51], s34 offen lds
    s_add_u32 s33, s33, 1024
    s_mov_b32 m0, s33
    s_add_u32 s34, s34, 32768
    buffer_load_dwordx4 v180, s[48:51], s34 offen lds
    s_add_u32 s33, s33, 1024
    s_mov_b32 m0, s33
    s_add_u32 s34, s34, 32768
    buffer_load_dwordx4 v180, s[48:51], s34 offen lds
    s_mov_b32 s60, 0
    buffer_load_dwordx4 v[112:115], v181, s[44:47], s60 offen offset:384
    buffer_load_dwordx4 v[116:119], v181, s[44:47], s60 offen offset:416
    buffer_load_dwordx4 v[120:123], v181, s[44:47], s60 offen offset:448
    buffer_load_dwordx4 v[124:127], v181, s[44:47], s60 offen offset:480
    s_mov_b32 s60, 40960
    buffer_load_dwordx4 v[128:131], v181, s[44:47], s60 offen offset:384
    buffer_load_dwordx4 v[132:135], v181, s[44:47], s60 offen offset:416
    buffer_load_dwordx4 v[136:139], v181, s[44:47], s60 offen offset:448
    buffer_load_dwordx4 v[140:143], v181, s[44:47], s60 offen offset:480
    ds_read_b64_tr_b16 v[192:193], v176 offset:0
    ds_read_b64_tr_b16 v[194:195], v176 offset:1024
    ds_read_b64_tr_b16 v[196:197], v177 offset:0
    ds_read_b64_tr_b16 v[198:199], v177 offset:1024
    ds_read_b64_tr_b16 v[200:201], v178 offset:0
    ds_read_b64_tr_b16 v[202:203], v178 offset:1024
    ds_read_b64_tr_b16 v[204:205], v179 offset:0
    ds_read_b64_tr_b16 v[206:207], v179 offset:1024
    s_waitcnt vmcnt(35) lgkmcnt(6)
    v_mfma_f32_32x32x16_bf16 a[64:79], v[192:195], v[16:19], 0
    s_waitcnt vmcnt(31)
    v_mfma_f32_32x32x16_bf16 a[128:143], v[192:195], v[32:35], 0
    ds_read_b64_tr_b16 v[192:193], v176 offset:4096
    ds_read_b64_tr_b16 v[194:195], v176 offset:5120
    s_waitcnt lgkmcnt(6)
    v_mfma_f32_32x32x16_bf16 a[80:95], v[196:199], v[16:19], 0
    v_mfma_f32_32x32x16_bf16 a[144:159], v[196:199], v[32:35], 0
    ds_read_b64_tr_b16 v[196:197], v177 offset:4096
    ds_read_b64_tr_b16 v[198:199], v177 offset:5120
    s_waitcnt lgkmcnt(6)
    v_mfma_f32_32x32x16_bf16 a[96:111], v[200:203], v[16:19], 0
    v_mfma_f32_32x32x16_bf16 a[160:175], v[200:203], v[32:35], 0
    ds_read_b64_tr_b16 v[200:201], v178 offset:4096
    ds_read_b64_tr_b16 v[202:203], v178 offset:5120
    s_waitcnt lgkmcnt(6)
    v_mfma_f32_32x32x16_bf16 a[112:127], v[204:207], v[16:19], 0
    v_mfma_f32_32x32x16_bf16 a[176:191], v[204:207], v[32:35], 0
    ds_read_b64_tr_b16 v[204:205], v179 offset:4096
    ds_read_b64_tr_b16 v[206:207], v179 offset:5120
    s_waitcnt lgkmcnt(6)
    v_mfma_f32_32x32x16_bf16 a[64:79], v[192:195], v[20:23], a[64:79]
    s_waitcnt vmcnt(30)
    v_mfma_f32_32x32x16_bf16 a[128:143], v[192:195], v[36:39], a[128:143]
    ds_read_b64_tr_b16 v[192:193], v176 offset:8192
    ds_read_b64_tr_b16 v[194:195], v176 offset:9216
    s_waitcnt lgkmcnt(6)
    v_mfma_f32_32x32x16_bf16 a[80:95], v[196:199], v[20:23], a[80:95]
    v_mfma_f32_32x32x16_bf16 a[144:159], v[196:199], v[36:39], a[144:159]
    ds_read_b64_tr_b16 v[196:197], v177 offset:8192
    ds_read_b64_tr_b16 v[198:199], v177 offset:9216
    s_waitcnt lgkmcnt(6)
    v_mfma_f32_32x32x16_bf16 a[96:111], v[200:203], v[20:23], a[96:111]
    v_mfma_f32_32x32x16_bf16 a[160:175], v[200:203], v[36:39], a[160:175]
    ds_read_b64_tr_b16 v[200:201], v178 offset:8192
    ds_read_b64_tr_b16 v[202:203], v178 offset:9216
    s_waitcnt lgkmcnt(6)
    v_mfma_f32_32x32x16_bf16 a[112:127], v[204:207], v[20:23], a[112:127]
    v_mfma_f32_32x32x16_bf16 a[176:191], v[204:207], v[36:39], a[176:191]
    ds_read_b64_tr_b16 v[204:205], v179 offset:8192
    ds_read_b64_tr_b16 v[206:207], v179 offset:9216
    s_waitcnt lgkmcnt(6)
    v_mfma_f32_32x32x16_bf16 a[64:79], v[192:195], v[24:27], a[64:79]
    s_waitcnt vmcnt(29)
    v_mfma_f32_32x32x16_bf16 a[128:143], v[192:195], v[40:43], a[128:143]
    ds_read_b64_tr_b16 v[192:193], v176 offset:12288
    ds_read_b64_tr_b16 v[194:195], v176 offset:13312
    s_waitcnt lgkmcnt(6)
    v_mfma_f32_32x32x16_bf16 a[80:95], v[196:199], v[24:27], a[80:95]
    v_mfma_f32_32x32x16_bf16 a[144:159], v[196:199], v[40:43], a[144:159]
    ds_read_b64_tr_b16 v[196:197], v177 offset:12288
    ds_read_b64_tr_b16 v[198:199], v177 offset:13312
    s_waitcnt lgkmcnt(6)
    v_mfma_f32_32x32x16_bf16 a[96:111], v[200:203], v[24:27], a[96:111]
    v_mfma_f32_32x32x16_bf16 a[160:175], v[200:203], v[40:43], a[160:175]
    ds_read_b64_tr_b16 v[200:201], v178 offset:12288
    ds_read_b64_tr_b16 v[202:203], v178 offset:13312
    s_waitcnt lgkmcnt(6)
    v_mfma_f32_32x32x16_bf16 a[112:127], v[204:207], v[24:27], a[112:127]
    v_mfma_f32_32x32x16_bf16 a[176:191], v[204:207], v[40:43], a[176:191]
    ds_read_b64_tr_b16 v[204:205], v179 offset:12288
    ds_read_b64_tr_b16 v[206:207], v179 offset:13312
    s_waitcnt lgkmcnt(6)
    v_mfma_f32_32x32x16_bf16 a[64:79], v[192:195], v[28:31], a[64:79]
    s_waitcnt vmcnt(28)
    v_mfma_f32_32x32x16_bf16 a[128:143], v[192:195], v[44:47], a[128:143]
    s_waitcnt lgkmcnt(4)
    v_mfma_f32_32x32x16_bf16 a[80:95], v[196:199], v[28:31], a[80:95]
    v_mfma_f32_32x32x16_bf16 a[144:159], v[196:199], v[44:47], a[144:159]
    s_waitcnt lgkmcnt(2)
    v_mfma_f32_32x32x16_bf16 a[96:111], v[200:203], v[28:31], a[96:111]
    v_mfma_f32_32x32x16_bf16 a[160:175], v[200:203], v[44:47], a[160:175]
    s_waitcnt lgkmcnt(0)
    v_mfma_f32_32x32x16_bf16 a[112:127], v[204:207], v[28:31], a[112:127]
    v_mfma_f32_32x32x16_bf16 a[176:191], v[204:207], v[44:47], a[176:191]
    s_barrier
    s_add_u32 s33, s31, 65536
    s_mov_b32 m0, s33
    s_mov_b32 s34, 2097152
    buffer_load_dwordx4 v180, s[48:51], s34 offen lds
    s_add_u32 s33, s33, 1024
    s_mov_b32 m0, s33
    s_add_u32 s34, s34, 32768
    buffer_load_dwordx4 v180, s[48:51], s34 offen lds
    s_add_u32 s33, s33, 1024
    s_mov_b32 m0, s33
    s_add_u32 s34, s34, 32768
    buffer_load_dwordx4 v180, s[48:51], s34 offen lds
    s_add_u32 s33, s33, 1024
    s_mov_b32 m0, s33
    s_add_u32 s34, s34, 32768
    buffer_load_dwordx4 v180, s[48:51], s34 offen lds
    s_mov_b32 s60, 0
    buffer_load_dwordx4 v[16:19], v181, s[44:47], s60 offen offset:512
    buffer_load_dwordx4 v[20:23], v181, s[44:47], s60 offen offset:544
    buffer_load_dwordx4 v[24:27], v181, s[44:47], s60 offen offset:576
    buffer_load_dwordx4 v[28:31], v181, s[44:47], s60 offen offset:608
    s_mov_b32 s60, 40960
    buffer_load_dwordx4 v[32:35], v181, s[44:47], s60 offen offset:512
    buffer_load_dwordx4 v[36:39], v181, s[44:47], s60 offen offset:544
    buffer_load_dwordx4 v[40:43], v181, s[44:47], s60 offen offset:576
    buffer_load_dwordx4 v[44:47], v181, s[44:47], s60 offen offset:608
    ds_read_b64_tr_b16 v[192:193], v176 offset:16384
    ds_read_b64_tr_b16 v[194:195], v176 offset:17408
    ds_read_b64_tr_b16 v[196:197], v177 offset:16384
    ds_read_b64_tr_b16 v[198:199], v177 offset:17408
    ds_read_b64_tr_b16 v[200:201], v178 offset:16384
    ds_read_b64_tr_b16 v[202:203], v178 offset:17408
    ds_read_b64_tr_b16 v[204:205], v179 offset:16384
    ds_read_b64_tr_b16 v[206:207], v179 offset:17408
    s_waitcnt vmcnt(39) lgkmcnt(6)
    v_mfma_f32_32x32x16_bf16 a[64:79], v[192:195], v[48:51], a[64:79]
    s_waitcnt vmcnt(35)
    v_mfma_f32_32x32x16_bf16 a[128:143], v[192:195], v[64:67], a[128:143]
    ds_read_b64_tr_b16 v[192:193], v176 offset:20480
    ds_read_b64_tr_b16 v[194:195], v176 offset:21504
    s_waitcnt lgkmcnt(6)
    v_mfma_f32_32x32x16_bf16 a[80:95], v[196:199], v[48:51], a[80:95]
    v_mfma_f32_32x32x16_bf16 a[144:159], v[196:199], v[64:67], a[144:159]
    ds_read_b64_tr_b16 v[196:197], v177 offset:20480
    ds_read_b64_tr_b16 v[198:199], v177 offset:21504
    s_waitcnt lgkmcnt(6)
    v_mfma_f32_32x32x16_bf16 a[96:111], v[200:203], v[48:51], a[96:111]
    v_mfma_f32_32x32x16_bf16 a[160:175], v[200:203], v[64:67], a[160:175]
    ds_read_b64_tr_b16 v[200:201], v178 offset:20480
    ds_read_b64_tr_b16 v[202:203], v178 offset:21504
    s_waitcnt lgkmcnt(6)
    v_mfma_f32_32x32x16_bf16 a[112:127], v[204:207], v[48:51], a[112:127]
    v_mfma_f32_32x32x16_bf16 a[176:191], v[204:207], v[64:67], a[176:191]
    ds_read_b64_tr_b16 v[204:205], v179 offset:20480
    ds_read_b64_tr_b16 v[206:207], v179 offset:21504
    s_waitcnt lgkmcnt(6)
    v_mfma_f32_32x32x16_bf16 a[64:79], v[192:195], v[52:55], a[64:79]
    s_waitcnt vmcnt(34)
    v_mfma_f32_32x32x16_bf16 a[128:143], v[192:195], v[68:71], a[128:143]
    ds_read_b64_tr_b16 v[192:193], v176 offset:24576
    ds_read_b64_tr_b16 v[194:195], v176 offset:25600
    s_waitcnt lgkmcnt(6)
    v_mfma_f32_32x32x16_bf16 a[80:95], v[196:199], v[52:55], a[80:95]
    v_mfma_f32_32x32x16_bf16 a[144:159], v[196:199], v[68:71], a[144:159]
    ds_read_b64_tr_b16 v[196:197], v177 offset:24576
    ds_read_b64_tr_b16 v[198:199], v177 offset:25600
    s_waitcnt lgkmcnt(6)
    v_mfma_f32_32x32x16_bf16 a[96:111], v[200:203], v[52:55], a[96:111]
    v_mfma_f32_32x32x16_bf16 a[160:175], v[200:203], v[68:71], a[160:175]
    ds_read_b64_tr_b16 v[200:201], v178 offset:24576
    ds_read_b64_tr_b16 v[202:203], v178 offset:25600
    s_waitcnt lgkmcnt(6)
    v_mfma_f32_32x32x16_bf16 a[112:127], v[204:207], v[52:55], a[112:127]
    v_mfma_f32_32x32x16_bf16 a[176:191], v[204:207], v[68:71], a[176:191]
    ds_read_b64_tr_b16 v[204:205], v179 offset:24576
    ds_read_b64_tr_b16 v[206:207], v179 offset:25600
    s_waitcnt lgkmcnt(6)
    v_mfma_f32_32x32x16_bf16 a[64:79], v[192:195], v[56:59], a[64:79]
    s_waitcnt vmcnt(33)
    v_mfma_f32_32x32x16_bf16 a[128:143], v[192:195], v[72:75], a[128:143]
    ds_read_b64_tr_b16 v[192:193], v176 offset:28672
    ds_read_b64_tr_b16 v[194:195], v176 offset:29696
    s_waitcnt lgkmcnt(6)
    v_mfma_f32_32x32x16_bf16 a[80:95], v[196:199], v[56:59], a[80:95]
    v_mfma_f32_32x32x16_bf16 a[144:159], v[196:199], v[72:75], a[144:159]
    ds_read_b64_tr_b16 v[196:197], v177 offset:28672
    ds_read_b64_tr_b16 v[198:199], v177 offset:29696
    s_waitcnt lgkmcnt(6)
    v_mfma_f32_32x32x16_bf16 a[96:111], v[200:203], v[56:59], a[96:111]
    v_mfma_f32_32x32x16_bf16 a[160:175], v[200:203], v[72:75], a[160:175]
    ds_read_b64_tr_b16 v[200:201], v178 offset:28672
    ds_read_b64_tr_b16 v[202:203], v178 offset:29696
    s_waitcnt lgkmcnt(6)
    v_mfma_f32_32x32x16_bf16 a[112:127], v[204:207], v[56:59], a[112:127]
    v_mfma_f32_32x32x16_bf16 a[176:191], v[204:207], v[72:75], a[176:191]
    ds_read_b64_tr_b16 v[204:205], v179 offset:28672
    ds_read_b64_tr_b16 v[206:207], v179 offset:29696
    s_waitcnt lgkmcnt(6)
    v_mfma_f32_32x32x16_bf16 a[64:79], v[192:195], v[60:63], a[64:79]
    s_waitcnt vmcnt(32)
    v_mfma_f32_32x32x16_bf16 a[128:143], v[192:195], v[76:79], a[128:143]
    s_waitcnt lgkmcnt(4)
    v_mfma_f32_32x32x16_bf16 a[80:95], v[196:199], v[60:63], a[80:95]
    v_mfma_f32_32x32x16_bf16 a[144:159], v[196:199], v[76:79], a[144:159]
    s_waitcnt lgkmcnt(2)
    v_mfma_f32_32x32x16_bf16 a[96:111], v[200:203], v[60:63], a[96:111]
    v_mfma_f32_32x32x16_bf16 a[160:175], v[200:203], v[76:79], a[160:175]
    s_waitcnt lgkmcnt(0)
    v_mfma_f32_32x32x16_bf16 a[112:127], v[204:207], v[60:63], a[112:127]
    v_mfma_f32_32x32x16_bf16 a[176:191], v[204:207], v[76:79], a[176:191]
    s_barrier
    s_add_u32 s33, s31, 81920
    s_mov_b32 m0, s33
    s_mov_b32 s34, 2621440
    buffer_load_dwordx4 v180, s[48:51], s34 offen lds
    s_add_u32 s33, s33, 1024
    s_mov_b32 m0, s33
    s_add_u32 s34, s34, 32768
    buffer_load_dwordx4 v180, s[48:51], s34 offen lds
    s_add_u32 s33, s33, 1024
    s_mov_b32 m0, s33
    s_add_u32 s34, s34, 32768
    buffer_load_dwordx4 v180, s[48:51], s34 offen lds
    s_add_u32 s33, s33, 1024
    s_mov_b32 m0, s33
    s_add_u32 s34, s34, 32768
    buffer_load_dwordx4 v180, s[48:51], s34 offen lds
    s_mov_b32 s60, 0
    buffer_load_dwordx4 v[48:51], v181, s[44:47], s60 offen offset:640
    buffer_load_dwordx4 v[52:55], v181, s[44:47], s60 offen offset:672
    buffer_load_dwordx4 v[56:59], v181, s[44:47], s60 offen offset:704
    buffer_load_dwordx4 v[60:63], v181, s[44:47], s60 offen offset:736
    s_mov_b32 s60, 40960
    buffer_load_dwordx4 v[64:67], v181, s[44:47], s60 offen offset:640
    buffer_load_dwordx4 v[68:71], v181, s[44:47], s60 offen offset:672
    buffer_load_dwordx4 v[72:75], v181, s[44:47], s60 offen offset:704
    buffer_load_dwordx4 v[76:79], v181, s[44:47], s60 offen offset:736
    ds_read_b64_tr_b16 v[192:193], v176 offset:32768
    ds_read_b64_tr_b16 v[194:195], v176 offset:33792
    ds_read_b64_tr_b16 v[196:197], v177 offset:32768
    ds_read_b64_tr_b16 v[198:199], v177 offset:33792
    ds_read_b64_tr_b16 v[200:201], v178 offset:32768
    ds_read_b64_tr_b16 v[202:203], v178 offset:33792
    ds_read_b64_tr_b16 v[204:205], v179 offset:32768
    ds_read_b64_tr_b16 v[206:207], v179 offset:33792
    s_waitcnt vmcnt(43) lgkmcnt(6)
    v_mfma_f32_32x32x16_bf16 a[64:79], v[192:195], v[80:83], a[64:79]
    s_waitcnt vmcnt(39)
    v_mfma_f32_32x32x16_bf16 a[128:143], v[192:195], v[96:99], a[128:143]
    ds_read_b64_tr_b16 v[192:193], v176 offset:36864
    ds_read_b64_tr_b16 v[194:195], v176 offset:37888
    s_waitcnt lgkmcnt(6)
    v_mfma_f32_32x32x16_bf16 a[80:95], v[196:199], v[80:83], a[80:95]
    v_mfma_f32_32x32x16_bf16 a[144:159], v[196:199], v[96:99], a[144:159]
    ds_read_b64_tr_b16 v[196:197], v177 offset:36864
    ds_read_b64_tr_b16 v[198:199], v177 offset:37888
    s_waitcnt lgkmcnt(6)
    v_mfma_f32_32x32x16_bf16 a[96:111], v[200:203], v[80:83], a[96:111]
    v_mfma_f32_32x32x16_bf16 a[160:175], v[200:203], v[96:99], a[160:175]
    ds_read_b64_tr_b16 v[200:201], v178 offset:36864
    ds_read_b64_tr_b16 v[202:203], v178 offset:37888
    s_waitcnt lgkmcnt(6)
    v_mfma_f32_32x32x16_bf16 a[112:127], v[204:207], v[80:83], a[112:127]
    v_mfma_f32_32x32x16_bf16 a[176:191], v[204:207], v[96:99], a[176:191]
    ds_read_b64_tr_b16 v[204:205], v179 offset:36864
    ds_read_b64_tr_b16 v[206:207], v179 offset:37888
    s_waitcnt lgkmcnt(6)
    v_mfma_f32_32x32x16_bf16 a[64:79], v[192:195], v[84:87], a[64:79]
    s_waitcnt vmcnt(38)
    v_mfma_f32_32x32x16_bf16 a[128:143], v[192:195], v[100:103], a[128:143]
    ds_read_b64_tr_b16 v[192:193], v176 offset:40960
    ds_read_b64_tr_b16 v[194:195], v176 offset:41984
    s_waitcnt lgkmcnt(6)
    v_mfma_f32_32x32x16_bf16 a[80:95], v[196:199], v[84:87], a[80:95]
    v_mfma_f32_32x32x16_bf16 a[144:159], v[196:199], v[100:103], a[144:159]
    ds_read_b64_tr_b16 v[196:197], v177 offset:40960
    ds_read_b64_tr_b16 v[198:199], v177 offset:41984
    s_waitcnt lgkmcnt(6)
    v_mfma_f32_32x32x16_bf16 a[96:111], v[200:203], v[84:87], a[96:111]
    v_mfma_f32_32x32x16_bf16 a[160:175], v[200:203], v[100:103], a[160:175]
    ds_read_b64_tr_b16 v[200:201], v178 offset:40960
    ds_read_b64_tr_b16 v[202:203], v178 offset:41984
    s_waitcnt lgkmcnt(6)
    v_mfma_f32_32x32x16_bf16 a[112:127], v[204:207], v[84:87], a[112:127]
    v_mfma_f32_32x32x16_bf16 a[176:191], v[204:207], v[100:103], a[176:191]
    ds_read_b64_tr_b16 v[204:205], v179 offset:40960
    ds_read_b64_tr_b16 v[206:207], v179 offset:41984
    s_waitcnt lgkmcnt(6)
    v_mfma_f32_32x32x16_bf16 a[64:79], v[192:195], v[88:91], a[64:79]
    s_waitcnt vmcnt(37)
    v_mfma_f32_32x32x16_bf16 a[128:143], v[192:195], v[104:107], a[128:143]
    ds_read_b64_tr_b16 v[192:193], v176 offset:45056
    ds_read_b64_tr_b16 v[194:195], v176 offset:46080
    s_waitcnt lgkmcnt(6)
    v_mfma_f32_32x32x16_bf16 a[80:95], v[196:199], v[88:91], a[80:95]
    v_mfma_f32_32x32x16_bf16 a[144:159], v[196:199], v[104:107], a[144:159]
    ds_read_b64_tr_b16 v[196:197], v177 offset:45056
    ds_read_b64_tr_b16 v[198:199], v177 offset:46080
    s_waitcnt lgkmcnt(6)
    v_mfma_f32_32x32x16_bf16 a[96:111], v[200:203], v[88:91], a[96:111]
    v_mfma_f32_32x32x16_bf16 a[160:175], v[200:203], v[104:107], a[160:175]
    ds_read_b64_tr_b16 v[200:201], v178 offset:45056
    ds_read_b64_tr_b16 v[202:203], v178 offset:46080
    s_waitcnt lgkmcnt(6)
    v_mfma_f32_32x32x16_bf16 a[112:127], v[204:207], v[88:91], a[112:127]
    v_mfma_f32_32x32x16_bf16 a[176:191], v[204:207], v[104:107], a[176:191]
    ds_read_b64_tr_b16 v[204:205], v179 offset:45056
    ds_read_b64_tr_b16 v[206:207], v179 offset:46080
    s_waitcnt lgkmcnt(6)
    v_mfma_f32_32x32x16_bf16 a[64:79], v[192:195], v[92:95], a[64:79]
    s_waitcnt vmcnt(36)
    v_mfma_f32_32x32x16_bf16 a[128:143], v[192:195], v[108:111], a[128:143]
    s_waitcnt lgkmcnt(4)
    v_mfma_f32_32x32x16_bf16 a[80:95], v[196:199], v[92:95], a[80:95]
    v_mfma_f32_32x32x16_bf16 a[144:159], v[196:199], v[108:111], a[144:159]
    s_waitcnt lgkmcnt(2)
    v_mfma_f32_32x32x16_bf16 a[96:111], v[200:203], v[92:95], a[96:111]
    v_mfma_f32_32x32x16_bf16 a[160:175], v[200:203], v[108:111], a[160:175]
    s_waitcnt lgkmcnt(0)
    v_mfma_f32_32x32x16_bf16 a[112:127], v[204:207], v[92:95], a[112:127]
    v_mfma_f32_32x32x16_bf16 a[176:191], v[204:207], v[108:111], a[176:191]
    s_waitcnt vmcnt(32)
    s_barrier
    s_add_u32 s33, s31, 98304
    s_mov_b32 m0, s33
    s_mov_b32 s34, 3145728
    buffer_load_dwordx4 v180, s[48:51], s34 offen lds
    s_add_u32 s33, s33, 1024
    s_mov_b32 m0, s33
    s_add_u32 s34, s34, 32768
    buffer_load_dwordx4 v180, s[48:51], s34 offen lds
    s_add_u32 s33, s33, 1024
    s_mov_b32 m0, s33
    s_add_u32 s34, s34, 32768
    buffer_load_dwordx4 v180, s[48:51], s34 offen lds
    s_add_u32 s33, s33, 1024
    s_mov_b32 m0, s33
    s_add_u32 s34, s34, 32768
    buffer_load_dwordx4 v180, s[48:51], s34 offen lds
    s_mov_b32 s60, 0
    buffer_load_dwordx4 v[80:83], v181, s[44:47], s60 offen offset:768
    buffer_load_dwordx4 v[84:87], v181, s[44:47], s60 offen offset:800
    buffer_load_dwordx4 v[88:91], v181, s[44:47], s60 offen offset:832
    buffer_load_dwordx4 v[92:95], v181, s[44:47], s60 offen offset:864
    s_mov_b32 s60, 40960
    buffer_load_dwordx4 v[96:99], v181, s[44:47], s60 offen offset:768
    buffer_load_dwordx4 v[100:103], v181, s[44:47], s60 offen offset:800
    buffer_load_dwordx4 v[104:107], v181, s[44:47], s60 offen offset:832
    buffer_load_dwordx4 v[108:111], v181, s[44:47], s60 offen offset:864
    ds_read_b64_tr_b16 v[192:193], v176 offset:49152
    ds_read_b64_tr_b16 v[194:195], v176 offset:50176
    ds_read_b64_tr_b16 v[196:197], v177 offset:49152
    ds_read_b64_tr_b16 v[198:199], v177 offset:50176
    ds_read_b64_tr_b16 v[200:201], v178 offset:49152
    ds_read_b64_tr_b16 v[202:203], v178 offset:50176
    ds_read_b64_tr_b16 v[204:205], v179 offset:49152
    ds_read_b64_tr_b16 v[206:207], v179 offset:50176
    s_waitcnt vmcnt(43) lgkmcnt(6)
    v_mfma_f32_32x32x16_bf16 a[64:79], v[192:195], v[112:115], a[64:79]
    s_waitcnt vmcnt(39)
    v_mfma_f32_32x32x16_bf16 a[128:143], v[192:195], v[128:131], a[128:143]
    ds_read_b64_tr_b16 v[192:193], v176 offset:53248
    ds_read_b64_tr_b16 v[194:195], v176 offset:54272
    s_waitcnt lgkmcnt(6)
    v_mfma_f32_32x32x16_bf16 a[80:95], v[196:199], v[112:115], a[80:95]
    v_mfma_f32_32x32x16_bf16 a[144:159], v[196:199], v[128:131], a[144:159]
    ds_read_b64_tr_b16 v[196:197], v177 offset:53248
    ds_read_b64_tr_b16 v[198:199], v177 offset:54272
    s_waitcnt lgkmcnt(6)
    v_mfma_f32_32x32x16_bf16 a[96:111], v[200:203], v[112:115], a[96:111]
    v_mfma_f32_32x32x16_bf16 a[160:175], v[200:203], v[128:131], a[160:175]
    ds_read_b64_tr_b16 v[200:201], v178 offset:53248
    ds_read_b64_tr_b16 v[202:203], v178 offset:54272
    s_waitcnt lgkmcnt(6)
    v_mfma_f32_32x32x16_bf16 a[112:127], v[204:207], v[112:115], a[112:127]
    v_mfma_f32_32x32x16_bf16 a[176:191], v[204:207], v[128:131], a[176:191]
    ds_read_b64_tr_b16 v[204:205], v179 offset:53248
    ds_read_b64_tr_b16 v[206:207], v179 offset:54272
    s_waitcnt lgkmcnt(6)
    v_mfma_f32_32x32x16_bf16 a[64:79], v[192:195], v[116:119], a[64:79]
    s_waitcnt vmcnt(38)
    v_mfma_f32_32x32x16_bf16 a[128:143], v[192:195], v[132:135], a[128:143]
    ds_read_b64_tr_b16 v[192:193], v176 offset:57344
    ds_read_b64_tr_b16 v[194:195], v176 offset:58368
    s_waitcnt lgkmcnt(6)
    v_mfma_f32_32x32x16_bf16 a[80:95], v[196:199], v[116:119], a[80:95]
    v_mfma_f32_32x32x16_bf16 a[144:159], v[196:199], v[132:135], a[144:159]
    ds_read_b64_tr_b16 v[196:197], v177 offset:57344
    ds_read_b64_tr_b16 v[198:199], v177 offset:58368
    s_waitcnt lgkmcnt(6)
    v_mfma_f32_32x32x16_bf16 a[96:111], v[200:203], v[116:119], a[96:111]
    v_mfma_f32_32x32x16_bf16 a[160:175], v[200:203], v[132:135], a[160:175]
    ds_read_b64_tr_b16 v[200:201], v178 offset:57344
    ds_read_b64_tr_b16 v[202:203], v178 offset:58368
    s_waitcnt lgkmcnt(6)
    v_mfma_f32_32x32x16_bf16 a[112:127], v[204:207], v[116:119], a[112:127]
    v_mfma_f32_32x32x16_bf16 a[176:191], v[204:207], v[132:135], a[176:191]
    ds_read_b64_tr_b16 v[204:205], v179 offset:57344
    ds_read_b64_tr_b16 v[206:207], v179 offset:58368
    s_waitcnt lgkmcnt(6)
    v_mfma_f32_32x32x16_bf16 a[64:79], v[192:195], v[120:123], a[64:79]
    s_waitcnt vmcnt(37)
    v_mfma_f32_32x32x16_bf16 a[128:143], v[192:195], v[136:139], a[128:143]
    ds_read_b64_tr_b16 v[192:193], v176 offset:61440
    ds_read_b64_tr_b16 v[194:195], v176 offset:62464
    s_waitcnt lgkmcnt(6)
    v_mfma_f32_32x32x16_bf16 a[80:95], v[196:199], v[120:123], a[80:95]
    v_mfma_f32_32x32x16_bf16 a[144:159], v[196:199], v[136:139], a[144:159]
    ds_read_b64_tr_b16 v[196:197], v177 offset:61440
    ds_read_b64_tr_b16 v[198:199], v177 offset:62464
    s_waitcnt lgkmcnt(6)
    v_mfma_f32_32x32x16_bf16 a[96:111], v[200:203], v[120:123], a[96:111]
    v_mfma_f32_32x32x16_bf16 a[160:175], v[200:203], v[136:139], a[160:175]
    ds_read_b64_tr_b16 v[200:201], v178 offset:61440
    ds_read_b64_tr_b16 v[202:203], v178 offset:62464
    s_waitcnt lgkmcnt(6)
    v_mfma_f32_32x32x16_bf16 a[112:127], v[204:207], v[120:123], a[112:127]
    v_mfma_f32_32x32x16_bf16 a[176:191], v[204:207], v[136:139], a[176:191]
    ds_read_b64_tr_b16 v[204:205], v179 offset:61440
    ds_read_b64_tr_b16 v[206:207], v179 offset:62464
    s_waitcnt lgkmcnt(6)
    v_mfma_f32_32x32x16_bf16 a[64:79], v[192:195], v[124:127], a[64:79]
    s_waitcnt vmcnt(36)
    v_mfma_f32_32x32x16_bf16 a[128:143], v[192:195], v[140:143], a[128:143]
    s_waitcnt lgkmcnt(4)
    v_mfma_f32_32x32x16_bf16 a[80:95], v[196:199], v[124:127], a[80:95]
    v_mfma_f32_32x32x16_bf16 a[144:159], v[196:199], v[140:143], a[144:159]
    s_waitcnt lgkmcnt(2)
    v_mfma_f32_32x32x16_bf16 a[96:111], v[200:203], v[124:127], a[96:111]
    v_mfma_f32_32x32x16_bf16 a[160:175], v[200:203], v[140:143], a[160:175]
    s_waitcnt lgkmcnt(0)
    v_mfma_f32_32x32x16_bf16 a[112:127], v[204:207], v[124:127], a[112:127]
    v_mfma_f32_32x32x16_bf16 a[176:191], v[204:207], v[140:143], a[176:191]
    s_waitcnt vmcnt(32)
    s_barrier
    s_add_u32 s33, s31, 114688
    s_mov_b32 m0, s33
    s_mov_b32 s34, 3670016
    buffer_load_dwordx4 v180, s[48:51], s34 offen lds
    s_add_u32 s33, s33, 1024
    s_mov_b32 m0, s33
    s_add_u32 s34, s34, 32768
    buffer_load_dwordx4 v180, s[48:51], s34 offen lds
    s_add_u32 s33, s33, 1024
    s_mov_b32 m0, s33
    s_add_u32 s34, s34, 32768
    buffer_load_dwordx4 v180, s[48:51], s34 offen lds
    s_add_u32 s33, s33, 1024
    s_mov_b32 m0, s33
    s_add_u32 s34, s34, 32768
    buffer_load_dwordx4 v180, s[48:51], s34 offen lds
    s_mov_b32 s60, 0
    buffer_load_dwordx4 v[112:115], v181, s[44:47], s60 offen offset:896
    buffer_load_dwordx4 v[116:119], v181, s[44:47], s60 offen offset:928
    buffer_load_dwordx4 v[120:123], v181, s[44:47], s60 offen offset:960
    buffer_load_dwordx4 v[124:127], v181, s[44:47], s60 offen offset:992
    s_mov_b32 s60, 40960
    buffer_load_dwordx4 v[128:131], v181, s[44:47], s60 offen offset:896
    buffer_load_dwordx4 v[132:135], v181, s[44:47], s60 offen offset:928
    buffer_load_dwordx4 v[136:139], v181, s[44:47], s60 offen offset:960
    buffer_load_dwordx4 v[140:143], v181, s[44:47], s60 offen offset:992
    ds_read_b64_tr_b16 v[192:193], v176 offset:0
    ds_read_b64_tr_b16 v[194:195], v176 offset:1024
    ds_read_b64_tr_b16 v[196:197], v177 offset:0
    ds_read_b64_tr_b16 v[198:199], v177 offset:1024
    ds_read_b64_tr_b16 v[200:201], v178 offset:0
    ds_read_b64_tr_b16 v[202:203], v178 offset:1024
    ds_read_b64_tr_b16 v[204:205], v179 offset:0
    ds_read_b64_tr_b16 v[206:207], v179 offset:1024
    s_waitcnt vmcnt(43) lgkmcnt(6)
    v_mfma_f32_32x32x16_bf16 a[64:79], v[192:195], v[16:19], a[64:79]
    s_waitcnt vmcnt(39)
    v_mfma_f32_32x32x16_bf16 a[128:143], v[192:195], v[32:35], a[128:143]
    ds_read_b64_tr_b16 v[192:193], v176 offset:4096
    ds_read_b64_tr_b16 v[194:195], v176 offset:5120
    s_waitcnt lgkmcnt(6)
    v_mfma_f32_32x32x16_bf16 a[80:95], v[196:199], v[16:19], a[80:95]
    v_mfma_f32_32x32x16_bf16 a[144:159], v[196:199], v[32:35], a[144:159]
    ds_read_b64_tr_b16 v[196:197], v177 offset:4096
    ds_read_b64_tr_b16 v[198:199], v177 offset:5120
    s_waitcnt lgkmcnt(6)
    v_mfma_f32_32x32x16_bf16 a[96:111], v[200:203], v[16:19], a[96:111]
    v_mfma_f32_32x32x16_bf16 a[160:175], v[200:203], v[32:35], a[160:175]
    ds_read_b64_tr_b16 v[200:201], v178 offset:4096
    ds_read_b64_tr_b16 v[202:203], v178 offset:5120
    s_waitcnt lgkmcnt(6)
    v_mfma_f32_32x32x16_bf16 a[112:127], v[204:207], v[16:19], a[112:127]
    v_mfma_f32_32x32x16_bf16 a[176:191], v[204:207], v[32:35], a[176:191]
    ds_read_b64_tr_b16 v[204:205], v179 offset:4096
    ds_read_b64_tr_b16 v[206:207], v179 offset:5120
    s_waitcnt lgkmcnt(6)
    v_mfma_f32_32x32x16_bf16 a[64:79], v[192:195], v[20:23], a[64:79]
    s_waitcnt vmcnt(38)
    v_mfma_f32_32x32x16_bf16 a[128:143], v[192:195], v[36:39], a[128:143]
    ds_read_b64_tr_b16 v[192:193], v176 offset:8192
    ds_read_b64_tr_b16 v[194:195], v176 offset:9216
    s_waitcnt lgkmcnt(6)
    v_mfma_f32_32x32x16_bf16 a[80:95], v[196:199], v[20:23], a[80:95]
    v_mfma_f32_32x32x16_bf16 a[144:159], v[196:199], v[36:39], a[144:159]
    ds_read_b64_tr_b16 v[196:197], v177 offset:8192
    ds_read_b64_tr_b16 v[198:199], v177 offset:9216
    s_waitcnt lgkmcnt(6)
    v_mfma_f32_32x32x16_bf16 a[96:111], v[200:203], v[20:23], a[96:111]
    v_mfma_f32_32x32x16_bf16 a[160:175], v[200:203], v[36:39], a[160:175]
    ds_read_b64_tr_b16 v[200:201], v178 offset:8192
    ds_read_b64_tr_b16 v[202:203], v178 offset:9216
    s_waitcnt lgkmcnt(6)
    v_mfma_f32_32x32x16_bf16 a[112:127], v[204:207], v[20:23], a[112:127]
    v_mfma_f32_32x32x16_bf16 a[176:191], v[204:207], v[36:39], a[176:191]
    ds_read_b64_tr_b16 v[204:205], v179 offset:8192
    ds_read_b64_tr_b16 v[206:207], v179 offset:9216
    s_waitcnt lgkmcnt(6)
    v_mfma_f32_32x32x16_bf16 a[64:79], v[192:195], v[24:27], a[64:79]
    s_waitcnt vmcnt(37)
    v_mfma_f32_32x32x16_bf16 a[128:143], v[192:195], v[40:43], a[128:143]
    ds_read_b64_tr_b16 v[192:193], v176 offset:12288
    ds_read_b64_tr_b16 v[194:195], v176 offset:13312
    s_waitcnt lgkmcnt(6)
    v_mfma_f32_32x32x16_bf16 a[80:95], v[196:199], v[24:27], a[80:95]
    v_mfma_f32_32x32x16_bf16 a[144:159], v[196:199], v[40:43], a[144:159]
    ds_read_b64_tr_b16 v[196:197], v177 offset:12288
    ds_read_b64_tr_b16 v[198:199], v177 offset:13312
    s_waitcnt lgkmcnt(6)
    v_mfma_f32_32x32x16_bf16 a[96:111], v[200:203], v[24:27], a[96:111]
    v_mfma_f32_32x32x16_bf16 a[160:175], v[200:203], v[40:43], a[160:175]
    ds_read_b64_tr_b16 v[200:201], v178 offset:12288
    ds_read_b64_tr_b16 v[202:203], v178 offset:13312
    s_waitcnt lgkmcnt(6)
    v_mfma_f32_32x32x16_bf16 a[112:127], v[204:207], v[24:27], a[112:127]
    v_mfma_f32_32x32x16_bf16 a[176:191], v[204:207], v[40:43], a[176:191]
    ds_read_b64_tr_b16 v[204:205], v179 offset:12288
    ds_read_b64_tr_b16 v[206:207], v179 offset:13312
    s_waitcnt lgkmcnt(6)
    v_mfma_f32_32x32x16_bf16 a[64:79], v[192:195], v[28:31], a[64:79]
    s_waitcnt vmcnt(36)
    v_mfma_f32_32x32x16_bf16 a[128:143], v[192:195], v[44:47], a[128:143]
    s_waitcnt lgkmcnt(4)
    v_mfma_f32_32x32x16_bf16 a[80:95], v[196:199], v[28:31], a[80:95]
    v_mfma_f32_32x32x16_bf16 a[144:159], v[196:199], v[44:47], a[144:159]
    s_waitcnt lgkmcnt(2)
    v_mfma_f32_32x32x16_bf16 a[96:111], v[200:203], v[28:31], a[96:111]
    v_mfma_f32_32x32x16_bf16 a[160:175], v[200:203], v[44:47], a[160:175]
    s_waitcnt lgkmcnt(0)
    v_mfma_f32_32x32x16_bf16 a[112:127], v[204:207], v[28:31], a[112:127]
    v_mfma_f32_32x32x16_bf16 a[176:191], v[204:207], v[44:47], a[176:191]
    s_waitcnt vmcnt(32)
    s_barrier
    s_add_u32 s33, s31, 65536
    s_mov_b32 m0, s33
    s_mov_b32 s34, 4194304
    buffer_load_dwordx4 v180, s[48:51], s34 offen lds
    s_add_u32 s33, s33, 1024
    s_mov_b32 m0, s33
    s_add_u32 s34, s34, 32768
    buffer_load_dwordx4 v180, s[48:51], s34 offen lds
    s_add_u32 s33, s33, 1024
    s_mov_b32 m0, s33
    s_add_u32 s34, s34, 32768
    buffer_load_dwordx4 v180, s[48:51], s34 offen lds
    s_add_u32 s33, s33, 1024
    s_mov_b32 m0, s33
    s_add_u32 s34, s34, 32768
    buffer_load_dwordx4 v180, s[48:51], s34 offen lds
    s_mov_b32 s60, 0
    buffer_load_dwordx4 v[16:19], v181, s[44:47], s60 offen offset:1024
    buffer_load_dwordx4 v[20:23], v181, s[44:47], s60 offen offset:1056
    buffer_load_dwordx4 v[24:27], v181, s[44:47], s60 offen offset:1088
    buffer_load_dwordx4 v[28:31], v181, s[44:47], s60 offen offset:1120
    s_mov_b32 s60, 40960
    buffer_load_dwordx4 v[32:35], v181, s[44:47], s60 offen offset:1024
    buffer_load_dwordx4 v[36:39], v181, s[44:47], s60 offen offset:1056
    buffer_load_dwordx4 v[40:43], v181, s[44:47], s60 offen offset:1088
    buffer_load_dwordx4 v[44:47], v181, s[44:47], s60 offen offset:1120
    ds_read_b64_tr_b16 v[192:193], v176 offset:16384
    ds_read_b64_tr_b16 v[194:195], v176 offset:17408
    ds_read_b64_tr_b16 v[196:197], v177 offset:16384
    ds_read_b64_tr_b16 v[198:199], v177 offset:17408
    ds_read_b64_tr_b16 v[200:201], v178 offset:16384
    ds_read_b64_tr_b16 v[202:203], v178 offset:17408
    ds_read_b64_tr_b16 v[204:205], v179 offset:16384
    ds_read_b64_tr_b16 v[206:207], v179 offset:17408
    s_waitcnt vmcnt(43) lgkmcnt(6)
    v_mfma_f32_32x32x16_bf16 a[64:79], v[192:195], v[48:51], a[64:79]
    s_waitcnt vmcnt(39)
    v_mfma_f32_32x32x16_bf16 a[128:143], v[192:195], v[64:67], a[128:143]
    ds_read_b64_tr_b16 v[192:193], v176 offset:20480
    ds_read_b64_tr_b16 v[194:195], v176 offset:21504
    s_waitcnt lgkmcnt(6)
    v_mfma_f32_32x32x16_bf16 a[80:95], v[196:199], v[48:51], a[80:95]
    v_mfma_f32_32x32x16_bf16 a[144:159], v[196:199], v[64:67], a[144:159]
    ds_read_b64_tr_b16 v[196:197], v177 offset:20480
    ds_read_b64_tr_b16 v[198:199], v177 offset:21504
    s_waitcnt lgkmcnt(6)
    v_mfma_f32_32x32x16_bf16 a[96:111], v[200:203], v[48:51], a[96:111]
    v_mfma_f32_32x32x16_bf16 a[160:175], v[200:203], v[64:67], a[160:175]
    ds_read_b64_tr_b16 v[200:201], v178 offset:20480
    ds_read_b64_tr_b16 v[202:203], v178 offset:21504
    s_waitcnt lgkmcnt(6)
    v_mfma_f32_32x32x16_bf16 a[112:127], v[204:207], v[48:51], a[112:127]
    v_mfma_f32_32x32x16_bf16 a[176:191], v[204:207], v[64:67], a[176:191]
    ds_read_b64_tr_b16 v[204:205], v179 offset:20480
    ds_read_b64_tr_b16 v[206:207], v179 offset:21504
    s_waitcnt lgkmcnt(6)
    v_mfma_f32_32x32x16_bf16 a[64:79], v[192:195], v[52:55], a[64:79]
    s_waitcnt vmcnt(38)
    v_mfma_f32_32x32x16_bf16 a[128:143], v[192:195], v[68:71], a[128:143]
    ds_read_b64_tr_b16 v[192:193], v176 offset:24576
    ds_read_b64_tr_b16 v[194:195], v176 offset:25600
    s_waitcnt lgkmcnt(6)
    v_mfma_f32_32x32x16_bf16 a[80:95], v[196:199], v[52:55], a[80:95]
    v_mfma_f32_32x32x16_bf16 a[144:159], v[196:199], v[68:71], a[144:159]
    ds_read_b64_tr_b16 v[196:197], v177 offset:24576
    ds_read_b64_tr_b16 v[198:199], v177 offset:25600
    s_waitcnt lgkmcnt(6)
    v_mfma_f32_32x32x16_bf16 a[96:111], v[200:203], v[52:55], a[96:111]
    v_mfma_f32_32x32x16_bf16 a[160:175], v[200:203], v[68:71], a[160:175]
    ds_read_b64_tr_b16 v[200:201], v178 offset:24576
    ds_read_b64_tr_b16 v[202:203], v178 offset:25600
    s_waitcnt lgkmcnt(6)
    v_mfma_f32_32x32x16_bf16 a[112:127], v[204:207], v[52:55], a[112:127]
    v_mfma_f32_32x32x16_bf16 a[176:191], v[204:207], v[68:71], a[176:191]
    ds_read_b64_tr_b16 v[204:205], v179 offset:24576
    ds_read_b64_tr_b16 v[206:207], v179 offset:25600
    s_waitcnt lgkmcnt(6)
    v_mfma_f32_32x32x16_bf16 a[64:79], v[192:195], v[56:59], a[64:79]
    s_waitcnt vmcnt(37)
    v_mfma_f32_32x32x16_bf16 a[128:143], v[192:195], v[72:75], a[128:143]
    ds_read_b64_tr_b16 v[192:193], v176 offset:28672
    ds_read_b64_tr_b16 v[194:195], v176 offset:29696
    s_waitcnt lgkmcnt(6)
    v_mfma_f32_32x32x16_bf16 a[80:95], v[196:199], v[56:59], a[80:95]
    v_mfma_f32_32x32x16_bf16 a[144:159], v[196:199], v[72:75], a[144:159]
    ds_read_b64_tr_b16 v[196:197], v177 offset:28672
    ds_read_b64_tr_b16 v[198:199], v177 offset:29696
    s_waitcnt lgkmcnt(6)
    v_mfma_f32_32x32x16_bf16 a[96:111], v[200:203], v[56:59], a[96:111]
    v_mfma_f32_32x32x16_bf16 a[160:175], v[200:203], v[72:75], a[160:175]
    ds_read_b64_tr_b16 v[200:201], v178 offset:28672
    ds_read_b64_tr_b16 v[202:203], v178 offset:29696
    s_waitcnt lgkmcnt(6)
    v_mfma_f32_32x32x16_bf16 a[112:127], v[204:207], v[56:59], a[112:127]
    v_mfma_f32_32x32x16_bf16 a[176:191], v[204:207], v[72:75], a[176:191]
    ds_read_b64_tr_b16 v[204:205], v179 offset:28672
    ds_read_b64_tr_b16 v[206:207], v179 offset:29696
    s_waitcnt lgkmcnt(6)
    v_mfma_f32_32x32x16_bf16 a[64:79], v[192:195], v[60:63], a[64:79]
    s_waitcnt vmcnt(36)
    v_mfma_f32_32x32x16_bf16 a[128:143], v[192:195], v[76:79], a[128:143]
    s_waitcnt lgkmcnt(4)
    v_mfma_f32_32x32x16_bf16 a[80:95], v[196:199], v[60:63], a[80:95]
    v_mfma_f32_32x32x16_bf16 a[144:159], v[196:199], v[76:79], a[144:159]
    s_waitcnt lgkmcnt(2)
    v_mfma_f32_32x32x16_bf16 a[96:111], v[200:203], v[60:63], a[96:111]
    v_mfma_f32_32x32x16_bf16 a[160:175], v[200:203], v[76:79], a[160:175]
    s_waitcnt lgkmcnt(0)
    v_mfma_f32_32x32x16_bf16 a[112:127], v[204:207], v[60:63], a[112:127]
    v_mfma_f32_32x32x16_bf16 a[176:191], v[204:207], v[76:79], a[176:191]
    s_waitcnt vmcnt(32)
    s_barrier
    s_add_u32 s33, s31, 81920
    s_mov_b32 m0, s33
    s_mov_b32 s34, 4718592
    buffer_load_dwordx4 v180, s[48:51], s34 offen lds
    s_add_u32 s33, s33, 1024
    s_mov_b32 m0, s33
    s_add_u32 s34, s34, 32768
    buffer_load_dwordx4 v180, s[48:51], s34 offen lds
    s_add_u32 s33, s33, 1024
    s_mov_b32 m0, s33
    s_add_u32 s34, s34, 32768
    buffer_load_dwordx4 v180, s[48:51], s34 offen lds
    s_add_u32 s33, s33, 1024
    s_mov_b32 m0, s33
    s_add_u32 s34, s34, 32768
    buffer_load_dwordx4 v180, s[48:51], s34 offen lds
    s_mov_b32 s60, 0
    buffer_load_dwordx4 v[48:51], v181, s[44:47], s60 offen offset:1152
    buffer_load_dwordx4 v[52:55], v181, s[44:47], s60 offen offset:1184
    buffer_load_dwordx4 v[56:59], v181, s[44:47], s60 offen offset:1216
    buffer_load_dwordx4 v[60:63], v181, s[44:47], s60 offen offset:1248
    s_mov_b32 s60, 40960
    buffer_load_dwordx4 v[64:67], v181, s[44:47], s60 offen offset:1152
    buffer_load_dwordx4 v[68:71], v181, s[44:47], s60 offen offset:1184
    buffer_load_dwordx4 v[72:75], v181, s[44:47], s60 offen offset:1216
    buffer_load_dwordx4 v[76:79], v181, s[44:47], s60 offen offset:1248
    ds_read_b64_tr_b16 v[192:193], v176 offset:32768
    ds_read_b64_tr_b16 v[194:195], v176 offset:33792
    ds_read_b64_tr_b16 v[196:197], v177 offset:32768
    ds_read_b64_tr_b16 v[198:199], v177 offset:33792
    ds_read_b64_tr_b16 v[200:201], v178 offset:32768
    ds_read_b64_tr_b16 v[202:203], v178 offset:33792
    ds_read_b64_tr_b16 v[204:205], v179 offset:32768
    ds_read_b64_tr_b16 v[206:207], v179 offset:33792
    s_waitcnt vmcnt(43) lgkmcnt(6)
    v_mfma_f32_32x32x16_bf16 a[64:79], v[192:195], v[80:83], a[64:79]
    s_waitcnt vmcnt(39)
    v_mfma_f32_32x32x16_bf16 a[128:143], v[192:195], v[96:99], a[128:143]
    ds_read_b64_tr_b16 v[192:193], v176 offset:36864
    ds_read_b64_tr_b16 v[194:195], v176 offset:37888
    s_waitcnt lgkmcnt(6)
    v_mfma_f32_32x32x16_bf16 a[80:95], v[196:199], v[80:83], a[80:95]
    v_mfma_f32_32x32x16_bf16 a[144:159], v[196:199], v[96:99], a[144:159]
    ds_read_b64_tr_b16 v[196:197], v177 offset:36864
    ds_read_b64_tr_b16 v[198:199], v177 offset:37888
    s_waitcnt lgkmcnt(6)
    v_mfma_f32_32x32x16_bf16 a[96:111], v[200:203], v[80:83], a[96:111]
    v_mfma_f32_32x32x16_bf16 a[160:175], v[200:203], v[96:99], a[160:175]
    ds_read_b64_tr_b16 v[200:201], v178 offset:36864
    ds_read_b64_tr_b16 v[202:203], v178 offset:37888
    s_waitcnt lgkmcnt(6)
    v_mfma_f32_32x32x16_bf16 a[112:127], v[204:207], v[80:83], a[112:127]
    v_mfma_f32_32x32x16_bf16 a[176:191], v[204:207], v[96:99], a[176:191]
    ds_read_b64_tr_b16 v[204:205], v179 offset:36864
    ds_read_b64_tr_b16 v[206:207], v179 offset:37888
    s_waitcnt lgkmcnt(6)
    v_mfma_f32_32x32x16_bf16 a[64:79], v[192:195], v[84:87], a[64:79]
    s_waitcnt vmcnt(38)
    v_mfma_f32_32x32x16_bf16 a[128:143], v[192:195], v[100:103], a[128:143]
    ds_read_b64_tr_b16 v[192:193], v176 offset:40960
    ds_read_b64_tr_b16 v[194:195], v176 offset:41984
    s_waitcnt lgkmcnt(6)
    v_mfma_f32_32x32x16_bf16 a[80:95], v[196:199], v[84:87], a[80:95]
    v_mfma_f32_32x32x16_bf16 a[144:159], v[196:199], v[100:103], a[144:159]
    ds_read_b64_tr_b16 v[196:197], v177 offset:40960
    ds_read_b64_tr_b16 v[198:199], v177 offset:41984
    s_waitcnt lgkmcnt(6)
    v_mfma_f32_32x32x16_bf16 a[96:111], v[200:203], v[84:87], a[96:111]
    v_mfma_f32_32x32x16_bf16 a[160:175], v[200:203], v[100:103], a[160:175]
    ds_read_b64_tr_b16 v[200:201], v178 offset:40960
    ds_read_b64_tr_b16 v[202:203], v178 offset:41984
    s_waitcnt lgkmcnt(6)
    v_mfma_f32_32x32x16_bf16 a[112:127], v[204:207], v[84:87], a[112:127]
    v_mfma_f32_32x32x16_bf16 a[176:191], v[204:207], v[100:103], a[176:191]
    ds_read_b64_tr_b16 v[204:205], v179 offset:40960
    ds_read_b64_tr_b16 v[206:207], v179 offset:41984
    s_waitcnt lgkmcnt(6)
    v_mfma_f32_32x32x16_bf16 a[64:79], v[192:195], v[88:91], a[64:79]
    s_waitcnt vmcnt(37)
    v_mfma_f32_32x32x16_bf16 a[128:143], v[192:195], v[104:107], a[128:143]
    ds_read_b64_tr_b16 v[192:193], v176 offset:45056
    ds_read_b64_tr_b16 v[194:195], v176 offset:46080
    s_waitcnt lgkmcnt(6)
    v_mfma_f32_32x32x16_bf16 a[80:95], v[196:199], v[88:91], a[80:95]
    v_mfma_f32_32x32x16_bf16 a[144:159], v[196:199], v[104:107], a[144:159]
    ds_read_b64_tr_b16 v[196:197], v177 offset:45056
    ds_read_b64_tr_b16 v[198:199], v177 offset:46080
    s_waitcnt lgkmcnt(6)
    v_mfma_f32_32x32x16_bf16 a[96:111], v[200:203], v[88:91], a[96:111]
    v_mfma_f32_32x32x16_bf16 a[160:175], v[200:203], v[104:107], a[160:175]
    ds_read_b64_tr_b16 v[200:201], v178 offset:45056
    ds_read_b64_tr_b16 v[202:203], v178 offset:46080
    s_waitcnt lgkmcnt(6)
    v_mfma_f32_32x32x16_bf16 a[112:127], v[204:207], v[88:91], a[112:127]
    v_mfma_f32_32x32x16_bf16 a[176:191], v[204:207], v[104:107], a[176:191]
    ds_read_b64_tr_b16 v[204:205], v179 offset:45056
    ds_read_b64_tr_b16 v[206:207], v179 offset:46080
    s_waitcnt lgkmcnt(6)
    v_mfma_f32_32x32x16_bf16 a[64:79], v[192:195], v[92:95], a[64:79]
    s_waitcnt vmcnt(36)
    v_mfma_f32_32x32x16_bf16 a[128:143], v[192:195], v[108:111], a[128:143]
    s_waitcnt lgkmcnt(4)
    v_mfma_f32_32x32x16_bf16 a[80:95], v[196:199], v[92:95], a[80:95]
    v_mfma_f32_32x32x16_bf16 a[144:159], v[196:199], v[108:111], a[144:159]
    s_waitcnt lgkmcnt(2)
    v_mfma_f32_32x32x16_bf16 a[96:111], v[200:203], v[92:95], a[96:111]
    v_mfma_f32_32x32x16_bf16 a[160:175], v[200:203], v[108:111], a[160:175]
    s_waitcnt lgkmcnt(0)
    v_mfma_f32_32x32x16_bf16 a[112:127], v[204:207], v[92:95], a[112:127]
    v_mfma_f32_32x32x16_bf16 a[176:191], v[204:207], v[108:111], a[176:191]
    s_waitcnt vmcnt(32)
    s_barrier
    ds_read_b64_tr_b16 v[192:193], v176 offset:49152
    ds_read_b64_tr_b16 v[194:195], v176 offset:50176
    ds_read_b64_tr_b16 v[196:197], v177 offset:49152
    ds_read_b64_tr_b16 v[198:199], v177 offset:50176
    ds_read_b64_tr_b16 v[200:201], v178 offset:49152
    ds_read_b64_tr_b16 v[202:203], v178 offset:50176
    ds_read_b64_tr_b16 v[204:205], v179 offset:49152
    ds_read_b64_tr_b16 v[206:207], v179 offset:50176
    s_waitcnt vmcnt(31) lgkmcnt(6)
    v_mfma_f32_32x32x16_bf16 a[64:79], v[192:195], v[112:115], a[64:79]
    s_waitcnt vmcnt(27)
    v_mfma_f32_32x32x16_bf16 a[128:143], v[192:195], v[128:131], a[128:143]
    ds_read_b64_tr_b16 v[192:193], v176 offset:53248
    ds_read_b64_tr_b16 v[194:195], v176 offset:54272
    s_waitcnt lgkmcnt(6)
    v_mfma_f32_32x32x16_bf16 a[80:95], v[196:199], v[112:115], a[80:95]
    v_mfma_f32_32x32x16_bf16 a[144:159], v[196:199], v[128:131], a[144:159]
    ds_read_b64_tr_b16 v[196:197], v177 offset:53248
    ds_read_b64_tr_b16 v[198:199], v177 offset:54272
    s_waitcnt lgkmcnt(6)
    v_mfma_f32_32x32x16_bf16 a[96:111], v[200:203], v[112:115], a[96:111]
    v_mfma_f32_32x32x16_bf16 a[160:175], v[200:203], v[128:131], a[160:175]
    ds_read_b64_tr_b16 v[200:201], v178 offset:53248
    ds_read_b64_tr_b16 v[202:203], v178 offset:54272
    s_waitcnt lgkmcnt(6)
    v_mfma_f32_32x32x16_bf16 a[112:127], v[204:207], v[112:115], a[112:127]
    v_mfma_f32_32x32x16_bf16 a[176:191], v[204:207], v[128:131], a[176:191]
    ds_read_b64_tr_b16 v[204:205], v179 offset:53248
    ds_read_b64_tr_b16 v[206:207], v179 offset:54272
    s_waitcnt lgkmcnt(6)
    v_mfma_f32_32x32x16_bf16 a[64:79], v[192:195], v[116:119], a[64:79]
    s_waitcnt vmcnt(26)
    v_mfma_f32_32x32x16_bf16 a[128:143], v[192:195], v[132:135], a[128:143]
    ds_read_b64_tr_b16 v[192:193], v176 offset:57344
    ds_read_b64_tr_b16 v[194:195], v176 offset:58368
    s_waitcnt lgkmcnt(6)
    v_mfma_f32_32x32x16_bf16 a[80:95], v[196:199], v[116:119], a[80:95]
    v_mfma_f32_32x32x16_bf16 a[144:159], v[196:199], v[132:135], a[144:159]
    ds_read_b64_tr_b16 v[196:197], v177 offset:57344
    ds_read_b64_tr_b16 v[198:199], v177 offset:58368
    s_waitcnt lgkmcnt(6)
    v_mfma_f32_32x32x16_bf16 a[96:111], v[200:203], v[116:119], a[96:111]
    v_mfma_f32_32x32x16_bf16 a[160:175], v[200:203], v[132:135], a[160:175]
    ds_read_b64_tr_b16 v[200:201], v178 offset:57344
    ds_read_b64_tr_b16 v[202:203], v178 offset:58368
    s_waitcnt lgkmcnt(6)
    v_mfma_f32_32x32x16_bf16 a[112:127], v[204:207], v[116:119], a[112:127]
    v_mfma_f32_32x32x16_bf16 a[176:191], v[204:207], v[132:135], a[176:191]
    ds_read_b64_tr_b16 v[204:205], v179 offset:57344
    ds_read_b64_tr_b16 v[206:207], v179 offset:58368
    s_waitcnt lgkmcnt(6)
    v_mfma_f32_32x32x16_bf16 a[64:79], v[192:195], v[120:123], a[64:79]
    s_waitcnt vmcnt(25)
    v_mfma_f32_32x32x16_bf16 a[128:143], v[192:195], v[136:139], a[128:143]
    ds_read_b64_tr_b16 v[192:193], v176 offset:61440
    ds_read_b64_tr_b16 v[194:195], v176 offset:62464
    s_waitcnt lgkmcnt(6)
    v_mfma_f32_32x32x16_bf16 a[80:95], v[196:199], v[120:123], a[80:95]
    v_mfma_f32_32x32x16_bf16 a[144:159], v[196:199], v[136:139], a[144:159]
    ds_read_b64_tr_b16 v[196:197], v177 offset:61440
    ds_read_b64_tr_b16 v[198:199], v177 offset:62464
    s_waitcnt lgkmcnt(6)
    v_mfma_f32_32x32x16_bf16 a[96:111], v[200:203], v[120:123], a[96:111]
    v_mfma_f32_32x32x16_bf16 a[160:175], v[200:203], v[136:139], a[160:175]
    ds_read_b64_tr_b16 v[200:201], v178 offset:61440
    ds_read_b64_tr_b16 v[202:203], v178 offset:62464
    s_waitcnt lgkmcnt(6)
    v_mfma_f32_32x32x16_bf16 a[112:127], v[204:207], v[120:123], a[112:127]
    v_mfma_f32_32x32x16_bf16 a[176:191], v[204:207], v[136:139], a[176:191]
    ds_read_b64_tr_b16 v[204:205], v179 offset:61440
    ds_read_b64_tr_b16 v[206:207], v179 offset:62464
    s_waitcnt lgkmcnt(6)
    v_mfma_f32_32x32x16_bf16 a[64:79], v[192:195], v[124:127], a[64:79]
    s_waitcnt vmcnt(24)
    v_mfma_f32_32x32x16_bf16 a[128:143], v[192:195], v[140:143], a[128:143]
    s_waitcnt lgkmcnt(4)
    v_mfma_f32_32x32x16_bf16 a[80:95], v[196:199], v[124:127], a[80:95]
    v_mfma_f32_32x32x16_bf16 a[144:159], v[196:199], v[140:143], a[144:159]
    s_waitcnt lgkmcnt(2)
    v_mfma_f32_32x32x16_bf16 a[96:111], v[200:203], v[124:127], a[96:111]
    v_mfma_f32_32x32x16_bf16 a[160:175], v[200:203], v[140:143], a[160:175]
    s_waitcnt lgkmcnt(0)
    v_mfma_f32_32x32x16_bf16 a[112:127], v[204:207], v[124:127], a[112:127]
    v_mfma_f32_32x32x16_bf16 a[176:191], v[204:207], v[140:143], a[176:191]
    s_waitcnt vmcnt(20)
    s_barrier
    ds_read_b64_tr_b16 v[192:193], v176 offset:0
    ds_read_b64_tr_b16 v[194:195], v176 offset:1024
    ds_read_b64_tr_b16 v[196:197], v177 offset:0
    ds_read_b64_tr_b16 v[198:199], v177 offset:1024
    ds_read_b64_tr_b16 v[200:201], v178 offset:0
    ds_read_b64_tr_b16 v[202:203], v178 offset:1024
    ds_read_b64_tr_b16 v[204:205], v179 offset:0
    ds_read_b64_tr_b16 v[206:207], v179 offset:1024
    s_waitcnt vmcnt(19) lgkmcnt(6)
    v_mfma_f32_32x32x16_bf16 a[64:79], v[192:195], v[16:19], a[64:79]
    s_waitcnt vmcnt(15)
    v_mfma_f32_32x32x16_bf16 a[128:143], v[192:195], v[32:35], a[128:143]
    ds_read_b64_tr_b16 v[192:193], v176 offset:4096
    ds_read_b64_tr_b16 v[194:195], v176 offset:5120
    s_waitcnt lgkmcnt(6)
    v_mfma_f32_32x32x16_bf16 a[80:95], v[196:199], v[16:19], a[80:95]
    v_mfma_f32_32x32x16_bf16 a[144:159], v[196:199], v[32:35], a[144:159]
    ds_read_b64_tr_b16 v[196:197], v177 offset:4096
    ds_read_b64_tr_b16 v[198:199], v177 offset:5120
    s_waitcnt lgkmcnt(6)
    v_mfma_f32_32x32x16_bf16 a[96:111], v[200:203], v[16:19], a[96:111]
    v_mfma_f32_32x32x16_bf16 a[160:175], v[200:203], v[32:35], a[160:175]
    ds_read_b64_tr_b16 v[200:201], v178 offset:4096
    ds_read_b64_tr_b16 v[202:203], v178 offset:5120
    s_waitcnt lgkmcnt(6)
    v_mfma_f32_32x32x16_bf16 a[112:127], v[204:207], v[16:19], a[112:127]
    v_mfma_f32_32x32x16_bf16 a[176:191], v[204:207], v[32:35], a[176:191]
    ds_read_b64_tr_b16 v[204:205], v179 offset:4096
    ds_read_b64_tr_b16 v[206:207], v179 offset:5120
    s_waitcnt lgkmcnt(6)
    v_mfma_f32_32x32x16_bf16 a[64:79], v[192:195], v[20:23], a[64:79]
    s_waitcnt vmcnt(14)
    v_mfma_f32_32x32x16_bf16 a[128:143], v[192:195], v[36:39], a[128:143]
    ds_read_b64_tr_b16 v[192:193], v176 offset:8192
    ds_read_b64_tr_b16 v[194:195], v176 offset:9216
    s_waitcnt lgkmcnt(6)
    v_mfma_f32_32x32x16_bf16 a[80:95], v[196:199], v[20:23], a[80:95]
    v_mfma_f32_32x32x16_bf16 a[144:159], v[196:199], v[36:39], a[144:159]
    ds_read_b64_tr_b16 v[196:197], v177 offset:8192
    ds_read_b64_tr_b16 v[198:199], v177 offset:9216
    s_waitcnt lgkmcnt(6)
    v_mfma_f32_32x32x16_bf16 a[96:111], v[200:203], v[20:23], a[96:111]
    v_mfma_f32_32x32x16_bf16 a[160:175], v[200:203], v[36:39], a[160:175]
    ds_read_b64_tr_b16 v[200:201], v178 offset:8192
    ds_read_b64_tr_b16 v[202:203], v178 offset:9216
    s_waitcnt lgkmcnt(6)
    v_mfma_f32_32x32x16_bf16 a[112:127], v[204:207], v[20:23], a[112:127]
    v_mfma_f32_32x32x16_bf16 a[176:191], v[204:207], v[36:39], a[176:191]
    ds_read_b64_tr_b16 v[204:205], v179 offset:8192
    ds_read_b64_tr_b16 v[206:207], v179 offset:9216
    s_waitcnt lgkmcnt(6)
    v_mfma_f32_32x32x16_bf16 a[64:79], v[192:195], v[24:27], a[64:79]
    s_waitcnt vmcnt(13)
    v_mfma_f32_32x32x16_bf16 a[128:143], v[192:195], v[40:43], a[128:143]
    ds_read_b64_tr_b16 v[192:193], v176 offset:12288
    ds_read_b64_tr_b16 v[194:195], v176 offset:13312
    s_waitcnt lgkmcnt(6)
    v_mfma_f32_32x32x16_bf16 a[80:95], v[196:199], v[24:27], a[80:95]
    v_mfma_f32_32x32x16_bf16 a[144:159], v[196:199], v[40:43], a[144:159]
    ds_read_b64_tr_b16 v[196:197], v177 offset:12288
    ds_read_b64_tr_b16 v[198:199], v177 offset:13312
    s_waitcnt lgkmcnt(6)
    v_mfma_f32_32x32x16_bf16 a[96:111], v[200:203], v[24:27], a[96:111]
    v_mfma_f32_32x32x16_bf16 a[160:175], v[200:203], v[40:43], a[160:175]
    ds_read_b64_tr_b16 v[200:201], v178 offset:12288
    ds_read_b64_tr_b16 v[202:203], v178 offset:13312
    s_waitcnt lgkmcnt(6)
    v_mfma_f32_32x32x16_bf16 a[112:127], v[204:207], v[24:27], a[112:127]
    v_mfma_f32_32x32x16_bf16 a[176:191], v[204:207], v[40:43], a[176:191]
    ds_read_b64_tr_b16 v[204:205], v179 offset:12288
    ds_read_b64_tr_b16 v[206:207], v179 offset:13312
    s_waitcnt lgkmcnt(6)
    v_mfma_f32_32x32x16_bf16 a[64:79], v[192:195], v[28:31], a[64:79]
    s_waitcnt vmcnt(12)
    v_mfma_f32_32x32x16_bf16 a[128:143], v[192:195], v[44:47], a[128:143]
    s_waitcnt lgkmcnt(4)
    v_mfma_f32_32x32x16_bf16 a[80:95], v[196:199], v[28:31], a[80:95]
    v_mfma_f32_32x32x16_bf16 a[144:159], v[196:199], v[44:47], a[144:159]
    s_waitcnt lgkmcnt(2)
    v_mfma_f32_32x32x16_bf16 a[96:111], v[200:203], v[28:31], a[96:111]
    v_mfma_f32_32x32x16_bf16 a[160:175], v[200:203], v[44:47], a[160:175]
    s_waitcnt lgkmcnt(0)
    v_mfma_f32_32x32x16_bf16 a[112:127], v[204:207], v[28:31], a[112:127]
    v_mfma_f32_32x32x16_bf16 a[176:191], v[204:207], v[44:47], a[176:191]
    s_waitcnt vmcnt(8)
    s_barrier
    ds_read_b64_tr_b16 v[192:193], v176 offset:16384
    ds_read_b64_tr_b16 v[194:195], v176 offset:17408
    ds_read_b64_tr_b16 v[196:197], v177 offset:16384
    ds_read_b64_tr_b16 v[198:199], v177 offset:17408
    ds_read_b64_tr_b16 v[200:201], v178 offset:16384
    ds_read_b64_tr_b16 v[202:203], v178 offset:17408
    ds_read_b64_tr_b16 v[204:205], v179 offset:16384
    ds_read_b64_tr_b16 v[206:207], v179 offset:17408
    s_waitcnt vmcnt(7) lgkmcnt(6)
    v_mfma_f32_32x32x16_bf16 a[64:79], v[192:195], v[48:51], a[64:79]
    s_waitcnt vmcnt(3)
    v_mfma_f32_32x32x16_bf16 a[128:143], v[192:195], v[64:67], a[128:143]
    ds_read_b64_tr_b16 v[192:193], v176 offset:20480
    ds_read_b64_tr_b16 v[194:195], v176 offset:21504
    s_waitcnt lgkmcnt(6)
    v_mfma_f32_32x32x16_bf16 a[80:95], v[196:199], v[48:51], a[80:95]
    v_mfma_f32_32x32x16_bf16 a[144:159], v[196:199], v[64:67], a[144:159]
    ds_read_b64_tr_b16 v[196:197], v177 offset:20480
    ds_read_b64_tr_b16 v[198:199], v177 offset:21504
    s_waitcnt lgkmcnt(6)
    v_mfma_f32_32x32x16_bf16 a[96:111], v[200:203], v[48:51], a[96:111]
    v_mfma_f32_32x32x16_bf16 a[160:175], v[200:203], v[64:67], a[160:175]
    ds_read_b64_tr_b16 v[200:201], v178 offset:20480
    ds_read_b64_tr_b16 v[202:203], v178 offset:21504
    s_waitcnt lgkmcnt(6)
    v_mfma_f32_32x32x16_bf16 a[112:127], v[204:207], v[48:51], a[112:127]
    v_mfma_f32_32x32x16_bf16 a[176:191], v[204:207], v[64:67], a[176:191]
    ds_read_b64_tr_b16 v[204:205], v179 offset:20480
    ds_read_b64_tr_b16 v[206:207], v179 offset:21504
    s_waitcnt lgkmcnt(6)
    v_mfma_f32_32x32x16_bf16 a[64:79], v[192:195], v[52:55], a[64:79]
    s_waitcnt vmcnt(2)
    v_mfma_f32_32x32x16_bf16 a[128:143], v[192:195], v[68:71], a[128:143]
    ds_read_b64_tr_b16 v[192:193], v176 offset:24576
    ds_read_b64_tr_b16 v[194:195], v176 offset:25600
    s_waitcnt lgkmcnt(6)
    v_mfma_f32_32x32x16_bf16 a[80:95], v[196:199], v[52:55], a[80:95]
    v_mfma_f32_32x32x16_bf16 a[144:159], v[196:199], v[68:71], a[144:159]
    ds_read_b64_tr_b16 v[196:197], v177 offset:24576
    ds_read_b64_tr_b16 v[198:199], v177 offset:25600
    s_waitcnt lgkmcnt(6)
    v_mfma_f32_32x32x16_bf16 a[96:111], v[200:203], v[52:55], a[96:111]
    v_mfma_f32_32x32x16_bf16 a[160:175], v[200:203], v[68:71], a[160:175]
    ds_read_b64_tr_b16 v[200:201], v178 offset:24576
    ds_read_b64_tr_b16 v[202:203], v178 offset:25600
    s_waitcnt lgkmcnt(6)
    v_mfma_f32_32x32x16_bf16 a[112:127], v[204:207], v[52:55], a[112:127]
    v_mfma_f32_32x32x16_bf16 a[176:191], v[204:207], v[68:71], a[176:191]
    ds_read_b64_tr_b16 v[204:205], v179 offset:24576
    ds_read_b64_tr_b16 v[206:207], v179 offset:25600
    s_waitcnt lgkmcnt(6)
    v_mfma_f32_32x32x16_bf16 a[64:79], v[192:195], v[56:59], a[64:79]
    s_waitcnt vmcnt(1)
    v_mfma_f32_32x32x16_bf16 a[128:143], v[192:195], v[72:75], a[128:143]
    ds_read_b64_tr_b16 v[192:193], v176 offset:28672
    ds_read_b64_tr_b16 v[194:195], v176 offset:29696
    s_waitcnt lgkmcnt(6)
    v_mfma_f32_32x32x16_bf16 a[80:95], v[196:199], v[56:59], a[80:95]
    v_mfma_f32_32x32x16_bf16 a[144:159], v[196:199], v[72:75], a[144:159]
    ds_read_b64_tr_b16 v[196:197], v177 offset:28672
    ds_read_b64_tr_b16 v[198:199], v177 offset:29696
    s_waitcnt lgkmcnt(6)
    v_mfma_f32_32x32x16_bf16 a[96:111], v[200:203], v[56:59], a[96:111]
    v_mfma_f32_32x32x16_bf16 a[160:175], v[200:203], v[72:75], a[160:175]
    ds_read_b64_tr_b16 v[200:201], v178 offset:28672
    ds_read_b64_tr_b16 v[202:203], v178 offset:29696
    s_waitcnt lgkmcnt(6)
    v_mfma_f32_32x32x16_bf16 a[112:127], v[204:207], v[56:59], a[112:127]
    v_mfma_f32_32x32x16_bf16 a[176:191], v[204:207], v[72:75], a[176:191]
    ds_read_b64_tr_b16 v[204:205], v179 offset:28672
    ds_read_b64_tr_b16 v[206:207], v179 offset:29696
    s_waitcnt lgkmcnt(6)
    v_mfma_f32_32x32x16_bf16 a[64:79], v[192:195], v[60:63], a[64:79]
    s_waitcnt vmcnt(0)
    v_mfma_f32_32x32x16_bf16 a[128:143], v[192:195], v[76:79], a[128:143]
    s_waitcnt lgkmcnt(4)
    v_mfma_f32_32x32x16_bf16 a[80:95], v[196:199], v[60:63], a[80:95]
    v_mfma_f32_32x32x16_bf16 a[144:159], v[196:199], v[76:79], a[144:159]
    s_waitcnt lgkmcnt(2)
    v_mfma_f32_32x32x16_bf16 a[96:111], v[200:203], v[60:63], a[96:111]
    v_mfma_f32_32x32x16_bf16 a[160:175], v[200:203], v[76:79], a[160:175]
    s_waitcnt lgkmcnt(0)
    v_mfma_f32_32x32x16_bf16 a[112:127], v[204:207], v[60:63], a[112:127]
    v_mfma_f32_32x32x16_bf16 a[176:191], v[204:207], v[76:79], a[176:191]
    s_nop 0
    v_accvgpr_read_b32 v232, a64
    v_accvgpr_read_b32 v233, a65
    v_accvgpr_read_b32 v234, a66
    v_accvgpr_read_b32 v235, a67
    v_accvgpr_read_b32 v236, a68
    v_accvgpr_read_b32 v237, a69
    v_accvgpr_read_b32 v238, a70
    v_accvgpr_read_b32 v239, a71
    v_cvt_pk_bf16_f32 v16, v232, v233
    v_cvt_pk_bf16_f32 v17, v234, v235
    v_cvt_pk_bf16_f32 v18, v236, v237
    v_cvt_pk_bf16_f32 v19, v238, v239
    s_nop 0
    v_permlane32_swap_b32 v16, v18
    v_permlane32_swap_b32 v17, v19
    v_accvgpr_write_b32 a0, v16
    v_accvgpr_write_b32 a1, v17
    v_accvgpr_write_b32 a2, v18
    v_accvgpr_write_b32 a3, v19
    v_accvgpr_read_b32 v240, a72
    v_accvgpr_read_b32 v241, a73
    v_accvgpr_read_b32 v242, a74
    v_accvgpr_read_b32 v243, a75
    v_accvgpr_read_b32 v244, a76
    v_accvgpr_read_b32 v245, a77
    v_accvgpr_read_b32 v246, a78
    v_accvgpr_read_b32 v247, a79
    v_cvt_pk_bf16_f32 v20, v240, v241
    v_cvt_pk_bf16_f32 v21, v242, v243
    v_cvt_pk_bf16_f32 v22, v244, v245
    v_cvt_pk_bf16_f32 v23, v246, v247
    s_nop 0
    v_permlane32_swap_b32 v20, v22
    v_permlane32_swap_b32 v21, v23
    v_accvgpr_write_b32 a4, v20
    v_accvgpr_write_b32 a5, v21
    v_accvgpr_write_b32 a6, v22
    v_accvgpr_write_b32 a7, v23
    v_accvgpr_read_b32 v232, a80
    v_accvgpr_read_b32 v233, a81
    v_accvgpr_read_b32 v234, a82
    v_accvgpr_read_b32 v235, a83
    v_accvgpr_read_b32 v236, a84
    v_accvgpr_read_b32 v237, a85
    v_accvgpr_read_b32 v238, a86
    v_accvgpr_read_b32 v239, a87
    v_cvt_pk_bf16_f32 v24, v232, v233
    v_cvt_pk_bf16_f32 v25, v234, v235
    v_cvt_pk_bf16_f32 v26, v236, v237
    v_cvt_pk_bf16_f32 v27, v238, v239
    s_nop 0
    v_permlane32_swap_b32 v24, v26
    v_permlane32_swap_b32 v25, v27
    v_accvgpr_write_b32 a8, v24
    v_accvgpr_write_b32 a9, v25
    v_accvgpr_write_b32 a10, v26
    v_accvgpr_write_b32 a11, v27
    v_accvgpr_read_b32 v240, a88
    v_accvgpr_read_b32 v241, a89
    v_accvgpr_read_b32 v242, a90
    v_accvgpr_read_b32 v243, a91
    v_accvgpr_read_b32 v244, a92
    v_accvgpr_read_b32 v245, a93
    v_accvgpr_read_b32 v246, a94
    v_accvgpr_read_b32 v247, a95
    v_cvt_pk_bf16_f32 v28, v240, v241
    v_cvt_pk_bf16_f32 v29, v242, v243
    v_cvt_pk_bf16_f32 v30, v244, v245
    v_cvt_pk_bf16_f32 v31, v246, v247
    s_nop 0
    v_permlane32_swap_b32 v28, v30
    v_permlane32_swap_b32 v29, v31
    v_accvgpr_write_b32 a12, v28
    v_accvgpr_write_b32 a13, v29
    v_accvgpr_write_b32 a14, v30
    v_accvgpr_write_b32 a15, v31
    v_accvgpr_read_b32 v232, a96
    v_accvgpr_read_b32 v233, a97
    v_accvgpr_read_b32 v234, a98
    v_accvgpr_read_b32 v235, a99
    v_accvgpr_read_b32 v236, a100
    v_accvgpr_read_b32 v237, a101
    v_accvgpr_read_b32 v238, a102
    v_accvgpr_read_b32 v239, a103
    v_cvt_pk_bf16_f32 v32, v232, v233
    v_cvt_pk_bf16_f32 v33, v234, v235
    v_cvt_pk_bf16_f32 v34, v236, v237
    v_cvt_pk_bf16_f32 v35, v238, v239
    s_nop 0
    v_permlane32_swap_b32 v32, v34
    v_permlane32_swap_b32 v33, v35
    v_accvgpr_write_b32 a16, v32
    v_accvgpr_write_b32 a17, v33
    v_accvgpr_write_b32 a18, v34
    v_accvgpr_write_b32 a19, v35
    v_accvgpr_read_b32 v240, a104
    v_accvgpr_read_b32 v241, a105
    v_accvgpr_read_b32 v242, a106
    v_accvgpr_read_b32 v243, a107
    v_accvgpr_read_b32 v244, a108
    v_accvgpr_read_b32 v245, a109
    v_accvgpr_read_b32 v246, a110
    v_accvgpr_read_b32 v247, a111
    v_cvt_pk_bf16_f32 v36, v240, v241
    v_cvt_pk_bf16_f32 v37, v242, v243
    v_cvt_pk_bf16_f32 v38, v244, v245
    v_cvt_pk_bf16_f32 v39, v246, v247
    s_nop 0
    v_permlane32_swap_b32 v36, v38
    v_permlane32_swap_b32 v37, v39
    v_accvgpr_write_b32 a20, v36
    v_accvgpr_write_b32 a21, v37
    v_accvgpr_write_b32 a22, v38
    v_accvgpr_write_b32 a23, v39
    v_accvgpr_read_b32 v232, a112
    v_accvgpr_read_b32 v233, a113
    v_accvgpr_read_b32 v234, a114
    v_accvgpr_read_b32 v235, a115
    v_accvgpr_read_b32 v236, a116
    v_accvgpr_read_b32 v237, a117
    v_accvgpr_read_b32 v238, a118
    v_accvgpr_read_b32 v239, a119
    v_cvt_pk_bf16_f32 v40, v232, v233
    v_cvt_pk_bf16_f32 v41, v234, v235
    v_cvt_pk_bf16_f32 v42, v236, v237
    v_cvt_pk_bf16_f32 v43, v238, v239
    s_nop 0
    v_permlane32_swap_b32 v40, v42
    v_permlane32_swap_b32 v41, v43
    v_accvgpr_write_b32 a24, v40
    v_accvgpr_write_b32 a25, v41
    v_accvgpr_write_b32 a26, v42
    v_accvgpr_write_b32 a27, v43
    v_accvgpr_read_b32 v240, a120
    v_accvgpr_read_b32 v241, a121
    v_accvgpr_read_b32 v242, a122
    v_accvgpr_read_b32 v243, a123
    v_accvgpr_read_b32 v244, a124
    v_accvgpr_read_b32 v245, a125
    v_accvgpr_read_b32 v246, a126
    v_accvgpr_read_b32 v247, a127
    v_cvt_pk_bf16_f32 v44, v240, v241
    v_cvt_pk_bf16_f32 v45, v242, v243
    v_cvt_pk_bf16_f32 v46, v244, v245
    v_cvt_pk_bf16_f32 v47, v246, v247
    s_nop 0
    v_permlane32_swap_b32 v44, v46
    v_permlane32_swap_b32 v45, v47
    v_accvgpr_write_b32 a28, v44
    v_accvgpr_write_b32 a29, v45
    v_accvgpr_write_b32 a30, v46
    v_accvgpr_write_b32 a31, v47
    v_accvgpr_read_b32 v232, a128
    v_accvgpr_read_b32 v233, a129
    v_accvgpr_read_b32 v234, a130
    v_accvgpr_read_b32 v235, a131
    v_accvgpr_read_b32 v236, a132
    v_accvgpr_read_b32 v237, a133
    v_accvgpr_read_b32 v238, a134
    v_accvgpr_read_b32 v239, a135
    v_cvt_pk_bf16_f32 v16, v232, v233
    v_cvt_pk_bf16_f32 v17, v234, v235
    v_cvt_pk_bf16_f32 v18, v236, v237
    v_cvt_pk_bf16_f32 v19, v238, v239
    s_nop 0
    v_permlane32_swap_b32 v16, v18
    v_permlane32_swap_b32 v17, v19
    v_accvgpr_write_b32 a32, v16
    v_accvgpr_write_b32 a33, v17
    v_accvgpr_write_b32 a34, v18
    v_accvgpr_write_b32 a35, v19
    v_accvgpr_read_b32 v240, a136
    v_accvgpr_read_b32 v241, a137
    v_accvgpr_read_b32 v242, a138
    v_accvgpr_read_b32 v243, a139
    v_accvgpr_read_b32 v244, a140
    v_accvgpr_read_b32 v245, a141
    v_accvgpr_read_b32 v246, a142
    v_accvgpr_read_b32 v247, a143
    v_cvt_pk_bf16_f32 v20, v240, v241
    v_cvt_pk_bf16_f32 v21, v242, v243
    v_cvt_pk_bf16_f32 v22, v244, v245
    v_cvt_pk_bf16_f32 v23, v246, v247
    s_nop 0
    v_permlane32_swap_b32 v20, v22
    v_permlane32_swap_b32 v21, v23
    v_accvgpr_write_b32 a36, v20
    v_accvgpr_write_b32 a37, v21
    v_accvgpr_write_b32 a38, v22
    v_accvgpr_write_b32 a39, v23
    v_accvgpr_read_b32 v232, a144
    v_accvgpr_read_b32 v233, a145
    v_accvgpr_read_b32 v234, a146
    v_accvgpr_read_b32 v235, a147
    v_accvgpr_read_b32 v236, a148
    v_accvgpr_read_b32 v237, a149
    v_accvgpr_read_b32 v238, a150
    v_accvgpr_read_b32 v239, a151
    v_cvt_pk_bf16_f32 v24, v232, v233
    v_cvt_pk_bf16_f32 v25, v234, v235
    v_cvt_pk_bf16_f32 v26, v236, v237
    v_cvt_pk_bf16_f32 v27, v238, v239
    s_nop 0
    v_permlane32_swap_b32 v24, v26
    v_permlane32_swap_b32 v25, v27
    v_accvgpr_write_b32 a40, v24
    v_accvgpr_write_b32 a41, v25
    v_accvgpr_write_b32 a42, v26
    v_accvgpr_write_b32 a43, v27
    v_accvgpr_read_b32 v240, a152
    v_accvgpr_read_b32 v241, a153
    v_accvgpr_read_b32 v242, a154
    v_accvgpr_read_b32 v243, a155
    v_accvgpr_read_b32 v244, a156
    v_accvgpr_read_b32 v245, a157
    v_accvgpr_read_b32 v246, a158
    v_accvgpr_read_b32 v247, a159
    v_cvt_pk_bf16_f32 v28, v240, v241
    v_cvt_pk_bf16_f32 v29, v242, v243
    v_cvt_pk_bf16_f32 v30, v244, v245
    v_cvt_pk_bf16_f32 v31, v246, v247
    s_nop 0
    v_permlane32_swap_b32 v28, v30
    v_permlane32_swap_b32 v29, v31
    v_accvgpr_write_b32 a44, v28
    v_accvgpr_write_b32 a45, v29
    v_accvgpr_write_b32 a46, v30
    v_accvgpr_write_b32 a47, v31
    v_accvgpr_read_b32 v232, a160
    v_accvgpr_read_b32 v233, a161
    v_accvgpr_read_b32 v234, a162
    v_accvgpr_read_b32 v235, a163
    v_accvgpr_read_b32 v236, a164
    v_accvgpr_read_b32 v237, a165
    v_accvgpr_read_b32 v238, a166
    v_accvgpr_read_b32 v239, a167
    v_cvt_pk_bf16_f32 v32, v232, v233
    v_cvt_pk_bf16_f32 v33, v234, v235
    v_cvt_pk_bf16_f32 v34, v236, v237
    v_cvt_pk_bf16_f32 v35, v238, v239
    s_nop 0
    v_permlane32_swap_b32 v32, v34
    v_permlane32_swap_b32 v33, v35
    v_accvgpr_write_b32 a48, v32
    v_accvgpr_write_b32 a49, v33
    v_accvgpr_write_b32 a50, v34
    v_accvgpr_write_b32 a51, v35
    v_accvgpr_read_b32 v240, a168
    v_accvgpr_read_b32 v241, a169
    v_accvgpr_read_b32 v242, a170
    v_accvgpr_read_b32 v243, a171
    v_accvgpr_read_b32 v244, a172
    v_accvgpr_read_b32 v245, a173
    v_accvgpr_read_b32 v246, a174
    v_accvgpr_read_b32 v247, a175
    v_cvt_pk_bf16_f32 v36, v240, v241
    v_cvt_pk_bf16_f32 v37, v242, v243
    v_cvt_pk_bf16_f32 v38, v244, v245
    v_cvt_pk_bf16_f32 v39, v246, v247
    s_nop 0
    v_permlane32_swap_b32 v36, v38
    v_permlane32_swap_b32 v37, v39
    v_accvgpr_write_b32 a52, v36
    v_accvgpr_write_b32 a53, v37
    v_accvgpr_write_b32 a54, v38
    v_accvgpr_write_b32 a55, v39
    v_accvgpr_read_b32 v232, a176
    v_accvgpr_read_b32 v233, a177
    v_accvgpr_read_b32 v234, a178
    v_accvgpr_read_b32 v235, a179
    v_accvgpr_read_b32 v236, a180
    v_accvgpr_read_b32 v237, a181
    v_accvgpr_read_b32 v238, a182
    v_accvgpr_read_b32 v239, a183
    v_cvt_pk_bf16_f32 v40, v232, v233
    v_cvt_pk_bf16_f32 v41, v234, v235
    v_cvt_pk_bf16_f32 v42, v236, v237
    v_cvt_pk_bf16_f32 v43, v238, v239
    s_nop 0
    v_permlane32_swap_b32 v40, v42
    v_permlane32_swap_b32 v41, v43
    v_accvgpr_write_b32 a56, v40
    v_accvgpr_write_b32 a57, v41
    v_accvgpr_write_b32 a58, v42
    v_accvgpr_write_b32 a59, v43
    v_accvgpr_read_b32 v240, a184
    v_accvgpr_read_b32 v241, a185
    v_accvgpr_read_b32 v242, a186
    v_accvgpr_read_b32 v243, a187
    v_accvgpr_read_b32 v244, a188
    v_accvgpr_read_b32 v245, a189
    v_accvgpr_read_b32 v246, a190
    v_accvgpr_read_b32 v247, a191
    v_cvt_pk_bf16_f32 v44, v240, v241
    v_cvt_pk_bf16_f32 v45, v242, v243
    v_cvt_pk_bf16_f32 v46, v244, v245
    v_cvt_pk_bf16_f32 v47, v246, v247
    s_nop 0
    v_permlane32_swap_b32 v44, v46
    v_permlane32_swap_b32 v45, v47
    v_accvgpr_write_b32 a60, v44
    v_accvgpr_write_b32 a61, v45
    v_accvgpr_write_b32 a62, v46
    v_accvgpr_write_b32 a63, v47
    s_barrier
    s_add_u32 s33, s31, 32768
    s_mov_b32 s34, 0
    s_add_u32 s35, s33, 65536
    s_mov_b32 m0, s35
    s_nop 0
    buffer_load_dwordx4 v224, s[16:19], s34 offen offset:0 lds
    buffer_load_dwordx4 v224, s[16:19], s34 offen offset:1024 lds
    buffer_load_dwordx4 v224, s[16:19], s34 offen offset:2048 lds
    buffer_load_dwordx4 v224, s[16:19], s34 offen offset:3072 lds
    s_add_u32 s33, s31, 49152
    s_mov_b32 s34, 16384
    s_add_u32 s35, s33, 65536
    s_mov_b32 m0, s35
    s_nop 0
    buffer_load_dwordx4 v224, s[16:19], s34 offen offset:0 lds
    buffer_load_dwordx4 v224, s[16:19], s34 offen offset:1024 lds
    buffer_load_dwordx4 v224, s[16:19], s34 offen offset:2048 lds
    buffer_load_dwordx4 v224, s[16:19], s34 offen offset:3072 lds
    s_add_u32 s33, s31, 0
    s_mov_b32 s34, 32768
    s_add_u32 s35, s33, 65536
    s_mov_b32 m0, s35
    s_nop 0
    buffer_load_dwordx4 v224, s[16:19], s34 offen offset:0 lds
    buffer_load_dwordx4 v224, s[16:19], s34 offen offset:1024 lds
    buffer_load_dwordx4 v224, s[16:19], s34 offen offset:2048 lds
    buffer_load_dwordx4 v224, s[16:19], s34 offen offset:3072 lds
    s_mov_b32 s30, 0
    s_mov_b32 s29, 49152
    v_mov_b32 v225, 4286578688
    v_mov_b32 v227, 0
    v_mov_b32 v226, 4286578688
    v_mov_b32 v228, 0
    v_mov_b32 v247, 0
    v_accvgpr_write_b32 a64, v247
    v_accvgpr_write_b32 a65, v247
    v_accvgpr_write_b32 a66, v247
    v_accvgpr_write_b32 a67, v247
    v_accvgpr_write_b32 a68, v247
    v_accvgpr_write_b32 a69, v247
    v_accvgpr_write_b32 a70, v247
    v_accvgpr_write_b32 a71, v247
    v_accvgpr_write_b32 a72, v247
    v_accvgpr_write_b32 a73, v247
    v_accvgpr_write_b32 a74, v247
    v_accvgpr_write_b32 a75, v247
    v_accvgpr_write_b32 a76, v247
    v_accvgpr_write_b32 a77, v247
    v_accvgpr_write_b32 a78, v247
    v_accvgpr_write_b32 a79, v247
    v_accvgpr_write_b32 a80, v247
    v_accvgpr_write_b32 a81, v247
    v_accvgpr_write_b32 a82, v247
    v_accvgpr_write_b32 a83, v247
    v_accvgpr_write_b32 a84, v247
    v_accvgpr_write_b32 a85, v247
    v_accvgpr_write_b32 a86, v247
    v_accvgpr_write_b32 a87, v247
    v_accvgpr_write_b32 a88, v247
    v_accvgpr_write_b32 a89, v247
    v_accvgpr_write_b32 a90, v247
    v_accvgpr_write_b32 a91, v247
    v_accvgpr_write_b32 a92, v247
    v_accvgpr_write_b32 a93, v247
    v_accvgpr_write_b32 a94, v247
    v_accvgpr_write_b32 a95, v247
    v_accvgpr_write_b32 a96, v247
    v_accvgpr_write_b32 a97, v247
    v_accvgpr_write_b32 a98, v247
    v_accvgpr_write_b32 a99, v247
    v_accvgpr_write_b32 a100, v247
    v_accvgpr_write_b32 a101, v247
    v_accvgpr_write_b32 a102, v247
    v_accvgpr_write_b32 a103, v247
    v_accvgpr_write_b32 a104, v247
    v_accvgpr_write_b32 a105, v247
    v_accvgpr_write_b32 a106, v247
    v_accvgpr_write_b32 a107, v247
    v_accvgpr_write_b32 a108, v247
    v_accvgpr_write_b32 a109, v247
    v_accvgpr_write_b32 a110, v247
    v_accvgpr_write_b32 a111, v247
    v_accvgpr_write_b32 a112, v247
    v_accvgpr_write_b32 a113, v247
    v_accvgpr_write_b32 a114, v247
    v_accvgpr_write_b32 a115, v247
    v_accvgpr_write_b32 a116, v247
    v_accvgpr_write_b32 a117, v247
    v_accvgpr_write_b32 a118, v247
    v_accvgpr_write_b32 a119, v247
    v_accvgpr_write_b32 a120, v247
    v_accvgpr_write_b32 a121, v247
    v_accvgpr_write_b32 a122, v247
    v_accvgpr_write_b32 a123, v247
    v_accvgpr_write_b32 a124, v247
    v_accvgpr_write_b32 a125, v247
    v_accvgpr_write_b32 a126, v247
    v_accvgpr_write_b32 a127, v247
    v_accvgpr_write_b32 a128, v247
    v_accvgpr_write_b32 a129, v247
    v_accvgpr_write_b32 a130, v247
    v_accvgpr_write_b32 a131, v247
    v_accvgpr_write_b32 a132, v247
    v_accvgpr_write_b32 a133, v247
    v_accvgpr_write_b32 a134, v247
    v_accvgpr_write_b32 a135, v247
    v_accvgpr_write_b32 a136, v247
    v_accvgpr_write_b32 a137, v247
    v_accvgpr_write_b32 a138, v247
    v_accvgpr_write_b32 a139, v247
    v_accvgpr_write_b32 a140, v247
    v_accvgpr_write_b32 a141, v247
    v_accvgpr_write_b32 a142, v247
    v_accvgpr_write_b32 a143, v247
    v_accvgpr_write_b32 a144, v247
    v_accvgpr_write_b32 a145, v247
    v_accvgpr_write_b32 a146, v247
    v_accvgpr_write_b32 a147, v247
    v_accvgpr_write_b32 a148, v247
    v_accvgpr_write_b32 a149, v247
    v_accvgpr_write_b32 a150, v247
    v_accvgpr_write_b32 a151, v247
    v_accvgpr_write_b32 a152, v247
    v_accvgpr_write_b32 a153, v247
    v_accvgpr_write_b32 a154, v247
    v_accvgpr_write_b32 a155, v247
    v_accvgpr_write_b32 a156, v247
    v_accvgpr_write_b32 a157, v247
    v_accvgpr_write_b32 a158, v247
    v_accvgpr_write_b32 a159, v247
    v_accvgpr_write_b32 a160, v247
    v_accvgpr_write_b32 a161, v247
    v_accvgpr_write_b32 a162, v247
    v_accvgpr_write_b32 a163, v247
    v_accvgpr_write_b32 a164, v247
    v_accvgpr_write_b32 a165, v247
    v_accvgpr_write_b32 a166, v247
    v_accvgpr_write_b32 a167, v247
    v_accvgpr_write_b32 a168, v247
    v_accvgpr_write_b32 a169, v247
    v_accvgpr_write_b32 a170, v247
    v_accvgpr_write_b32 a171, v247
    v_accvgpr_write_b32 a172, v247
    v_accvgpr_write_b32 a173, v247
    v_accvgpr_write_b32 a174, v247
    v_accvgpr_write_b32 a175, v247
    v_accvgpr_write_b32 a176, v247
    v_accvgpr_write_b32 a177, v247
    v_accvgpr_write_b32 a178, v247
    v_accvgpr_write_b32 a179, v247
    v_accvgpr_write_b32 a180, v247
    v_accvgpr_write_b32 a181, v247
    v_accvgpr_write_b32 a182, v247
    v_accvgpr_write_b32 a183, v247
    v_accvgpr_write_b32 a184, v247
    v_accvgpr_write_b32 a185, v247
    v_accvgpr_write_b32 a186, v247
    v_accvgpr_write_b32 a187, v247
    v_accvgpr_write_b32 a188, v247
    v_accvgpr_write_b32 a189, v247
    v_accvgpr_write_b32 a190, v247
    v_accvgpr_write_b32 a191, v247
    ds_read_b128 v[176:179], v208 offset:16384
    ds_read_b128 v[180:183], v209 offset:16384
    ds_read_b128 v[184:187], v210 offset:16384
    ds_read_b128 v[188:191], v211 offset:16384
    s_waitcnt lgkmcnt(3)
    v_mfma_f32_32x32x16_bf16 v[16:31], v[176:179], a[0:3], 0
    v_mfma_f32_32x32x16_bf16 v[48:63], v[176:179], a[32:35], 0
    ds_read_b128 v[176:179], v212 offset:16384
    s_waitcnt lgkmcnt(3)
    v_mfma_f32_32x32x16_bf16 v[16:31], v[180:183], a[4:7], v[16:31]
    v_mfma_f32_32x32x16_bf16 v[48:63], v[180:183], a[36:39], v[48:63]
    ds_read_b128 v[180:183], v213 offset:16384
    s_waitcnt lgkmcnt(3)
    v_mfma_f32_32x32x16_bf16 v[16:31], v[184:187], a[8:11], v[16:31]
    v_mfma_f32_32x32x16_bf16 v[48:63], v[184:187], a[40:43], v[48:63]
    ds_read_b128 v[184:187], v214 offset:16384
    s_waitcnt lgkmcnt(3)
    v_mfma_f32_32x32x16_bf16 v[16:31], v[188:191], a[12:15], v[16:31]
    v_mfma_f32_32x32x16_bf16 v[48:63], v[188:191], a[44:47], v[48:63]
    ds_read_b128 v[188:191], v215 offset:16384
    s_waitcnt lgkmcnt(3)
    v_mfma_f32_32x32x16_bf16 v[16:31], v[176:179], a[16:19], v[16:31]
    v_mfma_f32_32x32x16_bf16 v[48:63], v[176:179], a[48:51], v[48:63]
    ds_read_b128 v[176:179], v208 offset:24576
    s_waitcnt lgkmcnt(3)
    v_mfma_f32_32x32x16_bf16 v[16:31], v[180:183], a[20:23], v[16:31]
    v_mfma_f32_32x32x16_bf16 v[48:63], v[180:183], a[52:55], v[48:63]
    ds_read_b128 v[180:183], v209 offset:24576
    s_waitcnt lgkmcnt(3)
    v_mfma_f32_32x32x16_bf16 v[16:31], v[184:187], a[24:27], v[16:31]
    v_mfma_f32_32x32x16_bf16 v[48:63], v[184:187], a[56:59], v[48:63]
    ds_read_b128 v[184:187], v210 offset:24576
    s_waitcnt lgkmcnt(3)
    v_mfma_f32_32x32x16_bf16 v[16:31], v[188:191], a[28:31], v[16:31]
    v_mfma_f32_32x32x16_bf16 v[48:63], v[188:191], a[60:63], v[48:63]
    ds_read_b128 v[188:191], v211 offset:24576
    s_waitcnt lgkmcnt(3)
    v_mfma_f32_32x32x16_bf16 v[32:47], v[176:179], a[0:3], 0
    v_mfma_f32_32x32x16_bf16 v[64:79], v[176:179], a[32:35], 0
    ds_read_b128 v[176:179], v212 offset:24576
    s_waitcnt lgkmcnt(3)
    v_mfma_f32_32x32x16_bf16 v[32:47], v[180:183], a[4:7], v[32:47]
    v_mfma_f32_32x32x16_bf16 v[64:79], v[180:183], a[36:39], v[64:79]
    ds_read_b128 v[180:183], v213 offset:24576
    s_waitcnt lgkmcnt(3)
    v_mfma_f32_32x32x16_bf16 v[32:47], v[184:187], a[8:11], v[32:47]
    v_mfma_f32_32x32x16_bf16 v[64:79], v[184:187], a[40:43], v[64:79]
    ds_read_b128 v[184:187], v214 offset:24576
    s_waitcnt lgkmcnt(3)
    v_mfma_f32_32x32x16_bf16 v[32:47], v[188:191], a[12:15], v[32:47]
    v_mfma_f32_32x32x16_bf16 v[64:79], v[188:191], a[44:47], v[64:79]
    ds_read_b128 v[188:191], v215 offset:24576
    s_waitcnt lgkmcnt(3)
    v_mfma_f32_32x32x16_bf16 v[32:47], v[176:179], a[16:19], v[32:47]
    v_mfma_f32_32x32x16_bf16 v[64:79], v[176:179], a[48:51], v[64:79]
    s_waitcnt lgkmcnt(2)
    v_mfma_f32_32x32x16_bf16 v[32:47], v[180:183], a[20:23], v[32:47]
    v_mfma_f32_32x32x16_bf16 v[64:79], v[180:183], a[52:55], v[64:79]
    s_waitcnt lgkmcnt(1)
    v_mfma_f32_32x32x16_bf16 v[32:47], v[184:187], a[24:27], v[32:47]
    v_mfma_f32_32x32x16_bf16 v[64:79], v[184:187], a[56:59], v[64:79]
    s_waitcnt lgkmcnt(0)
    v_mfma_f32_32x32x16_bf16 v[32:47], v[188:191], a[28:31], v[32:47]
    v_mfma_f32_32x32x16_bf16 v[64:79], v[188:191], a[60:63], v[64:79]
    v_max3_f32 v232, v16, v17, v18
    v_max3_f32 v233, v19, v20, v21
    v_max3_f32 v232, v232, v22, v23
    v_max3_f32 v233, v233, v24, v25
    v_max3_f32 v232, v232, v26, v27
    v_max3_f32 v233, v233, v28, v29
    v_max3_f32 v232, v232, v30, v31
    s_nop 3
    v_max3_f32 v233, v233, v32, v33
    v_max3_f32 v232, v232, v34, v35
    v_max3_f32 v233, v233, v36, v37
    v_max3_f32 v232, v232, v38, v39
    v_max3_f32 v233, v233, v40, v41
    v_max3_f32 v232, v232, v42, v43
    v_max3_f32 v233, v233, v44, v45
    v_max3_f32 v232, v232, v46, v47
    v_max_f32 v232, v232, v233
    v_mov_b32 v233, v232
    s_nop 1
    v_permlane32_swap_b32 v232, v233
    v_max3_f32 v232, v232, v233, v225
    v_sub_f32 v234, v232, v225
    v_max3_f32 v240, v48, v49, v50
    v_max3_f32 v241, v51, v52, v53
    v_max3_f32 v240, v240, v54, v55
    v_max3_f32 v241, v241, v56, v57
    v_max3_f32 v240, v240, v58, v59
    v_max3_f32 v241, v241, v60, v61
    v_max3_f32 v240, v240, v62, v63
    v_max3_f32 v241, v241, v64, v65
    v_max3_f32 v240, v240, v66, v67
    v_max3_f32 v241, v241, v68, v69
    v_max3_f32 v240, v240, v70, v71
    v_max3_f32 v241, v241, v72, v73
    v_max3_f32 v240, v240, v74, v75
    v_max3_f32 v241, v241, v76, v77
    v_max3_f32 v240, v240, v78, v79
    v_max_f32 v240, v240, v241
    v_mov_b32 v241, v240
    s_nop 1
    v_permlane32_swap_b32 v240, v241
    v_max3_f32 v240, v240, v241, v226
    v_sub_f32 v242, v240, v226
    v_max_f32 v234, v234, v242
    v_cmp_gt_f32 vcc, v234, s39
    s_nop 0
    s_cbranch_vccnz L_rare0
L_back0:
    s_mov_b32 s28, 0
    v_xor_b32 v208, 32768, v208
    v_xor_b32 v209, 32768, v209
    v_xor_b32 v210, 32768, v210
    v_xor_b32 v211, 32768, v211
    v_xor_b32 v212, 32768, v212
    v_xor_b32 v213, 32768, v213
    v_xor_b32 v214, 32768, v214
    v_xor_b32 v215, 32768, v215
    v_xor_b32 v216, 32768, v216
    v_xor_b32 v217, 32768, v217
    v_xor_b32 v218, 32768, v218
    v_xor_b32 v219, 32768, v219
    s_waitcnt vmcnt(4)
    s_barrier
    s_add_u32 s30, s30, 16384
    s_and_b32 s30, s30, 65535
    s_add_u32 s33, s30, s31
    s_add_u32 s29, s29, 16384
    s_sub_u32 s34, s29, 16384
    s_mov_b32 m0, s33
    s_nop 0
    buffer_load_dwordx4 v220, s[12:15], s29 offen offset:0 lds
    buffer_load_dwordx4 v221, s[12:15], s29 offen offset:1024 lds
    buffer_load_dwordx4 v222, s[12:15], s29 offen offset:2048 lds
    buffer_load_dwordx4 v223, s[12:15], s29 offen offset:3072 lds
    s_add_u32 s35, s33, 65536
    s_mov_b32 m0, s35
    s_nop 0
    buffer_load_dwordx4 v224, s[16:19], s34 offen offset:0 lds
    buffer_load_dwordx4 v224, s[16:19], s34 offen offset:1024 lds
    buffer_load_dwordx4 v224, s[16:19], s34 offen offset:2048 lds
    buffer_load_dwordx4 v224, s[16:19], s34 offen offset:3072 lds
L_loop:
    ds_read_b128 v[176:179], v208 offset:0
    ds_read_b128 v[180:183], v209 offset:0
    ds_read_b128 v[184:187], v210 offset:0
    ds_read_b128 v[188:191], v211 offset:0
    s_waitcnt lgkmcnt(3)
    v_mfma_f32_32x32x16_bf16 v[80:95], v[176:179], a[0:3], 0
    v_fma_f32 v16, v16, s32, -v229
    v_fma_f32 v17, v17, s32, -v229
    v_exp_f32 v16, v16
    v_exp_f32 v17, v17
    v_add_f32 v227, v227, v16
    v_mfma_f32_32x32x16_bf16 v[112:127], v[176:179], a[32:35], 0
    v_add_f32 v227, v227, v17
    v_cvt_pk_bf16_f32 v144, v16, v17
    v_fma_f32 v18, v18, s32, -v229
    v_fma_f32 v19, v19, s32, -v229
    v_exp_f32 v18, v18
    ds_read_b128 v[176:179], v212 offset:0
    s_waitcnt lgkmcnt(3)
    v_mfma_f32_32x32x16_bf16 v[80:95], v[180:183], a[4:7], v[80:95]
    v_exp_f32 v19, v19
    v_add_f32 v227, v227, v18
    v_add_f32 v227, v227, v19
    v_cvt_pk_bf16_f32 v145, v18, v19
    v_fma_f32 v20, v20, s32, -v229
    v_mfma_f32_32x32x16_bf16 v[112:127], v[180:183], a[36:39], v[112:127]
    v_fma_f32 v21, v21, s32, -v229
    v_exp_f32 v20, v20
    v_exp_f32 v21, v21
    v_add_f32 v227, v227, v20
    v_add_f32 v227, v227, v21
    v_cvt_pk_bf16_f32 v146, v20, v21
    ds_read_b128 v[180:183], v213 offset:0
    s_waitcnt lgkmcnt(3)
    v_mfma_f32_32x32x16_bf16 v[80:95], v[184:187], a[8:11], v[80:95]
    v_fma_f32 v22, v22, s32, -v229
    v_fma_f32 v23, v23, s32, -v229
    v_exp_f32 v22, v22
    v_exp_f32 v23, v23
    v_add_f32 v227, v227, v22
    v_mfma_f32_32x32x16_bf16 v[112:127], v[184:187], a[40:43], v[112:127]
    v_add_f32 v227, v227, v23
    v_cvt_pk_bf16_f32 v147, v22, v23
    v_fma_f32 v48, v48, s32, -v230
    v_fma_f32 v49, v49, s32, -v230
    v_exp_f32 v48, v48
    ds_read_b128 v[184:187], v214 offset:0
    s_waitcnt lgkmcnt(3)
    v_mfma_f32_32x32x16_bf16 v[80:95], v[188:191], a[12:15], v[80:95]
    v_exp_f32 v49, v49
    v_add_f32 v228, v228, v48
    v_add_f32 v228, v228, v49
    v_cvt_pk_bf16_f32 v160, v48, v49
    v_fma_f32 v50, v50, s32, -v230
    v_mfma_f32_32x32x16_bf16 v[112:127], v[188:191], a[44:47], v[112:127]
    v_fma_f32 v51, v51, s32, -v230
    v_exp_f32 v50, v50
    v_exp_f32 v51, v51
    v_add_f32 v228, v228, v50
    v_add_f32 v228, v228, v51
    v_cvt_pk_bf16_f32 v161, v50, v51
    ds_read_b128 v[188:191], v215 offset:0
    s_waitcnt lgkmcnt(3)
    v_mfma_f32_32x32x16_bf16 v[80:95], v[176:179], a[16:19], v[80:95]
    v_fma_f32 v52, v52, s32, -v230
    v_fma_f32 v53, v53, s32, -v230
    v_exp_f32 v52, v52
    v_exp_f32 v53, v53
    v_add_f32 v228, v228, v52
    v_mfma_f32_32x32x16_bf16 v[112:127], v[176:179], a[48:51], v[112:127]
    v_add_f32 v228, v228, v53
    v_cvt_pk_bf16_f32 v162, v52, v53
    v_fma_f32 v54, v54, s32, -v230
    v_fma_f32 v55, v55, s32, -v230
    v_exp_f32 v54, v54
    ds_read_b128 v[176:179], v208 offset:8192
    s_waitcnt lgkmcnt(3)
    v_mfma_f32_32x32x16_bf16 v[80:95], v[180:183], a[20:23], v[80:95]
    v_exp_f32 v55, v55
    v_add_f32 v228, v228, v54
    v_add_f32 v228, v228, v55
    v_cvt_pk_bf16_f32 v163, v54, v55
    v_fma_f32 v24, v24, s32, -v229
    v_mfma_f32_32x32x16_bf16 v[112:127], v[180:183], a[52:55], v[112:127]
    v_fma_f32 v25, v25, s32, -v229
    v_exp_f32 v24, v24
    v_exp_f32 v25, v25
    v_add_f32 v227, v227, v24
    v_add_f32 v227, v227, v25
    v_cvt_pk_bf16_f32 v148, v24, v25
    ds_read_b128 v[180:183], v209 offset:8192
    s_waitcnt lgkmcnt(3)
    v_mfma_f32_32x32x16_bf16 v[80:95], v[184:187], a[24:27], v[80:95]
    v_fma_f32 v26, v26, s32, -v229
    v_fma_f32 v27, v27, s32, -v229
    v_exp_f32 v26, v26
    v_exp_f32 v27, v27
    v_add_f32 v227, v227, v26
    v_mfma_f32_32x32x16_bf16 v[112:127], v[184:187], a[56:59], v[112:127]
    v_add_f32 v227, v227, v27
    v_cvt_pk_bf16_f32 v149, v26, v27
    v_fma_f32 v28, v28, s32, -v229
    v_fma_f32 v29, v29, s32, -v229
    v_exp_f32 v28, v28
    ds_read_b128 v[184:187], v210 offset:8192
    s_waitcnt lgkmcnt(3)
    v_mfma_f32_32x32x16_bf16 v[80:95], v[188:191], a[28:31], v[80:95]
    v_exp_f32 v29, v29
    v_add_f32 v227, v227, v28
    v_add_f32 v227, v227, v29
    v_cvt_pk_bf16_f32 v150, v28, v29
    v_fma_f32 v30, v30, s32, -v229
    v_mfma_f32_32x32x16_bf16 v[112:127], v[188:191], a[60:63], v[112:127]
    v_fma_f32 v31, v31, s32, -v229
    v_exp_f32 v30, v30
    v_exp_f32 v31, v31
    v_add_f32 v227, v227, v30
    v_add_f32 v227, v227, v31
    v_cvt_pk_bf16_f32 v151, v30, v31
    ds_read_b128 v[188:191], v211 offset:8192
    s_waitcnt lgkmcnt(3)
    v_mfma_f32_32x32x16_bf16 v[96:111], v[176:179], a[0:3], 0
    v_fma_f32 v56, v56, s32, -v230
    v_fma_f32 v57, v57, s32, -v230
    v_exp_f32 v56, v56
    v_exp_f32 v57, v57
    v_add_f32 v228, v228, v56
    v_mfma_f32_32x32x16_bf16 v[128:143], v[176:179], a[32:35], 0
    v_add_f32 v228, v228, v57
    v_cvt_pk_bf16_f32 v164, v56, v57
    v_fma_f32 v58, v58, s32, -v230
    v_fma_f32 v59, v59, s32, -v230
    v_exp_f32 v58, v58
    ds_read_b128 v[176:179], v212 offset:8192
    s_waitcnt lgkmcnt(3)
    v_mfma_f32_32x32x16_bf16 v[96:111], v[180:183], a[4:7], v[96:111]
    v_exp_f32 v59, v59
    v_add_f32 v228, v228, v58
    v_add_f32 v228, v228, v59
    v_cvt_pk_bf16_f32 v165, v58, v59
    v_fma_f32 v60, v60, s32, -v230
    v_mfma_f32_32x32x16_bf16 v[128:143], v[180:183], a[36:39], v[128:143]
    v_fma_f32 v61, v61, s32, -v230
    v_exp_f32 v60, v60
    v_exp_f32 v61, v61
    v_add_f32 v228, v228, v60
    v_add_f32 v228, v228, v61
    v_cvt_pk_bf16_f32 v166, v60, v61
    ds_read_b128 v[180:183], v213 offset:8192
    s_waitcnt lgkmcnt(3)
    v_mfma_f32_32x32x16_bf16 v[96:111], v[184:187], a[8:11], v[96:111]
    v_fma_f32 v62, v62, s32, -v230
    v_fma_f32 v63, v63, s32, -v230
    v_exp_f32 v62, v62
    v_exp_f32 v63, v63
    v_add_f32 v228, v228, v62
    v_mfma_f32_32x32x16_bf16 v[128:143], v[184:187], a[40:43], v[128:143]
    v_add_f32 v228, v228, v63
    v_cvt_pk_bf16_f32 v167, v62, v63
    v_fma_f32 v32, v32, s32, -v229
    v_fma_f32 v33, v33, s32, -v229
    v_exp_f32 v32, v32
    ds_read_b128 v[184:187], v214 offset:8192
    s_waitcnt lgkmcnt(3)
    v_mfma_f32_32x32x16_bf16 v[96:111], v[188:191], a[12:15], v[96:111]
    v_exp_f32 v33, v33
    v_add_f32 v227, v227, v32
    v_add_f32 v227, v227, v33
    v_cvt_pk_bf16_f32 v152, v32, v33
    v_fma_f32 v34, v34, s32, -v229
    v_mfma_f32_32x32x16_bf16 v[128:143], v[188:191], a[44:47], v[128:143]
    v_fma_f32 v35, v35, s32, -v229
    v_exp_f32 v34, v34
    v_exp_f32 v35, v35
    v_add_f32 v227, v227, v34
    v_add_f32 v227, v227, v35
    v_cvt_pk_bf16_f32 v153, v34, v35
    ds_read_b128 v[188:191], v215 offset:8192
    s_waitcnt lgkmcnt(3)
    v_mfma_f32_32x32x16_bf16 v[96:111], v[176:179], a[16:19], v[96:111]
    v_fma_f32 v36, v36, s32, -v229
    v_fma_f32 v37, v37, s32, -v229
    v_exp_f32 v36, v36
    v_exp_f32 v37, v37
    v_add_f32 v227, v227, v36
    v_mfma_f32_32x32x16_bf16 v[128:143], v[176:179], a[48:51], v[128:143]
    v_add_f32 v227, v227, v37
    v_cvt_pk_bf16_f32 v154, v36, v37
    v_fma_f32 v38, v38, s32, -v229
    v_fma_f32 v39, v39, s32, -v229
    v_exp_f32 v38, v38
    s_waitcnt lgkmcnt(2)
    v_mfma_f32_32x32x16_bf16 v[96:111], v[180:183], a[20:23], v[96:111]
    v_exp_f32 v39, v39
    v_add_f32 v227, v227, v38
    v_add_f32 v227, v227, v39
    v_cvt_pk_bf16_f32 v155, v38, v39
    v_fma_f32 v64, v64, s32, -v230
    v_mfma_f32_32x32x16_bf16 v[128:143], v[180:183], a[52:55], v[128:143]
    v_fma_f32 v65, v65, s32, -v230
    v_exp_f32 v64, v64
    v_exp_f32 v65, v65
    v_add_f32 v228, v228, v64
    v_add_f32 v228, v228, v65
    v_cvt_pk_bf16_f32 v168, v64, v65
    s_waitcnt lgkmcnt(1)
    v_mfma_f32_32x32x16_bf16 v[96:111], v[184:187], a[24:27], v[96:111]
    v_fma_f32 v66, v66, s32, -v230
    v_fma_f32 v67, v67, s32, -v230
    v_exp_f32 v66, v66
    v_exp_f32 v67, v67
    v_add_f32 v228, v228, v66
    v_mfma_f32_32x32x16_bf16 v[128:143], v[184:187], a[56:59], v[128:143]
    v_add_f32 v228, v228, v67
    v_cvt_pk_bf16_f32 v169, v66, v67
    v_fma_f32 v68, v68, s32, -v230
    v_fma_f32 v69, v69, s32, -v230
    v_exp_f32 v68, v68
    s_waitcnt lgkmcnt(0)
    v_mfma_f32_32x32x16_bf16 v[96:111], v[188:191], a[28:31], v[96:111]
    v_exp_f32 v69, v69
    v_add_f32 v228, v228, v68
    v_add_f32 v228, v228, v69
    v_cvt_pk_bf16_f32 v170, v68, v69
    v_fma_f32 v70, v70, s32, -v230
    v_mfma_f32_32x32x16_bf16 v[128:143], v[188:191], a[60:63], v[128:143]
    v_fma_f32 v71, v71, s32, -v230
    v_exp_f32 v70, v70
    v_exp_f32 v71, v71
    v_add_f32 v228, v228, v70
    v_add_f32 v228, v228, v71
    v_cvt_pk_bf16_f32 v171, v70, v71
    ds_read_b64_tr_b16 v[192:193], v216 offset:0
    ds_read_b64_tr_b16 v[194:195], v216 offset:2048
    ds_read_b64_tr_b16 v[196:197], v217 offset:0
    ds_read_b64_tr_b16 v[198:199], v217 offset:2048
    ds_read_b64_tr_b16 v[200:201], v218 offset:0
    ds_read_b64_tr_b16 v[202:203], v218 offset:2048
    ds_read_b64_tr_b16 v[204:205], v219 offset:0
    ds_read_b64_tr_b16 v[206:207], v219 offset:2048
    s_waitcnt lgkmcnt(6)
    v_mfma_f32_32x32x16_bf16 a[64:79], v[192:195], v[144:147], a[64:79]
    v_fma_f32 v40, v40, s32, -v229
    v_fma_f32 v41, v41, s32, -v229
    v_mfma_f32_32x32x16_bf16 a[128:143], v[192:195], v[160:163], a[128:143]
    v_exp_f32 v40, v40
    v_exp_f32 v41, v41
    v_add_f32 v227, v227, v40
    ds_read_b64_tr_b16 v[192:193], v216 offset:4096
    ds_read_b64_tr_b16 v[194:195], v216 offset:6144
    s_waitcnt lgkmcnt(6)
    v_mfma_f32_32x32x16_bf16 a[80:95], v[196:199], v[144:147], a[80:95]
    v_add_f32 v227, v227, v41
    v_cvt_pk_bf16_f32 v156, v40, v41
    v_fma_f32 v42, v42, s32, -v229
    v_mfma_f32_32x32x16_bf16 a[144:159], v[196:199], v[160:163], a[144:159]
    v_fma_f32 v43, v43, s32, -v229
    v_exp_f32 v42, v42
    v_exp_f32 v43, v43
    ds_read_b64_tr_b16 v[196:197], v217 offset:4096
    ds_read_b64_tr_b16 v[198:199], v217 offset:6144
    s_waitcnt lgkmcnt(6)
    v_mfma_f32_32x32x16_bf16 a[96:111], v[200:203], v[144:147], a[96:111]
    v_add_f32 v227, v227, v42
    v_add_f32 v227, v227, v43
    v_cvt_pk_bf16_f32 v157, v42, v43
    v_mfma_f32_32x32x16_bf16 a[160:175], v[200:203], v[160:163], a[160:175]
    v_fma_f32 v44, v44, s32, -v229
    v_fma_f32 v45, v45, s32, -v229
    ds_read_b64_tr_b16 v[200:201], v218 offset:4096
    ds_read_b64_tr_b16 v[202:203], v218 offset:6144
    s_waitcnt lgkmcnt(6)
    v_mfma_f32_32x32x16_bf16 a[112:127], v[204:207], v[144:147], a[112:127]
    v_exp_f32 v44, v44
    v_exp_f32 v45, v45
    v_add_f32 v227, v227, v44
    v_mfma_f32_32x32x16_bf16 a[176:191], v[204:207], v[160:163], a[176:191]
    v_add_f32 v227, v227, v45
    v_cvt_pk_bf16_f32 v158, v44, v45
    v_fma_f32 v46, v46, s32, -v229
    ds_read_b64_tr_b16 v[204:205], v219 offset:4096
    ds_read_b64_tr_b16 v[206:207], v219 offset:6144
    s_waitcnt lgkmcnt(6)
    v_mfma_f32_32x32x16_bf16 a[64:79], v[192:195], v[148:151], a[64:79]
    v_fma_f32 v47, v47, s32, -v229
    v_exp_f32 v46, v46
    v_exp_f32 v47, v47
    v_mfma_f32_32x32x16_bf16 a[128:143], v[192:195], v[164:167], a[128:143]
    v_add_f32 v227, v227, v46
    v_add_f32 v227, v227, v47
    v_cvt_pk_bf16_f32 v159, v46, v47
    ds_read_b64_tr_b16 v[192:193], v216 offset:8192
    ds_read_b64_tr_b16 v[194:195], v216 offset:10240
    s_waitcnt lgkmcnt(6)
    v_mfma_f32_32x32x16_bf16 a[80:95], v[196:199], v[148:151], a[80:95]
    v_fma_f32 v72, v72, s32, -v230
    v_fma_f32 v73, v73, s32, -v230
    v_mfma_f32_32x32x16_bf16 a[144:159], v[196:199], v[164:167], a[144:159]
    v_exp_f32 v72, v72
    v_exp_f32 v73, v73
    v_add_f32 v228, v228, v72
    ds_read_b64_tr_b16 v[196:197], v217 offset:8192
    ds_read_b64_tr_b16 v[198:199], v217 offset:10240
    s_waitcnt lgkmcnt(6)
    v_mfma_f32_32x32x16_bf16 a[96:111], v[200:203], v[148:151], a[96:111]
    v_add_f32 v228, v228, v73
    v_cvt_pk_bf16_f32 v172, v72, v73
    v_fma_f32 v74, v74, s32, -v230
    v_mfma_f32_32x32x16_bf16 a[160:175], v[200:203], v[164:167], a[160:175]
    v_fma_f32 v75, v75, s32, -v230
    v_exp_f32 v74, v74
    v_exp_f32 v75, v75
    ds_read_b64_tr_b16 v[200:201], v218 offset:8192
    ds_read_b64_tr_b16 v[202:203], v218 offset:10240
    s_waitcnt lgkmcnt(6)
    v_mfma_f32_32x32x16_bf16 a[112:127], v[204:207], v[148:151], a[112:127]
    v_add_f32 v228, v228, v74
    v_add_f32 v228, v228, v75
    v_cvt_pk_bf16_f32 v173, v74, v75
    v_mfma_f32_32x32x16_bf16 a[176:191], v[204:207], v[164:167], a[176:191]
    v_fma_f32 v76, v76, s32, -v230
    v_fma_f32 v77, v77, s32, -v230
    ds_read_b64_tr_b16 v[204:205], v219 offset:8192
    ds_read_b64_tr_b16 v[206:207], v219 offset:10240
    s_waitcnt lgkmcnt(6)
    v_mfma_f32_32x32x16_bf16 a[64:79], v[192:195], v[152:155], a[64:79]
    v_exp_f32 v76, v76
    v_exp_f32 v77, v77
    v_add_f32 v228, v228, v76
    v_mfma_f32_32x32x16_bf16 a[128:143], v[192:195], v[168:171], a[128:143]
    v_add_f32 v228, v228, v77
    v_cvt_pk_bf16_f32 v174, v76, v77
    v_fma_f32 v78, v78, s32, -v230
    ds_read_b64_tr_b16 v[192:193], v216 offset:12288
    ds_read_b64_tr_b16 v[194:195], v216 offset:14336
    s_waitcnt lgkmcnt(6)
    v_mfma_f32_32x32x16_bf16 a[80:95], v[196:199], v[152:155], a[80:95]
    v_fma_f32 v79, v79, s32, -v230
    v_exp_f32 v78, v78
    v_exp_f32 v79, v79
    v_mfma_f32_32x32x16_bf16 a[144:159], v[196:199], v[168:171], a[144:159]
    v_add_f32 v228, v228, v78
    v_add_f32 v228, v228, v79
    v_cvt_pk_bf16_f32 v175, v78, v79
    ds_read_b64_tr_b16 v[196:197], v217 offset:12288
    ds_read_b64_tr_b16 v[198:199], v217 offset:14336
    s_waitcnt lgkmcnt(6)
    v_mfma_f32_32x32x16_bf16 a[96:111], v[200:203], v[152:155], a[96:111]
    v_max3_f32 v232, v80, v81, v82
    v_max3_f32 v233, v83, v84, v85
    v_max3_f32 v232, v232, v86, v87
    v_mfma_f32_32x32x16_bf16 a[160:175], v[200:203], v[168:171], a[160:175]
    v_max3_f32 v233, v233, v88, v89
    v_max3_f32 v232, v232, v90, v91
    v_max3_f32 v233, v233, v92, v93
    v_max3_f32 v232, v232, v94, v95
    ds_read_b64_tr_b16 v[200:201], v218 offset:12288
    ds_read_b64_tr_b16 v[202:203], v218 offset:14336
    s_waitcnt lgkmcnt(6)
    v_mfma_f32_32x32x16_bf16 a[112:127], v[204:207], v[152:155], a[112:127]
    v_max3_f32 v233, v233, v96, v97
    v_max3_f32 v232, v232, v98, v99
    v_max3_f32 v233, v233, v100, v101
    v_mfma_f32_32x32x16_bf16 a[176:191], v[204:207], v[168:171], a[176:191]
    v_max3_f32 v232, v232, v102, v103
    v_max3_f32 v233, v233, v104, v105
    v_max3_f32 v232, v232, v106, v107
    v_max3_f32 v233, v233, v108, v109
    ds_read_b64_tr_b16 v[204:205], v219 offset:12288
    ds_read_b64_tr_b16 v[206:207], v219 offset:14336
    s_waitcnt lgkmcnt(6)
    v_mfma_f32_32x32x16_bf16 a[64:79], v[192:195], v[156:159], a[64:79]
    v_max3_f32 v232, v232, v110, v111
    v_max_f32 v232, v232, v233
    v_mov_b32 v233, v232
    v_mfma_f32_32x32x16_bf16 a[128:143], v[192:195], v[172:175], a[128:143]
    s_nop 0
    v_permlane32_swap_b32 v232, v233
    v_max3_f32 v232, v232, v233, v225
    v_sub_f32 v234, v232, v225
    v_max3_f32 v240, v112, v113, v114
    s_waitcnt lgkmcnt(4)
    v_mfma_f32_32x32x16_bf16 a[80:95], v[196:199], v[156:159], a[80:95]
    v_max3_f32 v241, v115, v116, v117
    v_max3_f32 v240, v240, v118, v119
    v_max3_f32 v241, v241, v120, v121
    v_mfma_f32_32x32x16_bf16 a[144:159], v[196:199], v[172:175], a[144:159]
    v_max3_f32 v240, v240, v122, v123
    v_max3_f32 v241, v241, v124, v125
    v_max3_f32 v240, v240, v126, v127
    v_max3_f32 v241, v241, v128, v129
    s_waitcnt lgkmcnt(2)
    v_mfma_f32_32x32x16_bf16 a[96:111], v[200:203], v[156:159], a[96:111]
    v_max3_f32 v240, v240, v130, v131
    v_max3_f32 v241, v241, v132, v133
    v_max3_f32 v240, v240, v134, v135
    v_mfma_f32_32x32x16_bf16 a[160:175], v[200:203], v[172:175], a[160:175]
    v_max3_f32 v241, v241, v136, v137
    v_max3_f32 v240, v240, v138, v139
    v_max3_f32 v241, v241, v140, v141
    v_max3_f32 v240, v240, v142, v143
    s_waitcnt lgkmcnt(0)
    v_mfma_f32_32x32x16_bf16 a[112:127], v[204:207], v[156:159], a[112:127]
    v_max_f32 v240, v240, v241
    v_mov_b32 v241, v240
    s_nop 1
    v_permlane32_swap_b32 v240, v241
    v_mfma_f32_32x32x16_bf16 a[176:191], v[204:207], v[172:175], a[176:191]
    v_max3_f32 v240, v240, v241, v226
    v_sub_f32 v242, v240, v226
    v_max_f32 v234, v234, v242
    v_cmp_gt_f32 vcc, v234, s39
    s_nop 0
    s_cbranch_vccnz L_rare1
L_back1:
    s_waitcnt vmcnt(16)
    s_barrier
    s_add_u32 s30, s30, 16384
    s_and_b32 s30, s30, 65535
    s_add_u32 s33, s30, s31
    s_add_u32 s29, s29, 16384
    s_sub_u32 s34, s29, 16384
    s_mov_b32 m0, s33
    s_nop 0
    buffer_load_dwordx4 v220, s[12:15], s29 offen offset:0 lds
    buffer_load_dwordx4 v221, s[12:15], s29 offen offset:1024 lds
    buffer_load_dwordx4 v222, s[12:15], s29 offen offset:2048 lds
    buffer_load_dwordx4 v223, s[12:15], s29 offen offset:3072 lds
    s_add_u32 s35, s33, 65536
    s_mov_b32 m0, s35
    s_nop 0
    buffer_load_dwordx4 v224, s[16:19], s34 offen offset:0 lds
    buffer_load_dwordx4 v224, s[16:19], s34 offen offset:1024 lds
    buffer_load_dwordx4 v224, s[16:19], s34 offen offset:2048 lds
    buffer_load_dwordx4 v224, s[16:19], s34 offen offset:3072 lds
    ds_read_b128 v[176:179], v208 offset:16384
    ds_read_b128 v[180:183], v209 offset:16384
    ds_read_b128 v[184:187], v210 offset:16384
    ds_read_b128 v[188:191], v211 offset:16384
    s_waitcnt lgkmcnt(3)
    v_mfma_f32_32x32x16_bf16 v[16:31], v[176:179], a[0:3], 0
    v_fma_f32 v80, v80, s32, -v229
    v_fma_f32 v81, v81, s32, -v229
    v_exp_f32 v80, v80
    v_exp_f32 v81, v81
    v_add_f32 v227, v227, v80
    v_mfma_f32_32x32x16_bf16 v[48:63], v[176:179], a[32:35], 0
    v_add_f32 v227, v227, v81
    v_cvt_pk_bf16_f32 v144, v80, v81
    v_fma_f32 v82, v82, s32, -v229
    v_fma_f32 v83, v83, s32, -v229
    v_exp_f32 v82, v82
    ds_read_b128 v[176:179], v212 offset:16384
    s_waitcnt lgkmcnt(3)
    v_mfma_f32_32x32x16_bf16 v[16:31], v[180:183], a[4:7], v[16:31]
    v_exp_f32 v83, v83
    v_add_f32 v227, v227, v82
    v_add_f32 v227, v227, v83
    v_cvt_pk_bf16_f32 v145, v82, v83
    v_fma_f32 v84, v84, s32, -v229
    v_mfma_f32_32x32x16_bf16 v[48:63], v[180:183], a[36:39], v[48:63]
    v_fma_f32 v85, v85, s32, -v229
    v_exp_f32 v84, v84
    v_exp_f32 v85, v85
    v_add_f32 v227, v227, v84
    v_add_f32 v227, v227, v85
    v_cvt_pk_bf16_f32 v146, v84, v85
    ds_read_b128 v[180:183], v213 offset:16384
    s_waitcnt lgkmcnt(3)
    v_mfma_f32_32x32x16_bf16 v[16:31], v[184:187], a[8:11], v[16:31]
    v_fma_f32 v86, v86, s32, -v229
    v_fma_f32 v87, v87, s32, -v229
    v_exp_f32 v86, v86
    v_exp_f32 v87, v87
    v_add_f32 v227, v227, v86
    v_mfma_f32_32x32x16_bf16 v[48:63], v[184:187], a[40:43], v[48:63]
    v_add_f32 v227, v227, v87
    v_cvt_pk_bf16_f32 v147, v86, v87
    v_fma_f32 v112, v112, s32, -v230
    v_fma_f32 v113, v113, s32, -v230
    v_exp_f32 v112, v112
    ds_read_b128 v[184:187], v214 offset:16384
    s_waitcnt lgkmcnt(3)
    v_mfma_f32_32x32x16_bf16 v[16:31], v[188:191], a[12:15], v[16:31]
    v_exp_f32 v113, v113
    v_add_f32 v228, v228, v112
    v_add_f32 v228, v228, v113
    v_cvt_pk_bf16_f32 v160, v112, v113
    v_fma_f32 v114, v114, s32, -v230
    v_mfma_f32_32x32x16_bf16 v[48:63], v[188:191], a[44:47], v[48:63]
    v_fma_f32 v115, v115, s32, -v230
    v_exp_f32 v114, v114
    v_exp_f32 v115, v115
    v_add_f32 v228, v228, v114
    v_add_f32 v228, v228, v115
    v_cvt_pk_bf16_f32 v161, v114, v115
    ds_read_b128 v[188:191], v215 offset:16384
    s_waitcnt lgkmcnt(3)
    v_mfma_f32_32x32x16_bf16 v[16:31], v[176:179], a[16:19], v[16:31]
    v_fma_f32 v116, v116, s32, -v230
    v_fma_f32 v117, v117, s32, -v230
    v_exp_f32 v116, v116
    v_exp_f32 v117, v117
    v_add_f32 v228, v228, v116
    v_mfma_f32_32x32x16_bf16 v[48:63], v[176:179], a[48:51], v[48:63]
    v_add_f32 v228, v228, v117
    v_cvt_pk_bf16_f32 v162, v116, v117
    v_fma_f32 v118, v118, s32, -v230
    v_fma_f32 v119, v119, s32, -v230
    v_exp_f32 v118, v118
    ds_read_b128 v[176:179], v208 offset:24576
    s_waitcnt lgkmcnt(3)
    v_mfma_f32_32x32x16_bf16 v[16:31], v[180:183], a[20:23], v[16:31]
    v_exp_f32 v119, v119
    v_add_f32 v228, v228, v118
    v_add_f32 v228, v228, v119
    v_cvt_pk_bf16_f32 v163, v118, v119
    v_fma_f32 v88, v88, s32, -v229
    v_mfma_f32_32x32x16_bf16 v[48:63], v[180:183], a[52:55], v[48:63]
    v_fma_f32 v89, v89, s32, -v229
    v_exp_f32 v88, v88
    v_exp_f32 v89, v89
    v_add_f32 v227, v227, v88
    v_add_f32 v227, v227, v89
    v_cvt_pk_bf16_f32 v148, v88, v89
    ds_read_b128 v[180:183], v209 offset:24576
    s_waitcnt lgkmcnt(3)
    v_mfma_f32_32x32x16_bf16 v[16:31], v[184:187], a[24:27], v[16:31]
    v_fma_f32 v90, v90, s32, -v229
    v_fma_f32 v91, v91, s32, -v229
    v_exp_f32 v90, v90
    v_exp_f32 v91, v91
    v_add_f32 v227, v227, v90
    v_mfma_f32_32x32x16_bf16 v[48:63], v[184:187], a[56:59], v[48:63]
    v_add_f32 v227, v227, v91
    v_cvt_pk_bf16_f32 v149, v90, v91
    v_fma_f32 v92, v92, s32, -v229
    v_fma_f32 v93, v93, s32, -v229
    v_exp_f32 v92, v92
    ds_read_b128 v[184:187], v210 offset:24576
    s_waitcnt lgkmcnt(3)
    v_mfma_f32_32x32x16_bf16 v[16:31], v[188:191], a[28:31], v[16:31]
    v_exp_f32 v93, v93
    v_add_f32 v227, v227, v92
    v_add_f32 v227, v227, v93
    v_cvt_pk_bf16_f32 v150, v92, v93
    v_fma_f32 v94, v94, s32, -v229
    v_mfma_f32_32x32x16_bf16 v[48:63], v[188:191], a[60:63], v[48:63]
    v_fma_f32 v95, v95, s32, -v229
    v_exp_f32 v94, v94
    v_exp_f32 v95, v95
    v_add_f32 v227, v227, v94
    v_add_f32 v227, v227, v95
    v_cvt_pk_bf16_f32 v151, v94, v95
    ds_read_b128 v[188:191], v211 offset:24576
    s_waitcnt lgkmcnt(3)
    v_mfma_f32_32x32x16_bf16 v[32:47], v[176:179], a[0:3], 0
    v_fma_f32 v120, v120, s32, -v230
    v_fma_f32 v121, v121, s32, -v230
    v_exp_f32 v120, v120
    v_exp_f32 v121, v121
    v_add_f32 v228, v228, v120
    v_mfma_f32_32x32x16_bf16 v[64:79], v[176:179], a[32:35], 0
    v_add_f32 v228, v228, v121
    v_cvt_pk_bf16_f32 v164, v120, v121
    v_fma_f32 v122, v122, s32, -v230
    v_fma_f32 v123, v123, s32, -v230
    v_exp_f32 v122, v122
    ds_read_b128 v[176:179], v212 offset:24576
    s_waitcnt lgkmcnt(3)
    v_mfma_f32_32x32x16_bf16 v[32:47], v[180:183], a[4:7], v[32:47]
    v_exp_f32 v123, v123
    v_add_f32 v228, v228, v122
    v_add_f32 v228, v228, v123
    v_cvt_pk_bf16_f32 v165, v122, v123
    v_fma_f32 v124, v124, s32, -v230
    v_mfma_f32_32x32x16_bf16 v[64:79], v[180:183], a[36:39], v[64:79]
    v_fma_f32 v125, v125, s32, -v230
    v_exp_f32 v124, v124
    v_exp_f32 v125, v125
    v_add_f32 v228, v228, v124
    v_add_f32 v228, v228, v125
    v_cvt_pk_bf16_f32 v166, v124, v125
    ds_read_b128 v[180:183], v213 offset:24576
    s_waitcnt lgkmcnt(3)
    v_mfma_f32_32x32x16_bf16 v[32:47], v[184:187], a[8:11], v[32:47]
    v_fma_f32 v126, v126, s32, -v230
    v_fma_f32 v127, v127, s32, -v230
    v_exp_f32 v126, v126
    v_exp_f32 v127, v127
    v_add_f32 v228, v228, v126
    v_mfma_f32_32x32x16_bf16 v[64:79], v[184:187], a[40:43], v[64:79]
    v_add_f32 v228, v228, v127
    v_cvt_pk_bf16_f32 v167, v126, v127
    v_fma_f32 v96, v96, s32, -v229
    v_fma_f32 v97, v97, s32, -v229
    v_exp_f32 v96, v96
    ds_read_b128 v[184:187], v214 offset:24576
    s_waitcnt lgkmcnt(3)
    v_mfma_f32_32x32x16_bf16 v[32:47], v[188:191], a[12:15], v[32:47]
    v_exp_f32 v97, v97
    v_add_f32 v227, v227, v96
    v_add_f32 v227, v227, v97
    v_cvt_pk_bf16_f32 v152, v96, v97
    v_fma_f32 v98, v98, s32, -v229
    v_mfma_f32_32x32x16_bf16 v[64:79], v[188:191], a[44:47], v[64:79]
    v_fma_f32 v99, v99, s32, -v229
    v_exp_f32 v98, v98
    v_exp_f32 v99, v99
    v_add_f32 v227, v227, v98
    v_add_f32 v227, v227, v99
    v_cvt_pk_bf16_f32 v153, v98, v99
    ds_read_b128 v[188:191], v215 offset:24576
    s_waitcnt lgkmcnt(3)
    v_mfma_f32_32x32x16_bf16 v[32:47], v[176:179], a[16:19], v[32:47]
    v_fma_f32 v100, v100, s32, -v229
    v_fma_f32 v101, v101, s32, -v229
    v_exp_f32 v100, v100
    v_exp_f32 v101, v101
    v_add_f32 v227, v227, v100
    v_mfma_f32_32x32x16_bf16 v[64:79], v[176:179], a[48:51], v[64:79]
    v_add_f32 v227, v227, v101
    v_cvt_pk_bf16_f32 v154, v100, v101
    v_fma_f32 v102, v102, s32, -v229
    v_fma_f32 v103, v103, s32, -v229
    v_exp_f32 v102, v102
    s_waitcnt lgkmcnt(2)
    v_mfma_f32_32x32x16_bf16 v[32:47], v[180:183], a[20:23], v[32:47]
    v_exp_f32 v103, v103
    v_add_f32 v227, v227, v102
    v_add_f32 v227, v227, v103
    v_cvt_pk_bf16_f32 v155, v102, v103
    v_fma_f32 v128, v128, s32, -v230
    v_mfma_f32_32x32x16_bf16 v[64:79], v[180:183], a[52:55], v[64:79]
    v_fma_f32 v129, v129, s32, -v230
    v_exp_f32 v128, v128
    v_exp_f32 v129, v129
    v_add_f32 v228, v228, v128
    v_add_f32 v228, v228, v129
    v_cvt_pk_bf16_f32 v168, v128, v129
    s_waitcnt lgkmcnt(1)
    v_mfma_f32_32x32x16_bf16 v[32:47], v[184:187], a[24:27], v[32:47]
    v_fma_f32 v130, v130, s32, -v230
    v_fma_f32 v131, v131, s32, -v230
    v_exp_f32 v130, v130
    v_exp_f32 v131, v131
    v_add_f32 v228, v228, v130
    v_mfma_f32_32x32x16_bf16 v[64:79], v[184:187], a[56:59], v[64:79]
    v_add_f32 v228, v228, v131
    v_cvt_pk_bf16_f32 v169, v130, v131
    v_fma_f32 v132, v132, s32, -v230
    v_fma_f32 v133, v133, s32, -v230
    v_exp_f32 v132, v132
    s_waitcnt lgkmcnt(0)
    v_mfma_f32_32x32x16_bf16 v[32:47], v[188:191], a[28:31], v[32:47]
    v_exp_f32 v133, v133
    v_add_f32 v228, v228, v132
    v_add_f32 v228, v228, v133
    v_cvt_pk_bf16_f32 v170, v132, v133
    v_fma_f32 v134, v134, s32, -v230
    v_mfma_f32_32x32x16_bf16 v[64:79], v[188:191], a[60:63], v[64:79]
    v_fma_f32 v135, v135, s32, -v230
    v_exp_f32 v134, v134
    v_exp_f32 v135, v135
    v_add_f32 v228, v228, v134
    v_add_f32 v228, v228, v135
    v_cvt_pk_bf16_f32 v171, v134, v135
    ds_read_b64_tr_b16 v[192:193], v216 offset:16384
    ds_read_b64_tr_b16 v[194:195], v216 offset:18432
    ds_read_b64_tr_b16 v[196:197], v217 offset:16384
    ds_read_b64_tr_b16 v[198:199], v217 offset:18432
    ds_read_b64_tr_b16 v[200:201], v218 offset:16384
    ds_read_b64_tr_b16 v[202:203], v218 offset:18432
    ds_read_b64_tr_b16 v[204:205], v219 offset:16384
    ds_read_b64_tr_b16 v[206:207], v219 offset:18432
    s_waitcnt lgkmcnt(6)
    v_mfma_f32_32x32x16_bf16 a[64:79], v[192:195], v[144:147], a[64:79]
    v_fma_f32 v104, v104, s32, -v229
    v_fma_f32 v105, v105, s32, -v229
    v_mfma_f32_32x32x16_bf16 a[128:143], v[192:195], v[160:163], a[128:143]
    v_exp_f32 v104, v104
    v_exp_f32 v105, v105
    v_add_f32 v227, v227, v104
    ds_read_b64_tr_b16 v[192:193], v216 offset:20480
    ds_read_b64_tr_b16 v[194:195], v216 offset:22528
    s_waitcnt lgkmcnt(6)
    v_mfma_f32_32x32x16_bf16 a[80:95], v[196:199], v[144:147], a[80:95]
    v_add_f32 v227, v227, v105
    v_cvt_pk_bf16_f32 v156, v104, v105
    v_fma_f32 v106, v106, s32, -v229
    v_mfma_f32_32x32x16_bf16 a[144:159], v[196:199], v[160:163], a[144:159]
    v_fma_f32 v107, v107, s32, -v229
    v_exp_f32 v106, v106
    v_exp_f32 v107, v107
    ds_read_b64_tr_b16 v[196:197], v217 offset:20480
    ds_read_b64_tr_b16 v[198:199], v217 offset:22528
    s_waitcnt lgkmcnt(6)
    v_mfma_f32_32x32x16_bf16 a[96:111], v[200:203], v[144:147], a[96:111]
    v_add_f32 v227, v227, v106
    v_add_f32 v227, v227, v107
    v_cvt_pk_bf16_f32 v157, v106, v107
    v_mfma_f32_32x32x16_bf16 a[160:175], v[200:203], v[160:163], a[160:175]
    v_fma_f32 v108, v108, s32, -v229
    v_fma_f32 v109, v109, s32, -v229
    ds_read_b64_tr_b16 v[200:201], v218 offset:20480
    ds_read_b64_tr_b16 v[202:203], v218 offset:22528
    s_waitcnt lgkmcnt(6)
    v_mfma_f32_32x32x16_bf16 a[112:127], v[204:207], v[144:147], a[112:127]
    v_exp_f32 v108, v108
    v_exp_f32 v109, v109
    v_add_f32 v227, v227, v108
    v_mfma_f32_32x32x16_bf16 a[176:191], v[204:207], v[160:163], a[176:191]
    v_add_f32 v227, v227, v109
    v_cvt_pk_bf16_f32 v158, v108, v109
    v_fma_f32 v110, v110, s32, -v229
    ds_read_b64_tr_b16 v[204:205], v219 offset:20480
    ds_read_b64_tr_b16 v[206:207], v219 offset:22528
    s_waitcnt lgkmcnt(6)
    v_mfma_f32_32x32x16_bf16 a[64:79], v[192:195], v[148:151], a[64:79]
    v_fma_f32 v111, v111, s32, -v229
    v_exp_f32 v110, v110
    v_exp_f32 v111, v111
    v_mfma_f32_32x32x16_bf16 a[128:143], v[192:195], v[164:167], a[128:143]
    v_add_f32 v227, v227, v110
    v_add_f32 v227, v227, v111
    v_cvt_pk_bf16_f32 v159, v110, v111
    ds_read_b64_tr_b16 v[192:193], v216 offset:24576
    ds_read_b64_tr_b16 v[194:195], v216 offset:26624
    s_waitcnt lgkmcnt(6)
    v_mfma_f32_32x32x16_bf16 a[80:95], v[196:199], v[148:151], a[80:95]
    v_fma_f32 v136, v136, s32, -v230
    v_fma_f32 v137, v137, s32, -v230
    v_mfma_f32_32x32x16_bf16 a[144:159], v[196:199], v[164:167], a[144:159]
    v_exp_f32 v136, v136
    v_exp_f32 v137, v137
    v_add_f32 v228, v228, v136
    ds_read_b64_tr_b16 v[196:197], v217 offset:24576
    ds_read_b64_tr_b16 v[198:199], v217 offset:26624
    s_waitcnt lgkmcnt(6)
    v_mfma_f32_32x32x16_bf16 a[96:111], v[200:203], v[148:151], a[96:111]
    v_add_f32 v228, v228, v137
    v_cvt_pk_bf16_f32 v172, v136, v137
    v_fma_f32 v138, v138, s32, -v230
    v_mfma_f32_32x32x16_bf16 a[160:175], v[200:203], v[164:167], a[160:175]
    v_fma_f32 v139, v139, s32, -v230
    v_exp_f32 v138, v138
    v_exp_f32 v139, v139
    ds_read_b64_tr_b16 v[200:201], v218 offset:24576
    ds_read_b64_tr_b16 v[202:203], v218 offset:26624
    s_waitcnt lgkmcnt(6)
    v_mfma_f32_32x32x16_bf16 a[112:127], v[204:207], v[148:151], a[112:127]
    v_add_f32 v228, v228, v138
    v_add_f32 v228, v228, v139
    v_cvt_pk_bf16_f32 v173, v138, v139
    v_mfma_f32_32x32x16_bf16 a[176:191], v[204:207], v[164:167], a[176:191]
    v_fma_f32 v140, v140, s32, -v230
    v_fma_f32 v141, v141, s32, -v230
    ds_read_b64_tr_b16 v[204:205], v219 offset:24576
    ds_read_b64_tr_b16 v[206:207], v219 offset:26624
    s_waitcnt lgkmcnt(6)
    v_mfma_f32_32x32x16_bf16 a[64:79], v[192:195], v[152:155], a[64:79]
    v_exp_f32 v140, v140
    v_exp_f32 v141, v141
    v_add_f32 v228, v228, v140
    v_mfma_f32_32x32x16_bf16 a[128:143], v[192:195], v[168:171], a[128:143]
    v_add_f32 v228, v228, v141
    v_cvt_pk_bf16_f32 v174, v140, v141
    v_fma_f32 v142, v142, s32, -v230
    ds_read_b64_tr_b16 v[192:193], v216 offset:28672
    ds_read_b64_tr_b16 v[194:195], v216 offset:30720
    s_waitcnt lgkmcnt(6)
    v_mfma_f32_32x32x16_bf16 a[80:95], v[196:199], v[152:155], a[80:95]
    v_fma_f32 v143, v143, s32, -v230
    v_exp_f32 v142, v142
    v_exp_f32 v143, v143
    v_mfma_f32_32x32x16_bf16 a[144:159], v[196:199], v[168:171], a[144:159]
    v_add_f32 v228, v228, v142
    v_add_f32 v228, v228, v143
    v_cvt_pk_bf16_f32 v175, v142, v143
    ds_read_b64_tr_b16 v[196:197], v217 offset:28672
    ds_read_b64_tr_b16 v[198:199], v217 offset:30720
    s_waitcnt lgkmcnt(6)
    v_mfma_f32_32x32x16_bf16 a[96:111], v[200:203], v[152:155], a[96:111]
    v_max3_f32 v232, v16, v17, v18
    v_max3_f32 v233, v19, v20, v21
    v_max3_f32 v232, v232, v22, v23
    v_mfma_f32_32x32x16_bf16 a[160:175], v[200:203], v[168:171], a[160:175]
    v_max3_f32 v233, v233, v24, v25
    v_max3_f32 v232, v232, v26, v27
    v_max3_f32 v233, v233, v28, v29
    v_max3_f32 v232, v232, v30, v31
    ds_read_b64_tr_b16 v[200:201], v218 offset:28672
    ds_read_b64_tr_b16 v[202:203], v218 offset:30720
    s_waitcnt lgkmcnt(6)
    v_mfma_f32_32x32x16_bf16 a[112:127], v[204:207], v[152:155], a[112:127]
    v_max3_f32 v233, v233, v32, v33
    v_max3_f32 v232, v232, v34, v35
    v_max3_f32 v233, v233, v36, v37
    v_mfma_f32_32x32x16_bf16 a[176:191], v[204:207], v[168:171], a[176:191]
    v_max3_f32 v232, v232, v38, v39
    v_max3_f32 v233, v233, v40, v41
    v_max3_f32 v232, v232, v42, v43
    v_max3_f32 v233, v233, v44, v45
    ds_read_b64_tr_b16 v[204:205], v219 offset:28672
    ds_read_b64_tr_b16 v[206:207], v219 offset:30720
    s_waitcnt lgkmcnt(6)
    v_mfma_f32_32x32x16_bf16 a[64:79], v[192:195], v[156:159], a[64:79]
    v_max3_f32 v232, v232, v46, v47
    v_max_f32 v232, v232, v233
    v_mov_b32 v233, v232
    v_mfma_f32_32x32x16_bf16 a[128:143], v[192:195], v[172:175], a[128:143]
    s_nop 0
    v_permlane32_swap_b32 v232, v233
    v_max3_f32 v232, v232, v233, v225
    v_sub_f32 v234, v232, v225
    v_max3_f32 v240, v48, v49, v50
    s_waitcnt lgkmcnt(4)
    v_mfma_f32_32x32x16_bf16 a[80:95], v[196:199], v[156:159], a[80:95]
    v_max3_f32 v241, v51, v52, v53
    v_max3_f32 v240, v240, v54, v55
    v_max3_f32 v241, v241, v56, v57
    v_mfma_f32_32x32x16_bf16 a[144:159], v[196:199], v[172:175], a[144:159]
    v_max3_f32 v240, v240, v58, v59
    v_max3_f32 v241, v241, v60, v61
    v_max3_f32 v240, v240, v62, v63
    v_max3_f32 v241, v241, v64, v65
    s_waitcnt lgkmcnt(2)
    v_mfma_f32_32x32x16_bf16 a[96:111], v[200:203], v[156:159], a[96:111]
    v_max3_f32 v240, v240, v66, v67
    v_max3_f32 v241, v241, v68, v69
    v_max3_f32 v240, v240, v70, v71
    v_mfma_f32_32x32x16_bf16 a[160:175], v[200:203], v[172:175], a[160:175]
    v_max3_f32 v241, v241, v72, v73
    v_max3_f32 v240, v240, v74, v75
    v_max3_f32 v241, v241, v76, v77
    v_max3_f32 v240, v240, v78, v79
    s_waitcnt lgkmcnt(0)
    v_mfma_f32_32x32x16_bf16 a[112:127], v[204:207], v[156:159], a[112:127]
    v_max_f32 v240, v240, v241
    v_mov_b32 v241, v240
    s_nop 1
    v_permlane32_swap_b32 v240, v241
    v_mfma_f32_32x32x16_bf16 a[176:191], v[204:207], v[172:175], a[176:191]
    v_max3_f32 v240, v240, v241, v226
    v_sub_f32 v242, v240, v226
    v_max_f32 v234, v234, v242
    v_cmp_gt_f32 vcc, v234, s39
    s_nop 0
    s_cbranch_vccnz L_rare2
L_back2:
    v_xor_b32 v208, 32768, v208
    v_xor_b32 v209, 32768, v209
    v_xor_b32 v210, 32768, v210
    v_xor_b32 v211, 32768, v211
    v_xor_b32 v212, 32768, v212
    v_xor_b32 v213, 32768, v213
    v_xor_b32 v214, 32768, v214
    v_xor_b32 v215, 32768, v215
    v_xor_b32 v216, 32768, v216
    v_xor_b32 v217, 32768, v217
    v_xor_b32 v218, 32768, v218
    v_xor_b32 v219, 32768, v219
    s_waitcnt vmcnt(16)
    s_barrier
    s_add_u32 s30, s30, 16384
    s_and_b32 s30, s30, 65535
    s_add_u32 s33, s30, s31
    s_add_u32 s29, s29, 16384
    s_sub_u32 s34, s29, 16384
    s_mov_b32 m0, s33
    s_nop 0
    buffer_load_dwordx4 v220, s[12:15], s29 offen offset:0 lds
    buffer_load_dwordx4 v221, s[12:15], s29 offen offset:1024 lds
    buffer_load_dwordx4 v222, s[12:15], s29 offen offset:2048 lds
    buffer_load_dwordx4 v223, s[12:15], s29 offen offset:3072 lds
    s_add_u32 s35, s33, 65536
    s_mov_b32 m0, s35
    s_nop 0
    buffer_load_dwordx4 v224, s[16:19], s34 offen offset:0 lds
    buffer_load_dwordx4 v224, s[16:19], s34 offen offset:1024 lds
    buffer_load_dwordx4 v224, s[16:19], s34 offen offset:2048 lds
    buffer_load_dwordx4 v224, s[16:19], s34 offen offset:3072 lds
    s_add_u32 s28, s28, 1
    s_cmp_lt_u32 s28, 7
    s_cbranch_scc1 L_loop
    ds_read_b128 v[176:179], v208 offset:0
    ds_read_b128 v[180:183], v209 offset:0
    ds_read_b128 v[184:187], v210 offset:0
    ds_read_b128 v[188:191], v211 offset:0
    s_waitcnt lgkmcnt(3)
    v_mfma_f32_32x32x16_bf16 v[80:95], v[176:179], a[0:3], 0
    v_fma_f32 v16, v16, s32, -v229
    v_fma_f32 v17, v17, s32, -v229
    v_exp_f32 v16, v16
    v_exp_f32 v17, v17
    v_add_f32 v227, v227, v16
    v_mfma_f32_32x32x16_bf16 v[112:127], v[176:179], a[32:35], 0
    v_add_f32 v227, v227, v17
    v_cvt_pk_bf16_f32 v144, v16, v17
    v_fma_f32 v18, v18, s32, -v229
    v_fma_f32 v19, v19, s32, -v229
    v_exp_f32 v18, v18
    ds_read_b128 v[176:179], v212 offset:0
    s_waitcnt lgkmcnt(3)
    v_mfma_f32_32x32x16_bf16 v[80:95], v[180:183], a[4:7], v[80:95]
    v_exp_f32 v19, v19
    v_add_f32 v227, v227, v18
    v_add_f32 v227, v227, v19
    v_cvt_pk_bf16_f32 v145, v18, v19
    v_fma_f32 v20, v20, s32, -v229
    v_mfma_f32_32x32x16_bf16 v[112:127], v[180:183], a[36:39], v[112:127]
    v_fma_f32 v21, v21, s32, -v229
    v_exp_f32 v20, v20
    v_exp_f32 v21, v21
    v_add_f32 v227, v227, v20
    v_add_f32 v227, v227, v21
    v_cvt_pk_bf16_f32 v146, v20, v21
    ds_read_b128 v[180:183], v213 offset:0
    s_waitcnt lgkmcnt(3)
    v_mfma_f32_32x32x16_bf16 v[80:95], v[184:187], a[8:11], v[80:95]
    v_fma_f32 v22, v22, s32, -v229
    v_fma_f32 v23, v23, s32, -v229
    v_exp_f32 v22, v22
    v_exp_f32 v23, v23
    v_add_f32 v227, v227, v22
    v_mfma_f32_32x32x16_bf16 v[112:127], v[184:187], a[40:43], v[112:127]
    v_add_f32 v227, v227, v23
    v_cvt_pk_bf16_f32 v147, v22, v23
    v_fma_f32 v48, v48, s32, -v230
    v_fma_f32 v49, v49, s32, -v230
    v_exp_f32 v48, v48
    ds_read_b128 v[184:187], v214 offset:0
    s_waitcnt lgkmcnt(3)
    v_mfma_f32_32x32x16_bf16 v[80:95], v[188:191], a[12:15], v[80:95]
    v_exp_f32 v49, v49
    v_add_f32 v228, v228, v48
    v_add_f32 v228, v228, v49
    v_cvt_pk_bf16_f32 v160, v48, v49
    v_fma_f32 v50, v50, s32, -v230
    v_mfma_f32_32x32x16_bf16 v[112:127], v[188:191], a[44:47], v[112:127]
    v_fma_f32 v51, v51, s32, -v230
    v_exp_f32 v50, v50
    v_exp_f32 v51, v51
    v_add_f32 v228, v228, v50
    v_add_f32 v228, v228, v51
    v_cvt_pk_bf16_f32 v161, v50, v51
    ds_read_b128 v[188:191], v215 offset:0
    s_waitcnt lgkmcnt(3)
    v_mfma_f32_32x32x16_bf16 v[80:95], v[176:179], a[16:19], v[80:95]
    v_fma_f32 v52, v52, s32, -v230
    v_fma_f32 v53, v53, s32, -v230
    v_exp_f32 v52, v52
    v_exp_f32 v53, v53
    v_add_f32 v228, v228, v52
    v_mfma_f32_32x32x16_bf16 v[112:127], v[176:179], a[48:51], v[112:127]
    v_add_f32 v228, v228, v53
    v_cvt_pk_bf16_f32 v162, v52, v53
    v_fma_f32 v54, v54, s32, -v230
    v_fma_f32 v55, v55, s32, -v230
    v_exp_f32 v54, v54
    ds_read_b128 v[176:179], v208 offset:8192
    s_waitcnt lgkmcnt(3)
    v_mfma_f32_32x32x16_bf16 v[80:95], v[180:183], a[20:23], v[80:95]
    v_exp_f32 v55, v55
    v_add_f32 v228, v228, v54
    v_add_f32 v228, v228, v55
    v_cvt_pk_bf16_f32 v163, v54, v55
    v_fma_f32 v24, v24, s32, -v229
    v_mfma_f32_32x32x16_bf16 v[112:127], v[180:183], a[52:55], v[112:127]
    v_fma_f32 v25, v25, s32, -v229
    v_exp_f32 v24, v24
    v_exp_f32 v25, v25
    v_add_f32 v227, v227, v24
    v_add_f32 v227, v227, v25
    v_cvt_pk_bf16_f32 v148, v24, v25
    ds_read_b128 v[180:183], v209 offset:8192
    s_waitcnt lgkmcnt(3)
    v_mfma_f32_32x32x16_bf16 v[80:95], v[184:187], a[24:27], v[80:95]
    v_fma_f32 v26, v26, s32, -v229
    v_fma_f32 v27, v27, s32, -v229
    v_exp_f32 v26, v26
    v_exp_f32 v27, v27
    v_add_f32 v227, v227, v26
    v_mfma_f32_32x32x16_bf16 v[112:127], v[184:187], a[56:59], v[112:127]
    v_add_f32 v227, v227, v27
    v_cvt_pk_bf16_f32 v149, v26, v27
    v_fma_f32 v28, v28, s32, -v229
    v_fma_f32 v29, v29, s32, -v229
    v_exp_f32 v28, v28
    ds_read_b128 v[184:187], v210 offset:8192
    s_waitcnt lgkmcnt(3)
    v_mfma_f32_32x32x16_bf16 v[80:95], v[188:191], a[28:31], v[80:95]
    v_exp_f32 v29, v29
    v_add_f32 v227, v227, v28
    v_add_f32 v227, v227, v29
    v_cvt_pk_bf16_f32 v150, v28, v29
    v_fma_f32 v30, v30, s32, -v229
    v_mfma_f32_32x32x16_bf16 v[112:127], v[188:191], a[60:63], v[112:127]
    v_fma_f32 v31, v31, s32, -v229
    v_exp_f32 v30, v30
    v_exp_f32 v31, v31
    v_add_f32 v227, v227, v30
    v_add_f32 v227, v227, v31
    v_cvt_pk_bf16_f32 v151, v30, v31
    ds_read_b128 v[188:191], v211 offset:8192
    s_waitcnt lgkmcnt(3)
    v_mfma_f32_32x32x16_bf16 v[96:111], v[176:179], a[0:3], 0
    v_fma_f32 v56, v56, s32, -v230
    v_fma_f32 v57, v57, s32, -v230
    v_exp_f32 v56, v56
    v_exp_f32 v57, v57
    v_add_f32 v228, v228, v56
    v_mfma_f32_32x32x16_bf16 v[128:143], v[176:179], a[32:35], 0
    v_add_f32 v228, v228, v57
    v_cvt_pk_bf16_f32 v164, v56, v57
    v_fma_f32 v58, v58, s32, -v230
    v_fma_f32 v59, v59, s32, -v230
    v_exp_f32 v58, v58
    ds_read_b128 v[176:179], v212 offset:8192
    s_waitcnt lgkmcnt(3)
    v_mfma_f32_32x32x16_bf16 v[96:111], v[180:183], a[4:7], v[96:111]
    v_exp_f32 v59, v59
    v_add_f32 v228, v228, v58
    v_add_f32 v228, v228, v59
    v_cvt_pk_bf16_f32 v165, v58, v59
    v_fma_f32 v60, v60, s32, -v230
    v_mfma_f32_32x32x16_bf16 v[128:143], v[180:183], a[36:39], v[128:143]
    v_fma_f32 v61, v61, s32, -v230
    v_exp_f32 v60, v60
    v_exp_f32 v61, v61
    v_add_f32 v228, v228, v60
    v_add_f32 v228, v228, v61
    v_cvt_pk_bf16_f32 v166, v60, v61
    ds_read_b128 v[180:183], v213 offset:8192
    s_waitcnt lgkmcnt(3)
    v_mfma_f32_32x32x16_bf16 v[96:111], v[184:187], a[8:11], v[96:111]
    v_fma_f32 v62, v62, s32, -v230
    v_fma_f32 v63, v63, s32, -v230
    v_exp_f32 v62, v62
    v_exp_f32 v63, v63
    v_add_f32 v228, v228, v62
    v_mfma_f32_32x32x16_bf16 v[128:143], v[184:187], a[40:43], v[128:143]
    v_add_f32 v228, v228, v63
    v_cvt_pk_bf16_f32 v167, v62, v63
    v_fma_f32 v32, v32, s32, -v229
    v_fma_f32 v33, v33, s32, -v229
    v_exp_f32 v32, v32
    ds_read_b128 v[184:187], v214 offset:8192
    s_waitcnt lgkmcnt(3)
    v_mfma_f32_32x32x16_bf16 v[96:111], v[188:191], a[12:15], v[96:111]
    v_exp_f32 v33, v33
    v_add_f32 v227, v227, v32
    v_add_f32 v227, v227, v33
    v_cvt_pk_bf16_f32 v152, v32, v33
    v_fma_f32 v34, v34, s32, -v229
    v_mfma_f32_32x32x16_bf16 v[128:143], v[188:191], a[44:47], v[128:143]
    v_fma_f32 v35, v35, s32, -v229
    v_exp_f32 v34, v34
    v_exp_f32 v35, v35
    v_add_f32 v227, v227, v34
    v_add_f32 v227, v227, v35
    v_cvt_pk_bf16_f32 v153, v34, v35
    ds_read_b128 v[188:191], v215 offset:8192
    s_waitcnt lgkmcnt(3)
    v_mfma_f32_32x32x16_bf16 v[96:111], v[176:179], a[16:19], v[96:111]
    v_fma_f32 v36, v36, s32, -v229
    v_fma_f32 v37, v37, s32, -v229
    v_exp_f32 v36, v36
    v_exp_f32 v37, v37
    v_add_f32 v227, v227, v36
    v_mfma_f32_32x32x16_bf16 v[128:143], v[176:179], a[48:51], v[128:143]
    v_add_f32 v227, v227, v37
    v_cvt_pk_bf16_f32 v154, v36, v37
    v_fma_f32 v38, v38, s32, -v229
    v_fma_f32 v39, v39, s32, -v229
    v_exp_f32 v38, v38
    s_waitcnt lgkmcnt(2)
    v_mfma_f32_32x32x16_bf16 v[96:111], v[180:183], a[20:23], v[96:111]
    v_exp_f32 v39, v39
    v_add_f32 v227, v227, v38
    v_add_f32 v227, v227, v39
    v_cvt_pk_bf16_f32 v155, v38, v39
    v_fma_f32 v64, v64, s32, -v230
    v_mfma_f32_32x32x16_bf16 v[128:143], v[180:183], a[52:55], v[128:143]
    v_fma_f32 v65, v65, s32, -v230
    v_exp_f32 v64, v64
    v_exp_f32 v65, v65
    v_add_f32 v228, v228, v64
    v_add_f32 v228, v228, v65
    v_cvt_pk_bf16_f32 v168, v64, v65
    s_waitcnt lgkmcnt(1)
    v_mfma_f32_32x32x16_bf16 v[96:111], v[184:187], a[24:27], v[96:111]
    v_fma_f32 v66, v66, s32, -v230
    v_fma_f32 v67, v67, s32, -v230
    v_exp_f32 v66, v66
    v_exp_f32 v67, v67
    v_add_f32 v228, v228, v66
    v_mfma_f32_32x32x16_bf16 v[128:143], v[184:187], a[56:59], v[128:143]
    v_add_f32 v228, v228, v67
    v_cvt_pk_bf16_f32 v169, v66, v67
    v_fma_f32 v68, v68, s32, -v230
    v_fma_f32 v69, v69, s32, -v230
    v_exp_f32 v68, v68
    s_waitcnt lgkmcnt(0)
    v_mfma_f32_32x32x16_bf16 v[96:111], v[188:191], a[28:31], v[96:111]
    v_exp_f32 v69, v69
    v_add_f32 v228, v228, v68
    v_add_f32 v228, v228, v69
    v_cvt_pk_bf16_f32 v170, v68, v69
    v_fma_f32 v70, v70, s32, -v230
    v_mfma_f32_32x32x16_bf16 v[128:143], v[188:191], a[60:63], v[128:143]
    v_fma_f32 v71, v71, s32, -v230
    v_exp_f32 v70, v70
    v_exp_f32 v71, v71
    v_add_f32 v228, v228, v70
    v_add_f32 v228, v228, v71
    v_cvt_pk_bf16_f32 v171, v70, v71
    ds_read_b64_tr_b16 v[192:193], v216 offset:0
    ds_read_b64_tr_b16 v[194:195], v216 offset:2048
    ds_read_b64_tr_b16 v[196:197], v217 offset:0
    ds_read_b64_tr_b16 v[198:199], v217 offset:2048
    ds_read_b64_tr_b16 v[200:201], v218 offset:0
    ds_read_b64_tr_b16 v[202:203], v218 offset:2048
    ds_read_b64_tr_b16 v[204:205], v219 offset:0
    ds_read_b64_tr_b16 v[206:207], v219 offset:2048
    s_waitcnt lgkmcnt(6)
    v_mfma_f32_32x32x16_bf16 a[64:79], v[192:195], v[144:147], a[64:79]
    v_fma_f32 v40, v40, s32, -v229
    v_fma_f32 v41, v41, s32, -v229
    v_mfma_f32_32x32x16_bf16 a[128:143], v[192:195], v[160:163], a[128:143]
    v_exp_f32 v40, v40
    v_exp_f32 v41, v41
    v_add_f32 v227, v227, v40
    ds_read_b64_tr_b16 v[192:193], v216 offset:4096
    ds_read_b64_tr_b16 v[194:195], v216 offset:6144
    s_waitcnt lgkmcnt(6)
    v_mfma_f32_32x32x16_bf16 a[80:95], v[196:199], v[144:147], a[80:95]
    v_add_f32 v227, v227, v41
    v_cvt_pk_bf16_f32 v156, v40, v41
    v_fma_f32 v42, v42, s32, -v229
    v_mfma_f32_32x32x16_bf16 a[144:159], v[196:199], v[160:163], a[144:159]
    v_fma_f32 v43, v43, s32, -v229
    v_exp_f32 v42, v42
    v_exp_f32 v43, v43
    ds_read_b64_tr_b16 v[196:197], v217 offset:4096
    ds_read_b64_tr_b16 v[198:199], v217 offset:6144
    s_waitcnt lgkmcnt(6)
    v_mfma_f32_32x32x16_bf16 a[96:111], v[200:203], v[144:147], a[96:111]
    v_add_f32 v227, v227, v42
    v_add_f32 v227, v227, v43
    v_cvt_pk_bf16_f32 v157, v42, v43
    v_mfma_f32_32x32x16_bf16 a[160:175], v[200:203], v[160:163], a[160:175]
    v_fma_f32 v44, v44, s32, -v229
    v_fma_f32 v45, v45, s32, -v229
    ds_read_b64_tr_b16 v[200:201], v218 offset:4096
    ds_read_b64_tr_b16 v[202:203], v218 offset:6144
    s_waitcnt lgkmcnt(6)
    v_mfma_f32_32x32x16_bf16 a[112:127], v[204:207], v[144:147], a[112:127]
    v_exp_f32 v44, v44
    v_exp_f32 v45, v45
    v_add_f32 v227, v227, v44
    v_mfma_f32_32x32x16_bf16 a[176:191], v[204:207], v[160:163], a[176:191]
    v_add_f32 v227, v227, v45
    v_cvt_pk_bf16_f32 v158, v44, v45
    v_fma_f32 v46, v46, s32, -v229
    ds_read_b64_tr_b16 v[204:205], v219 offset:4096
    ds_read_b64_tr_b16 v[206:207], v219 offset:6144
    s_waitcnt lgkmcnt(6)
    v_mfma_f32_32x32x16_bf16 a[64:79], v[192:195], v[148:151], a[64:79]
    v_fma_f32 v47, v47, s32, -v229
    v_exp_f32 v46, v46
    v_exp_f32 v47, v47
    v_mfma_f32_32x32x16_bf16 a[128:143], v[192:195], v[164:167], a[128:143]
    v_add_f32 v227, v227, v46
    v_add_f32 v227, v227, v47
    v_cvt_pk_bf16_f32 v159, v46, v47
    ds_read_b64_tr_b16 v[192:193], v216 offset:8192
    ds_read_b64_tr_b16 v[194:195], v216 offset:10240
    s_waitcnt lgkmcnt(6)
    v_mfma_f32_32x32x16_bf16 a[80:95], v[196:199], v[148:151], a[80:95]
    v_fma_f32 v72, v72, s32, -v230
    v_fma_f32 v73, v73, s32, -v230
    v_mfma_f32_32x32x16_bf16 a[144:159], v[196:199], v[164:167], a[144:159]
    v_exp_f32 v72, v72
    v_exp_f32 v73, v73
    v_add_f32 v228, v228, v72
    ds_read_b64_tr_b16 v[196:197], v217 offset:8192
    ds_read_b64_tr_b16 v[198:199], v217 offset:10240
    s_waitcnt lgkmcnt(6)
    v_mfma_f32_32x32x16_bf16 a[96:111], v[200:203], v[148:151], a[96:111]
    v_add_f32 v228, v228, v73
    v_cvt_pk_bf16_f32 v172, v72, v73
    v_fma_f32 v74, v74, s32, -v230
    v_mfma_f32_32x32x16_bf16 a[160:175], v[200:203], v[164:167], a[160:175]
    v_fma_f32 v75, v75, s32, -v230
    v_exp_f32 v74, v74
    v_exp_f32 v75, v75
    ds_read_b64_tr_b16 v[200:201], v218 offset:8192
    ds_read_b64_tr_b16 v[202:203], v218 offset:10240
    s_waitcnt lgkmcnt(6)
    v_mfma_f32_32x32x16_bf16 a[112:127], v[204:207], v[148:151], a[112:127]
    v_add_f32 v228, v228, v74
    v_add_f32 v228, v228, v75
    v_cvt_pk_bf16_f32 v173, v74, v75
    v_mfma_f32_32x32x16_bf16 a[176:191], v[204:207], v[164:167], a[176:191]
    v_fma_f32 v76, v76, s32, -v230
    v_fma_f32 v77, v77, s32, -v230
    ds_read_b64_tr_b16 v[204:205], v219 offset:8192
    ds_read_b64_tr_b16 v[206:207], v219 offset:10240
    s_waitcnt lgkmcnt(6)
    v_mfma_f32_32x32x16_bf16 a[64:79], v[192:195], v[152:155], a[64:79]
    v_exp_f32 v76, v76
    v_exp_f32 v77, v77
    v_add_f32 v228, v228, v76
    v_mfma_f32_32x32x16_bf16 a[128:143], v[192:195], v[168:171], a[128:143]
    v_add_f32 v228, v228, v77
    v_cvt_pk_bf16_f32 v174, v76, v77
    v_fma_f32 v78, v78, s32, -v230
    ds_read_b64_tr_b16 v[192:193], v216 offset:12288
    ds_read_b64_tr_b16 v[194:195], v216 offset:14336
    s_waitcnt lgkmcnt(6)
    v_mfma_f32_32x32x16_bf16 a[80:95], v[196:199], v[152:155], a[80:95]
    v_fma_f32 v79, v79, s32, -v230
    v_exp_f32 v78, v78
    v_exp_f32 v79, v79
    v_mfma_f32_32x32x16_bf16 a[144:159], v[196:199], v[168:171], a[144:159]
    v_add_f32 v228, v228, v78
    v_add_f32 v228, v228, v79
    v_cvt_pk_bf16_f32 v175, v78, v79
    ds_read_b64_tr_b16 v[196:197], v217 offset:12288
    ds_read_b64_tr_b16 v[198:199], v217 offset:14336
    s_waitcnt lgkmcnt(6)
    v_mfma_f32_32x32x16_bf16 a[96:111], v[200:203], v[152:155], a[96:111]
    v_max3_f32 v232, v80, v81, v82
    v_max3_f32 v233, v83, v84, v85
    v_max3_f32 v232, v232, v86, v87
    v_mfma_f32_32x32x16_bf16 a[160:175], v[200:203], v[168:171], a[160:175]
    v_max3_f32 v233, v233, v88, v89
    v_max3_f32 v232, v232, v90, v91
    v_max3_f32 v233, v233, v92, v93
    v_max3_f32 v232, v232, v94, v95
    ds_read_b64_tr_b16 v[200:201], v218 offset:12288
    ds_read_b64_tr_b16 v[202:203], v218 offset:14336
    s_waitcnt lgkmcnt(6)
    v_mfma_f32_32x32x16_bf16 a[112:127], v[204:207], v[152:155], a[112:127]
    v_max3_f32 v233, v233, v96, v97
    v_max3_f32 v232, v232, v98, v99
    v_max3_f32 v233, v233, v100, v101
    v_mfma_f32_32x32x16_bf16 a[176:191], v[204:207], v[168:171], a[176:191]
    v_max3_f32 v232, v232, v102, v103
    v_max3_f32 v233, v233, v104, v105
    v_max3_f32 v232, v232, v106, v107
    v_max3_f32 v233, v233, v108, v109
    ds_read_b64_tr_b16 v[204:205], v219 offset:12288
    ds_read_b64_tr_b16 v[206:207], v219 offset:14336
    s_waitcnt lgkmcnt(6)
    v_mfma_f32_32x32x16_bf16 a[64:79], v[192:195], v[156:159], a[64:79]
    v_max3_f32 v232, v232, v110, v111
    v_max_f32 v232, v232, v233
    v_mov_b32 v233, v232
    v_mfma_f32_32x32x16_bf16 a[128:143], v[192:195], v[172:175], a[128:143]
    s_nop 0
    v_permlane32_swap_b32 v232, v233
    v_max3_f32 v232, v232, v233, v225
    v_sub_f32 v234, v232, v225
    v_max3_f32 v240, v112, v113, v114
    s_waitcnt lgkmcnt(4)
    v_mfma_f32_32x32x16_bf16 a[80:95], v[196:199], v[156:159], a[80:95]
    v_max3_f32 v241, v115, v116, v117
    v_max3_f32 v240, v240, v118, v119
    v_max3_f32 v241, v241, v120, v121
    v_mfma_f32_32x32x16_bf16 a[144:159], v[196:199], v[172:175], a[144:159]
    v_max3_f32 v240, v240, v122, v123
    v_max3_f32 v241, v241, v124, v125
    v_max3_f32 v240, v240, v126, v127
    v_max3_f32 v241, v241, v128, v129
    s_waitcnt lgkmcnt(2)
    v_mfma_f32_32x32x16_bf16 a[96:111], v[200:203], v[156:159], a[96:111]
    v_max3_f32 v240, v240, v130, v131
    v_max3_f32 v241, v241, v132, v133
    v_max3_f32 v240, v240, v134, v135
    v_mfma_f32_32x32x16_bf16 a[160:175], v[200:203], v[172:175], a[160:175]
    v_max3_f32 v241, v241, v136, v137
    v_max3_f32 v240, v240, v138, v139
    v_max3_f32 v241, v241, v140, v141
    v_max3_f32 v240, v240, v142, v143
    s_waitcnt lgkmcnt(0)
    v_mfma_f32_32x32x16_bf16 a[112:127], v[204:207], v[156:159], a[112:127]
    v_max_f32 v240, v240, v241
    v_mov_b32 v241, v240
    s_nop 1
    v_permlane32_swap_b32 v240, v241
    v_mfma_f32_32x32x16_bf16 a[176:191], v[204:207], v[172:175], a[176:191]
    v_max3_f32 v240, v240, v241, v226
    v_sub_f32 v242, v240, v226
    v_max_f32 v234, v234, v242
    v_cmp_gt_f32 vcc, v234, s39
    s_nop 0
    s_cbranch_vccnz L_rare3
L_back3:
    s_waitcnt vmcnt(16)
    s_barrier
    v_fma_f32 v80, v80, s32, -v229
    v_fma_f32 v81, v81, s32, -v229
    v_exp_f32 v80, v80
    v_exp_f32 v81, v81
    v_add_f32 v227, v227, v80
    v_add_f32 v227, v227, v81
    v_cvt_pk_bf16_f32 v144, v80, v81
    v_fma_f32 v82, v82, s32, -v229
    v_fma_f32 v83, v83, s32, -v229
    v_exp_f32 v82, v82
    v_exp_f32 v83, v83
    v_add_f32 v227, v227, v82
    v_add_f32 v227, v227, v83
    v_cvt_pk_bf16_f32 v145, v82, v83
    v_fma_f32 v84, v84, s32, -v229
    v_fma_f32 v85, v85, s32, -v229
    v_exp_f32 v84, v84
    v_exp_f32 v85, v85
    v_add_f32 v227, v227, v84
    v_add_f32 v227, v227, v85
    v_cvt_pk_bf16_f32 v146, v84, v85
    v_fma_f32 v86, v86, s32, -v229
    v_fma_f32 v87, v87, s32, -v229
    v_exp_f32 v86, v86
    v_exp_f32 v87, v87
    v_add_f32 v227, v227, v86
    v_add_f32 v227, v227, v87
    v_cvt_pk_bf16_f32 v147, v86, v87
    v_fma_f32 v112, v112, s32, -v230
    v_fma_f32 v113, v113, s32, -v230
    v_exp_f32 v112, v112
    v_exp_f32 v113, v113
    v_add_f32 v228, v228, v112
    v_add_f32 v228, v228, v113
    v_cvt_pk_bf16_f32 v160, v112, v113
    v_fma_f32 v114, v114, s32, -v230
    v_fma_f32 v115, v115, s32, -v230
    v_exp_f32 v114, v114
    v_exp_f32 v115, v115
    v_add_f32 v228, v228, v114
    v_add_f32 v228, v228, v115
    v_cvt_pk_bf16_f32 v161, v114, v115
    v_fma_f32 v116, v116, s32, -v230
    v_fma_f32 v117, v117, s32, -v230
    v_exp_f32 v116, v116
    v_exp_f32 v117, v117
    v_add_f32 v228, v228, v116
    v_add_f32 v228, v228, v117
    v_cvt_pk_bf16_f32 v162, v116, v117
    v_fma_f32 v118, v118, s32, -v230
    v_fma_f32 v119, v119, s32, -v230
    v_exp_f32 v118, v118
    v_exp_f32 v119, v119
    v_add_f32 v228, v228, v118
    v_add_f32 v228, v228, v119
    v_cvt_pk_bf16_f32 v163, v118, v119
    v_fma_f32 v88, v88, s32, -v229
    v_fma_f32 v89, v89, s32, -v229
    v_exp_f32 v88, v88
    v_exp_f32 v89, v89
    v_add_f32 v227, v227, v88
    v_add_f32 v227, v227, v89
    v_cvt_pk_bf16_f32 v148, v88, v89
    v_fma_f32 v90, v90, s32, -v229
    v_fma_f32 v91, v91, s32, -v229
    v_exp_f32 v90, v90
    v_exp_f32 v91, v91
    v_add_f32 v227, v227, v90
    v_add_f32 v227, v227, v91
    v_cvt_pk_bf16_f32 v149, v90, v91
    v_fma_f32 v92, v92, s32, -v229
    v_fma_f32 v93, v93, s32, -v229
    v_exp_f32 v92, v92
    v_exp_f32 v93, v93
    v_add_f32 v227, v227, v92
    v_add_f32 v227, v227, v93
    v_cvt_pk_bf16_f32 v150, v92, v93
    v_fma_f32 v94, v94, s32, -v229
    v_fma_f32 v95, v95, s32, -v229
    v_exp_f32 v94, v94
    v_exp_f32 v95, v95
    v_add_f32 v227, v227, v94
    v_add_f32 v227, v227, v95
    v_cvt_pk_bf16_f32 v151, v94, v95
    v_fma_f32 v120, v120, s32, -v230
    v_fma_f32 v121, v121, s32, -v230
    v_exp_f32 v120, v120
    v_exp_f32 v121, v121
    v_add_f32 v228, v228, v120
    v_add_f32 v228, v228, v121
    v_cvt_pk_bf16_f32 v164, v120, v121
    v_fma_f32 v122, v122, s32, -v230
    v_fma_f32 v123, v123, s32, -v230
    v_exp_f32 v122, v122
    v_exp_f32 v123, v123
    v_add_f32 v228, v228, v122
    v_add_f32 v228, v228, v123
    v_cvt_pk_bf16_f32 v165, v122, v123
    v_fma_f32 v124, v124, s32, -v230
    v_fma_f32 v125, v125, s32, -v230
    v_exp_f32 v124, v124
    v_exp_f32 v125, v125
    v_add_f32 v228, v228, v124
    v_add_f32 v228, v228, v125
    v_cvt_pk_bf16_f32 v166, v124, v125
    v_fma_f32 v126, v126, s32, -v230
    v_fma_f32 v127, v127, s32, -v230
    v_exp_f32 v126, v126
    v_exp_f32 v127, v127
    v_add_f32 v228, v228, v126
    v_add_f32 v228, v228, v127
    v_cvt_pk_bf16_f32 v167, v126, v127
    v_fma_f32 v96, v96, s32, -v229
    v_fma_f32 v97, v97, s32, -v229
    v_exp_f32 v96, v96
    v_exp_f32 v97, v97
    v_add_f32 v227, v227, v96
    v_add_f32 v227, v227, v97
    v_cvt_pk_bf16_f32 v152, v96, v97
    v_fma_f32 v98, v98, s32, -v229
    v_fma_f32 v99, v99, s32, -v229
    v_exp_f32 v98, v98
    v_exp_f32 v99, v99
    v_add_f32 v227, v227, v98
    v_add_f32 v227, v227, v99
    v_cvt_pk_bf16_f32 v153, v98, v99
    v_fma_f32 v100, v100, s32, -v229
    v_fma_f32 v101, v101, s32, -v229
    v_exp_f32 v100, v100
    v_exp_f32 v101, v101
    v_add_f32 v227, v227, v100
    v_add_f32 v227, v227, v101
    v_cvt_pk_bf16_f32 v154, v100, v101
    v_fma_f32 v102, v102, s32, -v229
    v_fma_f32 v103, v103, s32, -v229
    v_exp_f32 v102, v102
    v_exp_f32 v103, v103
    v_add_f32 v227, v227, v102
    v_add_f32 v227, v227, v103
    v_cvt_pk_bf16_f32 v155, v102, v103
    v_fma_f32 v128, v128, s32, -v230
    v_fma_f32 v129, v129, s32, -v230
    v_exp_f32 v128, v128
    v_exp_f32 v129, v129
    v_add_f32 v228, v228, v128
    v_add_f32 v228, v228, v129
    v_cvt_pk_bf16_f32 v168, v128, v129
    v_fma_f32 v130, v130, s32, -v230
    v_fma_f32 v131, v131, s32, -v230
    v_exp_f32 v130, v130
    v_exp_f32 v131, v131
    v_add_f32 v228, v228, v130
    v_add_f32 v228, v228, v131
    v_cvt_pk_bf16_f32 v169, v130, v131
    v_fma_f32 v132, v132, s32, -v230
    v_fma_f32 v133, v133, s32, -v230
    v_exp_f32 v132, v132
    v_exp_f32 v133, v133
    v_add_f32 v228, v228, v132
    v_add_f32 v228, v228, v133
    v_cvt_pk_bf16_f32 v170, v132, v133
    v_fma_f32 v134, v134, s32, -v230
    v_fma_f32 v135, v135, s32, -v230
    v_exp_f32 v134, v134
    v_exp_f32 v135, v135
    v_add_f32 v228, v228, v134
    v_add_f32 v228, v228, v135
    v_cvt_pk_bf16_f32 v171, v134, v135
    ds_read_b64_tr_b16 v[192:193], v216 offset:16384
    ds_read_b64_tr_b16 v[194:195], v216 offset:18432
    ds_read_b64_tr_b16 v[196:197], v217 offset:16384
    ds_read_b64_tr_b16 v[198:199], v217 offset:18432
    ds_read_b64_tr_b16 v[200:201], v218 offset:16384
    ds_read_b64_tr_b16 v[202:203], v218 offset:18432
    ds_read_b64_tr_b16 v[204:205], v219 offset:16384
    ds_read_b64_tr_b16 v[206:207], v219 offset:18432
    s_waitcnt lgkmcnt(6)
    v_mfma_f32_32x32x16_bf16 a[64:79], v[192:195], v[144:147], a[64:79]
    v_fma_f32 v104, v104, s32, -v229
    v_fma_f32 v105, v105, s32, -v229
    v_mfma_f32_32x32x16_bf16 a[128:143], v[192:195], v[160:163], a[128:143]
    v_exp_f32 v104, v104
    v_exp_f32 v105, v105
    v_add_f32 v227, v227, v104
    ds_read_b64_tr_b16 v[192:193], v216 offset:20480
    ds_read_b64_tr_b16 v[194:195], v216 offset:22528
    s_waitcnt lgkmcnt(6)
    v_mfma_f32_32x32x16_bf16 a[80:95], v[196:199], v[144:147], a[80:95]
    v_add_f32 v227, v227, v105
    v_cvt_pk_bf16_f32 v156, v104, v105
    v_fma_f32 v106, v106, s32, -v229
    v_mfma_f32_32x32x16_bf16 a[144:159], v[196:199], v[160:163], a[144:159]
    v_fma_f32 v107, v107, s32, -v229
    v_exp_f32 v106, v106
    v_exp_f32 v107, v107
    ds_read_b64_tr_b16 v[196:197], v217 offset:20480
    ds_read_b64_tr_b16 v[198:199], v217 offset:22528
    s_waitcnt lgkmcnt(6)
    v_mfma_f32_32x32x16_bf16 a[96:111], v[200:203], v[144:147], a[96:111]
    v_add_f32 v227, v227, v106
    v_add_f32 v227, v227, v107
    v_cvt_pk_bf16_f32 v157, v106, v107
    v_mfma_f32_32x32x16_bf16 a[160:175], v[200:203], v[160:163], a[160:175]
    v_fma_f32 v108, v108, s32, -v229
    v_fma_f32 v109, v109, s32, -v229
    ds_read_b64_tr_b16 v[200:201], v218 offset:20480
    ds_read_b64_tr_b16 v[202:203], v218 offset:22528
    s_waitcnt lgkmcnt(6)
    v_mfma_f32_32x32x16_bf16 a[112:127], v[204:207], v[144:147], a[112:127]
    v_exp_f32 v108, v108
    v_exp_f32 v109, v109
    v_add_f32 v227, v227, v108
    v_mfma_f32_32x32x16_bf16 a[176:191], v[204:207], v[160:163], a[176:191]
    v_add_f32 v227, v227, v109
    v_cvt_pk_bf16_f32 v158, v108, v109
    v_fma_f32 v110, v110, s32, -v229
    ds_read_b64_tr_b16 v[204:205], v219 offset:20480
    ds_read_b64_tr_b16 v[206:207], v219 offset:22528
    s_waitcnt lgkmcnt(6)
    v_mfma_f32_32x32x16_bf16 a[64:79], v[192:195], v[148:151], a[64:79]
    v_fma_f32 v111, v111, s32, -v229
    v_exp_f32 v110, v110
    v_exp_f32 v111, v111
    v_mfma_f32_32x32x16_bf16 a[128:143], v[192:195], v[164:167], a[128:143]
    v_add_f32 v227, v227, v110
    v_add_f32 v227, v227, v111
    v_cvt_pk_bf16_f32 v159, v110, v111
    ds_read_b64_tr_b16 v[192:193], v216 offset:24576
    ds_read_b64_tr_b16 v[194:195], v216 offset:26624
    s_waitcnt lgkmcnt(6)
    v_mfma_f32_32x32x16_bf16 a[80:95], v[196:199], v[148:151], a[80:95]
    v_fma_f32 v136, v136, s32, -v230
    v_fma_f32 v137, v137, s32, -v230
    v_mfma_f32_32x32x16_bf16 a[144:159], v[196:199], v[164:167], a[144:159]
    v_exp_f32 v136, v136
    v_exp_f32 v137, v137
    v_add_f32 v228, v228, v136
    ds_read_b64_tr_b16 v[196:197], v217 offset:24576
    ds_read_b64_tr_b16 v[198:199], v217 offset:26624
    s_waitcnt lgkmcnt(6)
    v_mfma_f32_32x32x16_bf16 a[96:111], v[200:203], v[148:151], a[96:111]
    v_add_f32 v228, v228, v137
    v_cvt_pk_bf16_f32 v172, v136, v137
    v_fma_f32 v138, v138, s32, -v230
    v_mfma_f32_32x32x16_bf16 a[160:175], v[200:203], v[164:167], a[160:175]
    v_fma_f32 v139, v139, s32, -v230
    v_exp_f32 v138, v138
    v_exp_f32 v139, v139
    ds_read_b64_tr_b16 v[200:201], v218 offset:24576
    ds_read_b64_tr_b16 v[202:203], v218 offset:26624
    s_waitcnt lgkmcnt(6)
    v_mfma_f32_32x32x16_bf16 a[112:127], v[204:207], v[148:151], a[112:127]
    v_add_f32 v228, v228, v138
    v_add_f32 v228, v228, v139
    v_cvt_pk_bf16_f32 v173, v138, v139
    v_mfma_f32_32x32x16_bf16 a[176:191], v[204:207], v[164:167], a[176:191]
    v_fma_f32 v140, v140, s32, -v230
    v_fma_f32 v141, v141, s32, -v230
    ds_read_b64_tr_b16 v[204:205], v219 offset:24576
    ds_read_b64_tr_b16 v[206:207], v219 offset:26624
    s_waitcnt lgkmcnt(6)
    v_mfma_f32_32x32x16_bf16 a[64:79], v[192:195], v[152:155], a[64:79]
    v_exp_f32 v140, v140
    v_exp_f32 v141, v141
    v_add_f32 v228, v228, v140
    v_mfma_f32_32x32x16_bf16 a[128:143], v[192:195], v[168:171], a[128:143]
    v_add_f32 v228, v228, v141
    v_cvt_pk_bf16_f32 v174, v140, v141
    v_fma_f32 v142, v142, s32, -v230
    ds_read_b64_tr_b16 v[192:193], v216 offset:28672
    ds_read_b64_tr_b16 v[194:195], v216 offset:30720
    s_waitcnt lgkmcnt(6)
    v_mfma_f32_32x32x16_bf16 a[80:95], v[196:199], v[152:155], a[80:95]
    v_fma_f32 v143, v143, s32, -v230
    v_exp_f32 v142, v142
    v_exp_f32 v143, v143
    v_mfma_f32_32x32x16_bf16 a[144:159], v[196:199], v[168:171], a[144:159]
    v_add_f32 v228, v228, v142
    v_add_f32 v228, v228, v143
    v_cvt_pk_bf16_f32 v175, v142, v143
    ds_read_b64_tr_b16 v[196:197], v217 offset:28672
    ds_read_b64_tr_b16 v[198:199], v217 offset:30720
    s_waitcnt lgkmcnt(6)
    v_mfma_f32_32x32x16_bf16 a[96:111], v[200:203], v[152:155], a[96:111]
    v_mfma_f32_32x32x16_bf16 a[160:175], v[200:203], v[168:171], a[160:175]
    ds_read_b64_tr_b16 v[200:201], v218 offset:28672
    ds_read_b64_tr_b16 v[202:203], v218 offset:30720
    s_waitcnt lgkmcnt(6)
    v_mfma_f32_32x32x16_bf16 a[112:127], v[204:207], v[152:155], a[112:127]
    v_mfma_f32_32x32x16_bf16 a[176:191], v[204:207], v[168:171], a[176:191]
    ds_read_b64_tr_b16 v[204:205], v219 offset:28672
    ds_read_b64_tr_b16 v[206:207], v219 offset:30720
    s_waitcnt lgkmcnt(6)
    v_mfma_f32_32x32x16_bf16 a[64:79], v[192:195], v[156:159], a[64:79]
    v_mfma_f32_32x32x16_bf16 a[128:143], v[192:195], v[172:175], a[128:143]
    s_waitcnt lgkmcnt(4)
    v_mfma_f32_32x32x16_bf16 a[80:95], v[196:199], v[156:159], a[80:95]
    v_mfma_f32_32x32x16_bf16 a[144:159], v[196:199], v[172:175], a[144:159]
    s_waitcnt lgkmcnt(2)
    v_mfma_f32_32x32x16_bf16 a[96:111], v[200:203], v[156:159], a[96:111]
    v_mfma_f32_32x32x16_bf16 a[160:175], v[200:203], v[172:175], a[160:175]
    s_waitcnt lgkmcnt(0)
    v_mfma_f32_32x32x16_bf16 a[112:127], v[204:207], v[156:159], a[112:127]
    v_mfma_f32_32x32x16_bf16 a[176:191], v[204:207], v[172:175], a[176:191]
    v_mov_b32 v232, v227
    v_mov_b32 v233, v227
    s_nop 1
    v_permlane32_swap_b32 v232, v233
    v_add_f32 v232, v232, v233
    v_rcp_f32 v232, v232
    s_mov_b32 s60, 0
    v_accvgpr_read_b32 v52, a64
    v_accvgpr_read_b32 v53, a65
    v_mul_f32 v52, v52, v232
    v_mul_f32 v53, v53, v232
    v_cvt_pk_bf16_f32 v16, v52, v53
    v_accvgpr_read_b32 v54, a66
    v_accvgpr_read_b32 v55, a67
    v_mul_f32 v54, v54, v232
    v_mul_f32 v55, v55, v232
    v_cvt_pk_bf16_f32 v17, v54, v55
    v_accvgpr_read_b32 v56, a68
    v_accvgpr_read_b32 v57, a69
    v_mul_f32 v56, v56, v232
    v_mul_f32 v57, v57, v232
    v_cvt_pk_bf16_f32 v18, v56, v57
    v_accvgpr_read_b32 v58, a70
    v_accvgpr_read_b32 v59, a71
    v_mul_f32 v58, v58, v232
    v_mul_f32 v59, v59, v232
    v_cvt_pk_bf16_f32 v19, v58, v59
    buffer_store_dwordx4 v[16:19], v231, s[24:27], s60 offen offset:0
    v_accvgpr_read_b32 v56, a72
    v_accvgpr_read_b32 v57, a73
    v_mul_f32 v56, v56, v232
    v_mul_f32 v57, v57, v232
    v_cvt_pk_bf16_f32 v20, v56, v57
    v_accvgpr_read_b32 v58, a74
    v_accvgpr_read_b32 v59, a75
    v_mul_f32 v58, v58, v232
    v_mul_f32 v59, v59, v232
    v_cvt_pk_bf16_f32 v21, v58, v59
    v_accvgpr_read_b32 v60, a76
    v_accvgpr_read_b32 v61, a77
    v_mul_f32 v60, v60, v232
    v_mul_f32 v61, v61, v232
    v_cvt_pk_bf16_f32 v22, v60, v61
    v_accvgpr_read_b32 v62, a78
    v_accvgpr_read_b32 v63, a79
    v_mul_f32 v62, v62, v232
    v_mul_f32 v63, v63, v232
    v_cvt_pk_bf16_f32 v23, v62, v63
    buffer_store_dwordx4 v[20:23], v231, s[24:27], s60 offen offset:256
    v_accvgpr_read_b32 v60, a80
    v_accvgpr_read_b32 v61, a81
    v_mul_f32 v60, v60, v232
    v_mul_f32 v61, v61, v232
    v_cvt_pk_bf16_f32 v24, v60, v61
    v_accvgpr_read_b32 v62, a82
    v_accvgpr_read_b32 v63, a83
    v_mul_f32 v62, v62, v232
    v_mul_f32 v63, v63, v232
    v_cvt_pk_bf16_f32 v25, v62, v63
    v_accvgpr_read_b32 v64, a84
    v_accvgpr_read_b32 v65, a85
    v_mul_f32 v64, v64, v232
    v_mul_f32 v65, v65, v232
    v_cvt_pk_bf16_f32 v26, v64, v65
    v_accvgpr_read_b32 v66, a86
    v_accvgpr_read_b32 v67, a87
    v_mul_f32 v66, v66, v232
    v_mul_f32 v67, v67, v232
    v_cvt_pk_bf16_f32 v27, v66, v67
    buffer_store_dwordx4 v[24:27], v231, s[24:27], s60 offen offset:512
    v_accvgpr_read_b32 v64, a88
    v_accvgpr_read_b32 v65, a89
    v_mul_f32 v64, v64, v232
    v_mul_f32 v65, v65, v232
    v_cvt_pk_bf16_f32 v28, v64, v65
    v_accvgpr_read_b32 v66, a90
    v_accvgpr_read_b32 v67, a91
    v_mul_f32 v66, v66, v232
    v_mul_f32 v67, v67, v232
    v_cvt_pk_bf16_f32 v29, v66, v67
    v_accvgpr_read_b32 v68, a92
    v_accvgpr_read_b32 v69, a93
    v_mul_f32 v68, v68, v232
    v_mul_f32 v69, v69, v232
    v_cvt_pk_bf16_f32 v30, v68, v69
    v_accvgpr_read_b32 v70, a94
    v_accvgpr_read_b32 v71, a95
    v_mul_f32 v70, v70, v232
    v_mul_f32 v71, v71, v232
    v_cvt_pk_bf16_f32 v31, v70, v71
    buffer_store_dwordx4 v[28:31], v231, s[24:27], s60 offen offset:768
    v_accvgpr_read_b32 v68, a96
    v_accvgpr_read_b32 v69, a97
    v_mul_f32 v68, v68, v232
    v_mul_f32 v69, v69, v232
    v_cvt_pk_bf16_f32 v32, v68, v69
    v_accvgpr_read_b32 v70, a98
    v_accvgpr_read_b32 v71, a99
    v_mul_f32 v70, v70, v232
    v_mul_f32 v71, v71, v232
    v_cvt_pk_bf16_f32 v33, v70, v71
    v_accvgpr_read_b32 v72, a100
    v_accvgpr_read_b32 v73, a101
    v_mul_f32 v72, v72, v232
    v_mul_f32 v73, v73, v232
    v_cvt_pk_bf16_f32 v34, v72, v73
    v_accvgpr_read_b32 v74, a102
    v_accvgpr_read_b32 v75, a103
    v_mul_f32 v74, v74, v232
    v_mul_f32 v75, v75, v232
    v_cvt_pk_bf16_f32 v35, v74, v75
    buffer_store_dwordx4 v[32:35], v231, s[24:27], s60 offen offset:1024
    v_accvgpr_read_b32 v72, a104
    v_accvgpr_read_b32 v73, a105
    v_mul_f32 v72, v72, v232
    v_mul_f32 v73, v73, v232
    v_cvt_pk_bf16_f32 v36, v72, v73
    v_accvgpr_read_b32 v74, a106
    v_accvgpr_read_b32 v75, a107
    v_mul_f32 v74, v74, v232
    v_mul_f32 v75, v75, v232
    v_cvt_pk_bf16_f32 v37, v74, v75
    v_accvgpr_read_b32 v76, a108
    v_accvgpr_read_b32 v77, a109
    v_mul_f32 v76, v76, v232
    v_mul_f32 v77, v77, v232
    v_cvt_pk_bf16_f32 v38, v76, v77
    v_accvgpr_read_b32 v78, a110
    v_accvgpr_read_b32 v79, a111
    v_mul_f32 v78, v78, v232
    v_mul_f32 v79, v79, v232
    v_cvt_pk_bf16_f32 v39, v78, v79
    buffer_store_dwordx4 v[36:39], v231, s[24:27], s60 offen offset:1280
    v_accvgpr_read_b32 v48, a112
    v_accvgpr_read_b32 v49, a113
    v_mul_f32 v48, v48, v232
    v_mul_f32 v49, v49, v232
    v_cvt_pk_bf16_f32 v40, v48, v49
    v_accvgpr_read_b32 v50, a114
    v_accvgpr_read_b32 v51, a115
    v_mul_f32 v50, v50, v232
    v_mul_f32 v51, v51, v232
    v_cvt_pk_bf16_f32 v41, v50, v51
    v_accvgpr_read_b32 v52, a116
    v_accvgpr_read_b32 v53, a117
    v_mul_f32 v52, v52, v232
    v_mul_f32 v53, v53, v232
    v_cvt_pk_bf16_f32 v42, v52, v53
    v_accvgpr_read_b32 v54, a118
    v_accvgpr_read_b32 v55, a119
    v_mul_f32 v54, v54, v232
    v_mul_f32 v55, v55, v232
    v_cvt_pk_bf16_f32 v43, v54, v55
    buffer_store_dwordx4 v[40:43], v231, s[24:27], s60 offen offset:1536
    v_accvgpr_read_b32 v48, a120
    v_accvgpr_read_b32 v49, a121
    v_mul_f32 v48, v48, v232
    v_mul_f32 v49, v49, v232
    v_cvt_pk_bf16_f32 v44, v48, v49
    v_accvgpr_read_b32 v50, a122
    v_accvgpr_read_b32 v51, a123
    v_mul_f32 v50, v50, v232
    v_mul_f32 v51, v51, v232
    v_cvt_pk_bf16_f32 v45, v50, v51
    v_accvgpr_read_b32 v52, a124
    v_accvgpr_read_b32 v53, a125
    v_mul_f32 v52, v52, v232
    v_mul_f32 v53, v53, v232
    v_cvt_pk_bf16_f32 v46, v52, v53
    v_accvgpr_read_b32 v54, a126
    v_accvgpr_read_b32 v55, a127
    v_mul_f32 v54, v54, v232
    v_mul_f32 v55, v55, v232
    v_cvt_pk_bf16_f32 v47, v54, v55
    buffer_store_dwordx4 v[44:47], v231, s[24:27], s60 offen offset:1792
    v_mov_b32 v232, v228
    v_mov_b32 v233, v228
    s_nop 1
    v_permlane32_swap_b32 v232, v233
    v_add_f32 v232, v232, v233
    v_rcp_f32 v232, v232
    s_mov_b32 s60, 262144
    v_accvgpr_read_b32 v116, a128
    v_accvgpr_read_b32 v117, a129
    v_mul_f32 v116, v116, v232
    v_mul_f32 v117, v117, v232
    v_cvt_pk_bf16_f32 v80, v116, v117
    v_accvgpr_read_b32 v118, a130
    v_accvgpr_read_b32 v119, a131
    v_mul_f32 v118, v118, v232
    v_mul_f32 v119, v119, v232
    v_cvt_pk_bf16_f32 v81, v118, v119
    v_accvgpr_read_b32 v120, a132
    v_accvgpr_read_b32 v121, a133
    v_mul_f32 v120, v120, v232
    v_mul_f32 v121, v121, v232
    v_cvt_pk_bf16_f32 v82, v120, v121
    v_accvgpr_read_b32 v122, a134
    v_accvgpr_read_b32 v123, a135
    v_mul_f32 v122, v122, v232
    v_mul_f32 v123, v123, v232
    v_cvt_pk_bf16_f32 v83, v122, v123
    buffer_store_dwordx4 v[80:83], v231, s[24:27], s60 offen offset:0
    v_accvgpr_read_b32 v120, a136
    v_accvgpr_read_b32 v121, a137
    v_mul_f32 v120, v120, v232
    v_mul_f32 v121, v121, v232
    v_cvt_pk_bf16_f32 v84, v120, v121
    v_accvgpr_read_b32 v122, a138
    v_accvgpr_read_b32 v123, a139
    v_mul_f32 v122, v122, v232
    v_mul_f32 v123, v123, v232
    v_cvt_pk_bf16_f32 v85, v122, v123
    v_accvgpr_read_b32 v124, a140
    v_accvgpr_read_b32 v125, a141
    v_mul_f32 v124, v124, v232
    v_mul_f32 v125, v125, v232
    v_cvt_pk_bf16_f32 v86, v124, v125
    v_accvgpr_read_b32 v126, a142
    v_accvgpr_read_b32 v127, a143
    v_mul_f32 v126, v126, v232
    v_mul_f32 v127, v127, v232
    v_cvt_pk_bf16_f32 v87, v126, v127
    buffer_store_dwordx4 v[84:87], v231, s[24:27], s60 offen offset:256
    v_accvgpr_read_b32 v124, a144
    v_accvgpr_read_b32 v125, a145
    v_mul_f32 v124, v124, v232
    v_mul_f32 v125, v125, v232
    v_cvt_pk_bf16_f32 v88, v124, v125
    v_accvgpr_read_b32 v126, a146
    v_accvgpr_read_b32 v127, a147
    v_mul_f32 v126, v126, v232
    v_mul_f32 v127, v127, v232
    v_cvt_pk_bf16_f32 v89, v126, v127
    v_accvgpr_read_b32 v128, a148
    v_accvgpr_read_b32 v129, a149
    v_mul_f32 v128, v128, v232
    v_mul_f32 v129, v129, v232
    v_cvt_pk_bf16_f32 v90, v128, v129
    v_accvgpr_read_b32 v130, a150
    v_accvgpr_read_b32 v131, a151
    v_mul_f32 v130, v130, v232
    v_mul_f32 v131, v131, v232
    v_cvt_pk_bf16_f32 v91, v130, v131
    buffer_store_dwordx4 v[88:91], v231, s[24:27], s60 offen offset:512
    v_accvgpr_read_b32 v128, a152
    v_accvgpr_read_b32 v129, a153
    v_mul_f32 v128, v128, v232
    v_mul_f32 v129, v129, v232
    v_cvt_pk_bf16_f32 v92, v128, v129
    v_accvgpr_read_b32 v130, a154
    v_accvgpr_read_b32 v131, a155
    v_mul_f32 v130, v130, v232
    v_mul_f32 v131, v131, v232
    v_cvt_pk_bf16_f32 v93, v130, v131
    v_accvgpr_read_b32 v132, a156
    v_accvgpr_read_b32 v133, a157
    v_mul_f32 v132, v132, v232
    v_mul_f32 v133, v133, v232
    v_cvt_pk_bf16_f32 v94, v132, v133
    v_accvgpr_read_b32 v134, a158
    v_accvgpr_read_b32 v135, a159
    v_mul_f32 v134, v134, v232
    v_mul_f32 v135, v135, v232
    v_cvt_pk_bf16_f32 v95, v134, v135
    buffer_store_dwordx4 v[92:95], v231, s[24:27], s60 offen offset:768
    v_accvgpr_read_b32 v132, a160
    v_accvgpr_read_b32 v133, a161
    v_mul_f32 v132, v132, v232
    v_mul_f32 v133, v133, v232
    v_cvt_pk_bf16_f32 v96, v132, v133
    v_accvgpr_read_b32 v134, a162
    v_accvgpr_read_b32 v135, a163
    v_mul_f32 v134, v134, v232
    v_mul_f32 v135, v135, v232
    v_cvt_pk_bf16_f32 v97, v134, v135
    v_accvgpr_read_b32 v136, a164
    v_accvgpr_read_b32 v137, a165
    v_mul_f32 v136, v136, v232
    v_mul_f32 v137, v137, v232
    v_cvt_pk_bf16_f32 v98, v136, v137
    v_accvgpr_read_b32 v138, a166
    v_accvgpr_read_b32 v139, a167
    v_mul_f32 v138, v138, v232
    v_mul_f32 v139, v139, v232
    v_cvt_pk_bf16_f32 v99, v138, v139
    buffer_store_dwordx4 v[96:99], v231, s[24:27], s60 offen offset:1024
    v_accvgpr_read_b32 v136, a168
    v_accvgpr_read_b32 v137, a169
    v_mul_f32 v136, v136, v232
    v_mul_f32 v137, v137, v232
    v_cvt_pk_bf16_f32 v100, v136, v137
    v_accvgpr_read_b32 v138, a170
    v_accvgpr_read_b32 v139, a171
    v_mul_f32 v138, v138, v232
    v_mul_f32 v139, v139, v232
    v_cvt_pk_bf16_f32 v101, v138, v139
    v_accvgpr_read_b32 v140, a172
    v_accvgpr_read_b32 v141, a173
    v_mul_f32 v140, v140, v232
    v_mul_f32 v141, v141, v232
    v_cvt_pk_bf16_f32 v102, v140, v141
    v_accvgpr_read_b32 v142, a174
    v_accvgpr_read_b32 v143, a175
    v_mul_f32 v142, v142, v232
    v_mul_f32 v143, v143, v232
    v_cvt_pk_bf16_f32 v103, v142, v143
    buffer_store_dwordx4 v[100:103], v231, s[24:27], s60 offen offset:1280
    v_accvgpr_read_b32 v112, a176
    v_accvgpr_read_b32 v113, a177
    v_mul_f32 v112, v112, v232
    v_mul_f32 v113, v113, v232
    v_cvt_pk_bf16_f32 v104, v112, v113
    v_accvgpr_read_b32 v114, a178
    v_accvgpr_read_b32 v115, a179
    v_mul_f32 v114, v114, v232
    v_mul_f32 v115, v115, v232
    v_cvt_pk_bf16_f32 v105, v114, v115
    v_accvgpr_read_b32 v116, a180
    v_accvgpr_read_b32 v117, a181
    v_mul_f32 v116, v116, v232
    v_mul_f32 v117, v117, v232
    v_cvt_pk_bf16_f32 v106, v116, v117
    v_accvgpr_read_b32 v118, a182
    v_accvgpr_read_b32 v119, a183
    v_mul_f32 v118, v118, v232
    v_mul_f32 v119, v119, v232
    v_cvt_pk_bf16_f32 v107, v118, v119
    buffer_store_dwordx4 v[104:107], v231, s[24:27], s60 offen offset:1536
    v_accvgpr_read_b32 v112, a184
    v_accvgpr_read_b32 v113, a185
    v_mul_f32 v112, v112, v232
    v_mul_f32 v113, v113, v232
    v_cvt_pk_bf16_f32 v108, v112, v113
    v_accvgpr_read_b32 v114, a186
    v_accvgpr_read_b32 v115, a187
    v_mul_f32 v114, v114, v232
    v_mul_f32 v115, v115, v232
    v_cvt_pk_bf16_f32 v109, v114, v115
    v_accvgpr_read_b32 v116, a188
    v_accvgpr_read_b32 v117, a189
    v_mul_f32 v116, v116, v232
    v_mul_f32 v117, v117, v232
    v_cvt_pk_bf16_f32 v110, v116, v117
    v_accvgpr_read_b32 v118, a190
    v_accvgpr_read_b32 v119, a191
    v_mul_f32 v118, v118, v232
    v_mul_f32 v119, v119, v232
    v_cvt_pk_bf16_f32 v111, v118, v119
    buffer_store_dwordx4 v[108:111], v231, s[24:27], s60 offen offset:1792
    s_waitcnt vmcnt(0)
L_end:
    s_endpgm
L_rare0:
    s_nop 15
    s_nop 15
    v_sub_f32 v233, v225, v232
    v_mul_f32 v233, s32, v233
    v_exp_f32 v233, v233
    v_mov_b32 v225, v232
    v_mul_f32 v229, s32, v232
    v_mul_f32 v227, v227, v233
    v_accvgpr_read_b32 v234, a64
    v_mul_f32 v234, v234, v233
    v_accvgpr_write_b32 a64, v234
    v_accvgpr_read_b32 v235, a65
    v_mul_f32 v235, v235, v233
    v_accvgpr_write_b32 a65, v235
    v_accvgpr_read_b32 v236, a66
    v_mul_f32 v236, v236, v233
    v_accvgpr_write_b32 a66, v236
    v_accvgpr_read_b32 v237, a67
    v_mul_f32 v237, v237, v233
    v_accvgpr_write_b32 a67, v237
    v_accvgpr_read_b32 v238, a68
    v_mul_f32 v238, v238, v233
    v_accvgpr_write_b32 a68, v238
    v_accvgpr_read_b32 v239, a69
    v_mul_f32 v239, v239, v233
    v_accvgpr_write_b32 a69, v239
    v_accvgpr_read_b32 v234, a70
    v_mul_f32 v234, v234, v233
    v_accvgpr_write_b32 a70, v234
    v_accvgpr_read_b32 v235, a71
    v_mul_f32 v235, v235, v233
    v_accvgpr_write_b32 a71, v235
    v_accvgpr_read_b32 v236, a72
    v_mul_f32 v236, v236, v233
    v_accvgpr_write_b32 a72, v236
    v_accvgpr_read_b32 v237, a73
    v_mul_f32 v237, v237, v233
    v_accvgpr_write_b32 a73, v237
    v_accvgpr_read_b32 v238, a74
    v_mul_f32 v238, v238, v233
    v_accvgpr_write_b32 a74, v238
    v_accvgpr_read_b32 v239, a75
    v_mul_f32 v239, v239, v233
    v_accvgpr_write_b32 a75, v239
    v_accvgpr_read_b32 v234, a76
    v_mul_f32 v234, v234, v233
    v_accvgpr_write_b32 a76, v234
    v_accvgpr_read_b32 v235, a77
    v_mul_f32 v235, v235, v233
    v_accvgpr_write_b32 a77, v235
    v_accvgpr_read_b32 v236, a78
    v_mul_f32 v236, v236, v233
    v_accvgpr_write_b32 a78, v236
    v_accvgpr_read_b32 v237, a79
    v_mul_f32 v237, v237, v233
    v_accvgpr_write_b32 a79, v237
    v_accvgpr_read_b32 v238, a80
    v_mul_f32 v238, v238, v233
    v_accvgpr_write_b32 a80, v238
    v_accvgpr_read_b32 v239, a81
    v_mul_f32 v239, v239, v233
    v_accvgpr_write_b32 a81, v239
    v_accvgpr_read_b32 v234, a82
    v_mul_f32 v234, v234, v233
    v_accvgpr_write_b32 a82, v234
    v_accvgpr_read_b32 v235, a83
    v_mul_f32 v235, v235, v233
    v_accvgpr_write_b32 a83, v235
    v_accvgpr_read_b32 v236, a84
    v_mul_f32 v236, v236, v233
    v_accvgpr_write_b32 a84, v236
    v_accvgpr_read_b32 v237, a85
    v_mul_f32 v237, v237, v233
    v_accvgpr_write_b32 a85, v237
    v_accvgpr_read_b32 v238, a86
    v_mul_f32 v238, v238, v233
    v_accvgpr_write_b32 a86, v238
    v_accvgpr_read_b32 v239, a87
    v_mul_f32 v239, v239, v233
    v_accvgpr_write_b32 a87, v239
    v_accvgpr_read_b32 v234, a88
    v_mul_f32 v234, v234, v233
    v_accvgpr_write_b32 a88, v234
    v_accvgpr_read_b32 v235, a89
    v_mul_f32 v235, v235, v233
    v_accvgpr_write_b32 a89, v235
    v_accvgpr_read_b32 v236, a90
    v_mul_f32 v236, v236, v233
    v_accvgpr_write_b32 a90, v236
    v_accvgpr_read_b32 v237, a91
    v_mul_f32 v237, v237, v233
    v_accvgpr_write_b32 a91, v237
    v_accvgpr_read_b32 v238, a92
    v_mul_f32 v238, v238, v233
    v_accvgpr_write_b32 a92, v238
    v_accvgpr_read_b32 v239, a93
    v_mul_f32 v239, v239, v233
    v_accvgpr_write_b32 a93, v239
    v_accvgpr_read_b32 v234, a94
    v_mul_f32 v234, v234, v233
    v_accvgpr_write_b32 a94, v234
    v_accvgpr_read_b32 v235, a95
    v_mul_f32 v235, v235, v233
    v_accvgpr_write_b32 a95, v235
    v_accvgpr_read_b32 v236, a96
    v_mul_f32 v236, v236, v233
    v_accvgpr_write_b32 a96, v236
    v_accvgpr_read_b32 v237, a97
    v_mul_f32 v237, v237, v233
    v_accvgpr_write_b32 a97, v237
    v_accvgpr_read_b32 v238, a98
    v_mul_f32 v238, v238, v233
    v_accvgpr_write_b32 a98, v238
    v_accvgpr_read_b32 v239, a99
    v_mul_f32 v239, v239, v233
    v_accvgpr_write_b32 a99, v239
    v_accvgpr_read_b32 v234, a100
    v_mul_f32 v234, v234, v233
    v_accvgpr_write_b32 a100, v234
    v_accvgpr_read_b32 v235, a101
    v_mul_f32 v235, v235, v233
    v_accvgpr_write_b32 a101, v235
    v_accvgpr_read_b32 v236, a102
    v_mul_f32 v236, v236, v233
    v_accvgpr_write_b32 a102, v236
    v_accvgpr_read_b32 v237, a103
    v_mul_f32 v237, v237, v233
    v_accvgpr_write_b32 a103, v237
    v_accvgpr_read_b32 v238, a104
    v_mul_f32 v238, v238, v233
    v_accvgpr_write_b32 a104, v238
    v_accvgpr_read_b32 v239, a105
    v_mul_f32 v239, v239, v233
    v_accvgpr_write_b32 a105, v239
    v_accvgpr_read_b32 v234, a106
    v_mul_f32 v234, v234, v233
    v_accvgpr_write_b32 a106, v234
    v_accvgpr_read_b32 v235, a107
    v_mul_f32 v235, v235, v233
    v_accvgpr_write_b32 a107, v235
    v_accvgpr_read_b32 v236, a108
    v_mul_f32 v236, v236, v233
    v_accvgpr_write_b32 a108, v236
    v_accvgpr_read_b32 v237, a109
    v_mul_f32 v237, v237, v233
    v_accvgpr_write_b32 a109, v237
    v_accvgpr_read_b32 v238, a110
    v_mul_f32 v238, v238, v233
    v_accvgpr_write_b32 a110, v238
    v_accvgpr_read_b32 v239, a111
    v_mul_f32 v239, v239, v233
    v_accvgpr_write_b32 a111, v239
    v_accvgpr_read_b32 v234, a112
    v_mul_f32 v234, v234, v233
    v_accvgpr_write_b32 a112, v234
    v_accvgpr_read_b32 v235, a113
    v_mul_f32 v235, v235, v233
    v_accvgpr_write_b32 a113, v235
    v_accvgpr_read_b32 v236, a114
    v_mul_f32 v236, v236, v233
    v_accvgpr_write_b32 a114, v236
    v_accvgpr_read_b32 v237, a115
    v_mul_f32 v237, v237, v233
    v_accvgpr_write_b32 a115, v237
    v_accvgpr_read_b32 v238, a116
    v_mul_f32 v238, v238, v233
    v_accvgpr_write_b32 a116, v238
    v_accvgpr_read_b32 v239, a117
    v_mul_f32 v239, v239, v233
    v_accvgpr_write_b32 a117, v239
    v_accvgpr_read_b32 v234, a118
    v_mul_f32 v234, v234, v233
    v_accvgpr_write_b32 a118, v234
    v_accvgpr_read_b32 v235, a119
    v_mul_f32 v235, v235, v233
    v_accvgpr_write_b32 a119, v235
    v_accvgpr_read_b32 v236, a120
    v_mul_f32 v236, v236, v233
    v_accvgpr_write_b32 a120, v236
    v_accvgpr_read_b32 v237, a121
    v_mul_f32 v237, v237, v233
    v_accvgpr_write_b32 a121, v237
    v_accvgpr_read_b32 v238, a122
    v_mul_f32 v238, v238, v233
    v_accvgpr_write_b32 a122, v238
    v_accvgpr_read_b32 v239, a123
    v_mul_f32 v239, v239, v233
    v_accvgpr_write_b32 a123, v239
    v_accvgpr_read_b32 v234, a124
    v_mul_f32 v234, v234, v233
    v_accvgpr_write_b32 a124, v234
    v_accvgpr_read_b32 v235, a125
    v_mul_f32 v235, v235, v233
    v_accvgpr_write_b32 a125, v235
    v_accvgpr_read_b32 v236, a126
    v_mul_f32 v236, v236, v233
    v_accvgpr_write_b32 a126, v236
    v_accvgpr_read_b32 v237, a127
    v_mul_f32 v237, v237, v233
    v_accvgpr_write_b32 a127, v237
    v_sub_f32 v241, v226, v240
    v_mul_f32 v241, s32, v241
    v_exp_f32 v241, v241
    v_mov_b32 v226, v240
    v_mul_f32 v230, s32, v240
    v_mul_f32 v228, v228, v241
    v_accvgpr_read_b32 v242, a128
    v_mul_f32 v242, v242, v241
    v_accvgpr_write_b32 a128, v242
    v_accvgpr_read_b32 v243, a129
    v_mul_f32 v243, v243, v241
    v_accvgpr_write_b32 a129, v243
    v_accvgpr_read_b32 v244, a130
    v_mul_f32 v244, v244, v241
    v_accvgpr_write_b32 a130, v244
    v_accvgpr_read_b32 v245, a131
    v_mul_f32 v245, v245, v241
    v_accvgpr_write_b32 a131, v245
    v_accvgpr_read_b32 v246, a132
    v_mul_f32 v246, v246, v241
    v_accvgpr_write_b32 a132, v246
    v_accvgpr_read_b32 v247, a133
    v_mul_f32 v247, v247, v241
    v_accvgpr_write_b32 a133, v247
    v_accvgpr_read_b32 v242, a134
    v_mul_f32 v242, v242, v241
    v_accvgpr_write_b32 a134, v242
    v_accvgpr_read_b32 v243, a135
    v_mul_f32 v243, v243, v241
    v_accvgpr_write_b32 a135, v243
    v_accvgpr_read_b32 v244, a136
    v_mul_f32 v244, v244, v241
    v_accvgpr_write_b32 a136, v244
    v_accvgpr_read_b32 v245, a137
    v_mul_f32 v245, v245, v241
    v_accvgpr_write_b32 a137, v245
    v_accvgpr_read_b32 v246, a138
    v_mul_f32 v246, v246, v241
    v_accvgpr_write_b32 a138, v246
    v_accvgpr_read_b32 v247, a139
    v_mul_f32 v247, v247, v241
    v_accvgpr_write_b32 a139, v247
    v_accvgpr_read_b32 v242, a140
    v_mul_f32 v242, v242, v241
    v_accvgpr_write_b32 a140, v242
    v_accvgpr_read_b32 v243, a141
    v_mul_f32 v243, v243, v241
    v_accvgpr_write_b32 a141, v243
    v_accvgpr_read_b32 v244, a142
    v_mul_f32 v244, v244, v241
    v_accvgpr_write_b32 a142, v244
    v_accvgpr_read_b32 v245, a143
    v_mul_f32 v245, v245, v241
    v_accvgpr_write_b32 a143, v245
    v_accvgpr_read_b32 v246, a144
    v_mul_f32 v246, v246, v241
    v_accvgpr_write_b32 a144, v246
    v_accvgpr_read_b32 v247, a145
    v_mul_f32 v247, v247, v241
    v_accvgpr_write_b32 a145, v247
    v_accvgpr_read_b32 v242, a146
    v_mul_f32 v242, v242, v241
    v_accvgpr_write_b32 a146, v242
    v_accvgpr_read_b32 v243, a147
    v_mul_f32 v243, v243, v241
    v_accvgpr_write_b32 a147, v243
    v_accvgpr_read_b32 v244, a148
    v_mul_f32 v244, v244, v241
    v_accvgpr_write_b32 a148, v244
    v_accvgpr_read_b32 v245, a149
    v_mul_f32 v245, v245, v241
    v_accvgpr_write_b32 a149, v245
    v_accvgpr_read_b32 v246, a150
    v_mul_f32 v246, v246, v241
    v_accvgpr_write_b32 a150, v246
    v_accvgpr_read_b32 v247, a151
    v_mul_f32 v247, v247, v241
    v_accvgpr_write_b32 a151, v247
    v_accvgpr_read_b32 v242, a152
    v_mul_f32 v242, v242, v241
    v_accvgpr_write_b32 a152, v242
    v_accvgpr_read_b32 v243, a153
    v_mul_f32 v243, v243, v241
    v_accvgpr_write_b32 a153, v243
    v_accvgpr_read_b32 v244, a154
    v_mul_f32 v244, v244, v241
    v_accvgpr_write_b32 a154, v244
    v_accvgpr_read_b32 v245, a155
    v_mul_f32 v245, v245, v241
    v_accvgpr_write_b32 a155, v245
    v_accvgpr_read_b32 v246, a156
    v_mul_f32 v246, v246, v241
    v_accvgpr_write_b32 a156, v246
    v_accvgpr_read_b32 v247, a157
    v_mul_f32 v247, v247, v241
    v_accvgpr_write_b32 a157, v247
    v_accvgpr_read_b32 v242, a158
    v_mul_f32 v242, v242, v241
    v_accvgpr_write_b32 a158, v242
    v_accvgpr_read_b32 v243, a159
    v_mul_f32 v243, v243, v241
    v_accvgpr_write_b32 a159, v243
    v_accvgpr_read_b32 v244, a160
    v_mul_f32 v244, v244, v241
    v_accvgpr_write_b32 a160, v244
    v_accvgpr_read_b32 v245, a161
    v_mul_f32 v245, v245, v241
    v_accvgpr_write_b32 a161, v245
    v_accvgpr_read_b32 v246, a162
    v_mul_f32 v246, v246, v241
    v_accvgpr_write_b32 a162, v246
    v_accvgpr_read_b32 v247, a163
    v_mul_f32 v247, v247, v241
    v_accvgpr_write_b32 a163, v247
    v_accvgpr_read_b32 v242, a164
    v_mul_f32 v242, v242, v241
    v_accvgpr_write_b32 a164, v242
    v_accvgpr_read_b32 v243, a165
    v_mul_f32 v243, v243, v241
    v_accvgpr_write_b32 a165, v243
    v_accvgpr_read_b32 v244, a166
    v_mul_f32 v244, v244, v241
    v_accvgpr_write_b32 a166, v244
    v_accvgpr_read_b32 v245, a167
    v_mul_f32 v245, v245, v241
    v_accvgpr_write_b32 a167, v245
    v_accvgpr_read_b32 v246, a168
    v_mul_f32 v246, v246, v241
    v_accvgpr_write_b32 a168, v246
    v_accvgpr_read_b32 v247, a169
    v_mul_f32 v247, v247, v241
    v_accvgpr_write_b32 a169, v247
    v_accvgpr_read_b32 v242, a170
    v_mul_f32 v242, v242, v241
    v_accvgpr_write_b32 a170, v242
    v_accvgpr_read_b32 v243, a171
    v_mul_f32 v243, v243, v241
    v_accvgpr_write_b32 a171, v243
    v_accvgpr_read_b32 v244, a172
    v_mul_f32 v244, v244, v241
    v_accvgpr_write_b32 a172, v244
    v_accvgpr_read_b32 v245, a173
    v_mul_f32 v245, v245, v241
    v_accvgpr_write_b32 a173, v245
    v_accvgpr_read_b32 v246, a174
    v_mul_f32 v246, v246, v241
    v_accvgpr_write_b32 a174, v246
    v_accvgpr_read_b32 v247, a175
    v_mul_f32 v247, v247, v241
    v_accvgpr_write_b32 a175, v247
    v_accvgpr_read_b32 v242, a176
    v_mul_f32 v242, v242, v241
    v_accvgpr_write_b32 a176, v242
    v_accvgpr_read_b32 v243, a177
    v_mul_f32 v243, v243, v241
    v_accvgpr_write_b32 a177, v243
    v_accvgpr_read_b32 v244, a178
    v_mul_f32 v244, v244, v241
    v_accvgpr_write_b32 a178, v244
    v_accvgpr_read_b32 v245, a179
    v_mul_f32 v245, v245, v241
    v_accvgpr_write_b32 a179, v245
    v_accvgpr_read_b32 v246, a180
    v_mul_f32 v246, v246, v241
    v_accvgpr_write_b32 a180, v246
    v_accvgpr_read_b32 v247, a181
    v_mul_f32 v247, v247, v241
    v_accvgpr_write_b32 a181, v247
    v_accvgpr_read_b32 v242, a182
    v_mul_f32 v242, v242, v241
    v_accvgpr_write_b32 a182, v242
    v_accvgpr_read_b32 v243, a183
    v_mul_f32 v243, v243, v241
    v_accvgpr_write_b32 a183, v243
    v_accvgpr_read_b32 v244, a184
    v_mul_f32 v244, v244, v241
    v_accvgpr_write_b32 a184, v244
    v_accvgpr_read_b32 v245, a185
    v_mul_f32 v245, v245, v241
    v_accvgpr_write_b32 a185, v245
    v_accvgpr_read_b32 v246, a186
    v_mul_f32 v246, v246, v241
    v_accvgpr_write_b32 a186, v246
    v_accvgpr_read_b32 v247, a187
    v_mul_f32 v247, v247, v241
    v_accvgpr_write_b32 a187, v247
    v_accvgpr_read_b32 v242, a188
    v_mul_f32 v242, v242, v241
    v_accvgpr_write_b32 a188, v242
    v_accvgpr_read_b32 v243, a189
    v_mul_f32 v243, v243, v241
    v_accvgpr_write_b32 a189, v243
    v_accvgpr_read_b32 v244, a190
    v_mul_f32 v244, v244, v241
    v_accvgpr_write_b32 a190, v244
    v_accvgpr_read_b32 v245, a191
    v_mul_f32 v245, v245, v241
    v_accvgpr_write_b32 a191, v245
    s_nop 15
    s_branch L_back0
L_rare1:
    s_nop 15
    s_nop 15
    v_sub_f32 v233, v225, v232
    v_mul_f32 v233, s32, v233
    v_exp_f32 v233, v233
    v_mov_b32 v225, v232
    v_mul_f32 v229, s32, v232
    v_mul_f32 v227, v227, v233
    v_accvgpr_read_b32 v234, a64
    v_mul_f32 v234, v234, v233
    v_accvgpr_write_b32 a64, v234
    v_accvgpr_read_b32 v235, a65
    v_mul_f32 v235, v235, v233
    v_accvgpr_write_b32 a65, v235
    v_accvgpr_read_b32 v236, a66
    v_mul_f32 v236, v236, v233
    v_accvgpr_write_b32 a66, v236
    v_accvgpr_read_b32 v237, a67
    v_mul_f32 v237, v237, v233
    v_accvgpr_write_b32 a67, v237
    v_accvgpr_read_b32 v238, a68
    v_mul_f32 v238, v238, v233
    v_accvgpr_write_b32 a68, v238
    v_accvgpr_read_b32 v239, a69
    v_mul_f32 v239, v239, v233
    v_accvgpr_write_b32 a69, v239
    v_accvgpr_read_b32 v234, a70
    v_mul_f32 v234, v234, v233
    v_accvgpr_write_b32 a70, v234
    v_accvgpr_read_b32 v235, a71
    v_mul_f32 v235, v235, v233
    v_accvgpr_write_b32 a71, v235
    v_accvgpr_read_b32 v236, a72
    v_mul_f32 v236, v236, v233
    v_accvgpr_write_b32 a72, v236
    v_accvgpr_read_b32 v237, a73
    v_mul_f32 v237, v237, v233
    v_accvgpr_write_b32 a73, v237
    v_accvgpr_read_b32 v238, a74
    v_mul_f32 v238, v238, v233
    v_accvgpr_write_b32 a74, v238
    v_accvgpr_read_b32 v239, a75
    v_mul_f32 v239, v239, v233
    v_accvgpr_write_b32 a75, v239
    v_accvgpr_read_b32 v234, a76
    v_mul_f32 v234, v234, v233
    v_accvgpr_write_b32 a76, v234
    v_accvgpr_read_b32 v235, a77
    v_mul_f32 v235, v235, v233
    v_accvgpr_write_b32 a77, v235
    v_accvgpr_read_b32 v236, a78
    v_mul_f32 v236, v236, v233
    v_accvgpr_write_b32 a78, v236
    v_accvgpr_read_b32 v237, a79
    v_mul_f32 v237, v237, v233
    v_accvgpr_write_b32 a79, v237
    v_accvgpr_read_b32 v238, a80
    v_mul_f32 v238, v238, v233
    v_accvgpr_write_b32 a80, v238
    v_accvgpr_read_b32 v239, a81
    v_mul_f32 v239, v239, v233
    v_accvgpr_write_b32 a81, v239
    v_accvgpr_read_b32 v234, a82
    v_mul_f32 v234, v234, v233
    v_accvgpr_write_b32 a82, v234
    v_accvgpr_read_b32 v235, a83
    v_mul_f32 v235, v235, v233
    v_accvgpr_write_b32 a83, v235
    v_accvgpr_read_b32 v236, a84
    v_mul_f32 v236, v236, v233
    v_accvgpr_write_b32 a84, v236
    v_accvgpr_read_b32 v237, a85
    v_mul_f32 v237, v237, v233
    v_accvgpr_write_b32 a85, v237
    v_accvgpr_read_b32 v238, a86
    v_mul_f32 v238, v238, v233
    v_accvgpr_write_b32 a86, v238
    v_accvgpr_read_b32 v239, a87
    v_mul_f32 v239, v239, v233
    v_accvgpr_write_b32 a87, v239
    v_accvgpr_read_b32 v234, a88
    v_mul_f32 v234, v234, v233
    v_accvgpr_write_b32 a88, v234
    v_accvgpr_read_b32 v235, a89
    v_mul_f32 v235, v235, v233
    v_accvgpr_write_b32 a89, v235
    v_accvgpr_read_b32 v236, a90
    v_mul_f32 v236, v236, v233
    v_accvgpr_write_b32 a90, v236
    v_accvgpr_read_b32 v237, a91
    v_mul_f32 v237, v237, v233
    v_accvgpr_write_b32 a91, v237
    v_accvgpr_read_b32 v238, a92
    v_mul_f32 v238, v238, v233
    v_accvgpr_write_b32 a92, v238
    v_accvgpr_read_b32 v239, a93
    v_mul_f32 v239, v239, v233
    v_accvgpr_write_b32 a93, v239
    v_accvgpr_read_b32 v234, a94
    v_mul_f32 v234, v234, v233
    v_accvgpr_write_b32 a94, v234
    v_accvgpr_read_b32 v235, a95
    v_mul_f32 v235, v235, v233
    v_accvgpr_write_b32 a95, v235
    v_accvgpr_read_b32 v236, a96
    v_mul_f32 v236, v236, v233
    v_accvgpr_write_b32 a96, v236
    v_accvgpr_read_b32 v237, a97
    v_mul_f32 v237, v237, v233
    v_accvgpr_write_b32 a97, v237
    v_accvgpr_read_b32 v238, a98
    v_mul_f32 v238, v238, v233
    v_accvgpr_write_b32 a98, v238
    v_accvgpr_read_b32 v239, a99
    v_mul_f32 v239, v239, v233
    v_accvgpr_write_b32 a99, v239
    v_accvgpr_read_b32 v234, a100
    v_mul_f32 v234, v234, v233
    v_accvgpr_write_b32 a100, v234
    v_accvgpr_read_b32 v235, a101
    v_mul_f32 v235, v235, v233
    v_accvgpr_write_b32 a101, v235
    v_accvgpr_read_b32 v236, a102
    v_mul_f32 v236, v236, v233
    v_accvgpr_write_b32 a102, v236
    v_accvgpr_read_b32 v237, a103
    v_mul_f32 v237, v237, v233
    v_accvgpr_write_b32 a103, v237
    v_accvgpr_read_b32 v238, a104
    v_mul_f32 v238, v238, v233
    v_accvgpr_write_b32 a104, v238
    v_accvgpr_read_b32 v239, a105
    v_mul_f32 v239, v239, v233
    v_accvgpr_write_b32 a105, v239
    v_accvgpr_read_b32 v234, a106
    v_mul_f32 v234, v234, v233
    v_accvgpr_write_b32 a106, v234
    v_accvgpr_read_b32 v235, a107
    v_mul_f32 v235, v235, v233
    v_accvgpr_write_b32 a107, v235
    v_accvgpr_read_b32 v236, a108
    v_mul_f32 v236, v236, v233
    v_accvgpr_write_b32 a108, v236
    v_accvgpr_read_b32 v237, a109
    v_mul_f32 v237, v237, v233
    v_accvgpr_write_b32 a109, v237
    v_accvgpr_read_b32 v238, a110
    v_mul_f32 v238, v238, v233
    v_accvgpr_write_b32 a110, v238
    v_accvgpr_read_b32 v239, a111
    v_mul_f32 v239, v239, v233
    v_accvgpr_write_b32 a111, v239
    v_accvgpr_read_b32 v234, a112
    v_mul_f32 v234, v234, v233
    v_accvgpr_write_b32 a112, v234
    v_accvgpr_read_b32 v235, a113
    v_mul_f32 v235, v235, v233
    v_accvgpr_write_b32 a113, v235
    v_accvgpr_read_b32 v236, a114
    v_mul_f32 v236, v236, v233
    v_accvgpr_write_b32 a114, v236
    v_accvgpr_read_b32 v237, a115
    v_mul_f32 v237, v237, v233
    v_accvgpr_write_b32 a115, v237
    v_accvgpr_read_b32 v238, a116
    v_mul_f32 v238, v238, v233
    v_accvgpr_write_b32 a116, v238
    v_accvgpr_read_b32 v239, a117
    v_mul_f32 v239, v239, v233
    v_accvgpr_write_b32 a117, v239
    v_accvgpr_read_b32 v234, a118
    v_mul_f32 v234, v234, v233
    v_accvgpr_write_b32 a118, v234
    v_accvgpr_read_b32 v235, a119
    v_mul_f32 v235, v235, v233
    v_accvgpr_write_b32 a119, v235
    v_accvgpr_read_b32 v236, a120
    v_mul_f32 v236, v236, v233
    v_accvgpr_write_b32 a120, v236
    v_accvgpr_read_b32 v237, a121
    v_mul_f32 v237, v237, v233
    v_accvgpr_write_b32 a121, v237
    v_accvgpr_read_b32 v238, a122
    v_mul_f32 v238, v238, v233
    v_accvgpr_write_b32 a122, v238
    v_accvgpr_read_b32 v239, a123
    v_mul_f32 v239, v239, v233
    v_accvgpr_write_b32 a123, v239
    v_accvgpr_read_b32 v234, a124
    v_mul_f32 v234, v234, v233
    v_accvgpr_write_b32 a124, v234
    v_accvgpr_read_b32 v235, a125
    v_mul_f32 v235, v235, v233
    v_accvgpr_write_b32 a125, v235
    v_accvgpr_read_b32 v236, a126
    v_mul_f32 v236, v236, v233
    v_accvgpr_write_b32 a126, v236
    v_accvgpr_read_b32 v237, a127
    v_mul_f32 v237, v237, v233
    v_accvgpr_write_b32 a127, v237
    v_sub_f32 v241, v226, v240
    v_mul_f32 v241, s32, v241
    v_exp_f32 v241, v241
    v_mov_b32 v226, v240
    v_mul_f32 v230, s32, v240
    v_mul_f32 v228, v228, v241
    v_accvgpr_read_b32 v242, a128
    v_mul_f32 v242, v242, v241
    v_accvgpr_write_b32 a128, v242
    v_accvgpr_read_b32 v243, a129
    v_mul_f32 v243, v243, v241
    v_accvgpr_write_b32 a129, v243
    v_accvgpr_read_b32 v244, a130
    v_mul_f32 v244, v244, v241
    v_accvgpr_write_b32 a130, v244
    v_accvgpr_read_b32 v245, a131
    v_mul_f32 v245, v245, v241
    v_accvgpr_write_b32 a131, v245
    v_accvgpr_read_b32 v246, a132
    v_mul_f32 v246, v246, v241
    v_accvgpr_write_b32 a132, v246
    v_accvgpr_read_b32 v247, a133
    v_mul_f32 v247, v247, v241
    v_accvgpr_write_b32 a133, v247
    v_accvgpr_read_b32 v242, a134
    v_mul_f32 v242, v242, v241
    v_accvgpr_write_b32 a134, v242
    v_accvgpr_read_b32 v243, a135
    v_mul_f32 v243, v243, v241
    v_accvgpr_write_b32 a135, v243
    v_accvgpr_read_b32 v244, a136
    v_mul_f32 v244, v244, v241
    v_accvgpr_write_b32 a136, v244
    v_accvgpr_read_b32 v245, a137
    v_mul_f32 v245, v245, v241
    v_accvgpr_write_b32 a137, v245
    v_accvgpr_read_b32 v246, a138
    v_mul_f32 v246, v246, v241
    v_accvgpr_write_b32 a138, v246
    v_accvgpr_read_b32 v247, a139
    v_mul_f32 v247, v247, v241
    v_accvgpr_write_b32 a139, v247
    v_accvgpr_read_b32 v242, a140
    v_mul_f32 v242, v242, v241
    v_accvgpr_write_b32 a140, v242
    v_accvgpr_read_b32 v243, a141
    v_mul_f32 v243, v243, v241
    v_accvgpr_write_b32 a141, v243
    v_accvgpr_read_b32 v244, a142
    v_mul_f32 v244, v244, v241
    v_accvgpr_write_b32 a142, v244
    v_accvgpr_read_b32 v245, a143
    v_mul_f32 v245, v245, v241
    v_accvgpr_write_b32 a143, v245
    v_accvgpr_read_b32 v246, a144
    v_mul_f32 v246, v246, v241
    v_accvgpr_write_b32 a144, v246
    v_accvgpr_read_b32 v247, a145
    v_mul_f32 v247, v247, v241
    v_accvgpr_write_b32 a145, v247
    v_accvgpr_read_b32 v242, a146
    v_mul_f32 v242, v242, v241
    v_accvgpr_write_b32 a146, v242
    v_accvgpr_read_b32 v243, a147
    v_mul_f32 v243, v243, v241
    v_accvgpr_write_b32 a147, v243
    v_accvgpr_read_b32 v244, a148
    v_mul_f32 v244, v244, v241
    v_accvgpr_write_b32 a148, v244
    v_accvgpr_read_b32 v245, a149
    v_mul_f32 v245, v245, v241
    v_accvgpr_write_b32 a149, v245
    v_accvgpr_read_b32 v246, a150
    v_mul_f32 v246, v246, v241
    v_accvgpr_write_b32 a150, v246
    v_accvgpr_read_b32 v247, a151
    v_mul_f32 v247, v247, v241
    v_accvgpr_write_b32 a151, v247
    v_accvgpr_read_b32 v242, a152
    v_mul_f32 v242, v242, v241
    v_accvgpr_write_b32 a152, v242
    v_accvgpr_read_b32 v243, a153
    v_mul_f32 v243, v243, v241
    v_accvgpr_write_b32 a153, v243
    v_accvgpr_read_b32 v244, a154
    v_mul_f32 v244, v244, v241
    v_accvgpr_write_b32 a154, v244
    v_accvgpr_read_b32 v245, a155
    v_mul_f32 v245, v245, v241
    v_accvgpr_write_b32 a155, v245
    v_accvgpr_read_b32 v246, a156
    v_mul_f32 v246, v246, v241
    v_accvgpr_write_b32 a156, v246
    v_accvgpr_read_b32 v247, a157
    v_mul_f32 v247, v247, v241
    v_accvgpr_write_b32 a157, v247
    v_accvgpr_read_b32 v242, a158
    v_mul_f32 v242, v242, v241
    v_accvgpr_write_b32 a158, v242
    v_accvgpr_read_b32 v243, a159
    v_mul_f32 v243, v243, v241
    v_accvgpr_write_b32 a159, v243
    v_accvgpr_read_b32 v244, a160
    v_mul_f32 v244, v244, v241
    v_accvgpr_write_b32 a160, v244
    v_accvgpr_read_b32 v245, a161
    v_mul_f32 v245, v245, v241
    v_accvgpr_write_b32 a161, v245
    v_accvgpr_read_b32 v246, a162
    v_mul_f32 v246, v246, v241
    v_accvgpr_write_b32 a162, v246
    v_accvgpr_read_b32 v247, a163
    v_mul_f32 v247, v247, v241
    v_accvgpr_write_b32 a163, v247
    v_accvgpr_read_b32 v242, a164
    v_mul_f32 v242, v242, v241
    v_accvgpr_write_b32 a164, v242
    v_accvgpr_read_b32 v243, a165
    v_mul_f32 v243, v243, v241
    v_accvgpr_write_b32 a165, v243
    v_accvgpr_read_b32 v244, a166
    v_mul_f32 v244, v244, v241
    v_accvgpr_write_b32 a166, v244
    v_accvgpr_read_b32 v245, a167
    v_mul_f32 v245, v245, v241
    v_accvgpr_write_b32 a167, v245
    v_accvgpr_read_b32 v246, a168
    v_mul_f32 v246, v246, v241
    v_accvgpr_write_b32 a168, v246
    v_accvgpr_read_b32 v247, a169
    v_mul_f32 v247, v247, v241
    v_accvgpr_write_b32 a169, v247
    v_accvgpr_read_b32 v242, a170
    v_mul_f32 v242, v242, v241
    v_accvgpr_write_b32 a170, v242
    v_accvgpr_read_b32 v243, a171
    v_mul_f32 v243, v243, v241
    v_accvgpr_write_b32 a171, v243
    v_accvgpr_read_b32 v244, a172
    v_mul_f32 v244, v244, v241
    v_accvgpr_write_b32 a172, v244
    v_accvgpr_read_b32 v245, a173
    v_mul_f32 v245, v245, v241
    v_accvgpr_write_b32 a173, v245
    v_accvgpr_read_b32 v246, a174
    v_mul_f32 v246, v246, v241
    v_accvgpr_write_b32 a174, v246
    v_accvgpr_read_b32 v247, a175
    v_mul_f32 v247, v247, v241
    v_accvgpr_write_b32 a175, v247
    v_accvgpr_read_b32 v242, a176
    v_mul_f32 v242, v242, v241
    v_accvgpr_write_b32 a176, v242
    v_accvgpr_read_b32 v243, a177
    v_mul_f32 v243, v243, v241
    v_accvgpr_write_b32 a177, v243
    v_accvgpr_read_b32 v244, a178
    v_mul_f32 v244, v244, v241
    v_accvgpr_write_b32 a178, v244
    v_accvgpr_read_b32 v245, a179
    v_mul_f32 v245, v245, v241
    v_accvgpr_write_b32 a179, v245
    v_accvgpr_read_b32 v246, a180
    v_mul_f32 v246, v246, v241
    v_accvgpr_write_b32 a180, v246
    v_accvgpr_read_b32 v247, a181
    v_mul_f32 v247, v247, v241
    v_accvgpr_write_b32 a181, v247
    v_accvgpr_read_b32 v242, a182
    v_mul_f32 v242, v242, v241
    v_accvgpr_write_b32 a182, v242
    v_accvgpr_read_b32 v243, a183
    v_mul_f32 v243, v243, v241
    v_accvgpr_write_b32 a183, v243
    v_accvgpr_read_b32 v244, a184
    v_mul_f32 v244, v244, v241
    v_accvgpr_write_b32 a184, v244
    v_accvgpr_read_b32 v245, a185
    v_mul_f32 v245, v245, v241
    v_accvgpr_write_b32 a185, v245
    v_accvgpr_read_b32 v246, a186
    v_mul_f32 v246, v246, v241
    v_accvgpr_write_b32 a186, v246
    v_accvgpr_read_b32 v247, a187
    v_mul_f32 v247, v247, v241
    v_accvgpr_write_b32 a187, v247
    v_accvgpr_read_b32 v242, a188
    v_mul_f32 v242, v242, v241
    v_accvgpr_write_b32 a188, v242
    v_accvgpr_read_b32 v243, a189
    v_mul_f32 v243, v243, v241
    v_accvgpr_write_b32 a189, v243
    v_accvgpr_read_b32 v244, a190
    v_mul_f32 v244, v244, v241
    v_accvgpr_write_b32 a190, v244
    v_accvgpr_read_b32 v245, a191
    v_mul_f32 v245, v245, v241
    v_accvgpr_write_b32 a191, v245
    s_nop 15
    s_branch L_back1
L_rare2:
    s_nop 15
    s_nop 15
    v_sub_f32 v233, v225, v232
    v_mul_f32 v233, s32, v233
    v_exp_f32 v233, v233
    v_mov_b32 v225, v232
    v_mul_f32 v229, s32, v232
    v_mul_f32 v227, v227, v233
    v_accvgpr_read_b32 v234, a64
    v_mul_f32 v234, v234, v233
    v_accvgpr_write_b32 a64, v234
    v_accvgpr_read_b32 v235, a65
    v_mul_f32 v235, v235, v233
    v_accvgpr_write_b32 a65, v235
    v_accvgpr_read_b32 v236, a66
    v_mul_f32 v236, v236, v233
    v_accvgpr_write_b32 a66, v236
    v_accvgpr_read_b32 v237, a67
    v_mul_f32 v237, v237, v233
    v_accvgpr_write_b32 a67, v237
    v_accvgpr_read_b32 v238, a68
    v_mul_f32 v238, v238, v233
    v_accvgpr_write_b32 a68, v238
    v_accvgpr_read_b32 v239, a69
    v_mul_f32 v239, v239, v233
    v_accvgpr_write_b32 a69, v239
    v_accvgpr_read_b32 v234, a70
    v_mul_f32 v234, v234, v233
    v_accvgpr_write_b32 a70, v234
    v_accvgpr_read_b32 v235, a71
    v_mul_f32 v235, v235, v233
    v_accvgpr_write_b32 a71, v235
    v_accvgpr_read_b32 v236, a72
    v_mul_f32 v236, v236, v233
    v_accvgpr_write_b32 a72, v236
    v_accvgpr_read_b32 v237, a73
    v_mul_f32 v237, v237, v233
    v_accvgpr_write_b32 a73, v237
    v_accvgpr_read_b32 v238, a74
    v_mul_f32 v238, v238, v233
    v_accvgpr_write_b32 a74, v238
    v_accvgpr_read_b32 v239, a75
    v_mul_f32 v239, v239, v233
    v_accvgpr_write_b32 a75, v239
    v_accvgpr_read_b32 v234, a76
    v_mul_f32 v234, v234, v233
    v_accvgpr_write_b32 a76, v234
    v_accvgpr_read_b32 v235, a77
    v_mul_f32 v235, v235, v233
    v_accvgpr_write_b32 a77, v235
    v_accvgpr_read_b32 v236, a78
    v_mul_f32 v236, v236, v233
    v_accvgpr_write_b32 a78, v236
    v_accvgpr_read_b32 v237, a79
    v_mul_f32 v237, v237, v233
    v_accvgpr_write_b32 a79, v237
    v_accvgpr_read_b32 v238, a80
    v_mul_f32 v238, v238, v233
    v_accvgpr_write_b32 a80, v238
    v_accvgpr_read_b32 v239, a81
    v_mul_f32 v239, v239, v233
    v_accvgpr_write_b32 a81, v239
    v_accvgpr_read_b32 v234, a82
    v_mul_f32 v234, v234, v233
    v_accvgpr_write_b32 a82, v234
    v_accvgpr_read_b32 v235, a83
    v_mul_f32 v235, v235, v233
    v_accvgpr_write_b32 a83, v235
    v_accvgpr_read_b32 v236, a84
    v_mul_f32 v236, v236, v233
    v_accvgpr_write_b32 a84, v236
    v_accvgpr_read_b32 v237, a85
    v_mul_f32 v237, v237, v233
    v_accvgpr_write_b32 a85, v237
    v_accvgpr_read_b32 v238, a86
    v_mul_f32 v238, v238, v233
    v_accvgpr_write_b32 a86, v238
    v_accvgpr_read_b32 v239, a87
    v_mul_f32 v239, v239, v233
    v_accvgpr_write_b32 a87, v239
    v_accvgpr_read_b32 v234, a88
    v_mul_f32 v234, v234, v233
    v_accvgpr_write_b32 a88, v234
    v_accvgpr_read_b32 v235, a89
    v_mul_f32 v235, v235, v233
    v_accvgpr_write_b32 a89, v235
    v_accvgpr_read_b32 v236, a90
    v_mul_f32 v236, v236, v233
    v_accvgpr_write_b32 a90, v236
    v_accvgpr_read_b32 v237, a91
    v_mul_f32 v237, v237, v233
    v_accvgpr_write_b32 a91, v237
    v_accvgpr_read_b32 v238, a92
    v_mul_f32 v238, v238, v233
    v_accvgpr_write_b32 a92, v238
    v_accvgpr_read_b32 v239, a93
    v_mul_f32 v239, v239, v233
    v_accvgpr_write_b32 a93, v239
    v_accvgpr_read_b32 v234, a94
    v_mul_f32 v234, v234, v233
    v_accvgpr_write_b32 a94, v234
    v_accvgpr_read_b32 v235, a95
    v_mul_f32 v235, v235, v233
    v_accvgpr_write_b32 a95, v235
    v_accvgpr_read_b32 v236, a96
    v_mul_f32 v236, v236, v233
    v_accvgpr_write_b32 a96, v236
    v_accvgpr_read_b32 v237, a97
    v_mul_f32 v237, v237, v233
    v_accvgpr_write_b32 a97, v237
    v_accvgpr_read_b32 v238, a98
    v_mul_f32 v238, v238, v233
    v_accvgpr_write_b32 a98, v238
    v_accvgpr_read_b32 v239, a99
    v_mul_f32 v239, v239, v233
    v_accvgpr_write_b32 a99, v239
    v_accvgpr_read_b32 v234, a100
    v_mul_f32 v234, v234, v233
    v_accvgpr_write_b32 a100, v234
    v_accvgpr_read_b32 v235, a101
    v_mul_f32 v235, v235, v233
    v_accvgpr_write_b32 a101, v235
    v_accvgpr_read_b32 v236, a102
    v_mul_f32 v236, v236, v233
    v_accvgpr_write_b32 a102, v236
    v_accvgpr_read_b32 v237, a103
    v_mul_f32 v237, v237, v233
    v_accvgpr_write_b32 a103, v237
    v_accvgpr_read_b32 v238, a104
    v_mul_f32 v238, v238, v233
    v_accvgpr_write_b32 a104, v238
    v_accvgpr_read_b32 v239, a105
    v_mul_f32 v239, v239, v233
    v_accvgpr_write_b32 a105, v239
    v_accvgpr_read_b32 v234, a106
    v_mul_f32 v234, v234, v233
    v_accvgpr_write_b32 a106, v234
    v_accvgpr_read_b32 v235, a107
    v_mul_f32 v235, v235, v233
    v_accvgpr_write_b32 a107, v235
    v_accvgpr_read_b32 v236, a108
    v_mul_f32 v236, v236, v233
    v_accvgpr_write_b32 a108, v236
    v_accvgpr_read_b32 v237, a109
    v_mul_f32 v237, v237, v233
    v_accvgpr_write_b32 a109, v237
    v_accvgpr_read_b32 v238, a110
    v_mul_f32 v238, v238, v233
    v_accvgpr_write_b32 a110, v238
    v_accvgpr_read_b32 v239, a111
    v_mul_f32 v239, v239, v233
    v_accvgpr_write_b32 a111, v239
    v_accvgpr_read_b32 v234, a112
    v_mul_f32 v234, v234, v233
    v_accvgpr_write_b32 a112, v234
    v_accvgpr_read_b32 v235, a113
    v_mul_f32 v235, v235, v233
    v_accvgpr_write_b32 a113, v235
    v_accvgpr_read_b32 v236, a114
    v_mul_f32 v236, v236, v233
    v_accvgpr_write_b32 a114, v236
    v_accvgpr_read_b32 v237, a115
    v_mul_f32 v237, v237, v233
    v_accvgpr_write_b32 a115, v237
    v_accvgpr_read_b32 v238, a116
    v_mul_f32 v238, v238, v233
    v_accvgpr_write_b32 a116, v238
    v_accvgpr_read_b32 v239, a117
    v_mul_f32 v239, v239, v233
    v_accvgpr_write_b32 a117, v239
    v_accvgpr_read_b32 v234, a118
    v_mul_f32 v234, v234, v233
    v_accvgpr_write_b32 a118, v234
    v_accvgpr_read_b32 v235, a119
    v_mul_f32 v235, v235, v233
    v_accvgpr_write_b32 a119, v235
    v_accvgpr_read_b32 v236, a120
    v_mul_f32 v236, v236, v233
    v_accvgpr_write_b32 a120, v236
    v_accvgpr_read_b32 v237, a121
    v_mul_f32 v237, v237, v233
    v_accvgpr_write_b32 a121, v237
    v_accvgpr_read_b32 v238, a122
    v_mul_f32 v238, v238, v233
    v_accvgpr_write_b32 a122, v238
    v_accvgpr_read_b32 v239, a123
    v_mul_f32 v239, v239, v233
    v_accvgpr_write_b32 a123, v239
    v_accvgpr_read_b32 v234, a124
    v_mul_f32 v234, v234, v233
    v_accvgpr_write_b32 a124, v234
    v_accvgpr_read_b32 v235, a125
    v_mul_f32 v235, v235, v233
    v_accvgpr_write_b32 a125, v235
    v_accvgpr_read_b32 v236, a126
    v_mul_f32 v236, v236, v233
    v_accvgpr_write_b32 a126, v236
    v_accvgpr_read_b32 v237, a127
    v_mul_f32 v237, v237, v233
    v_accvgpr_write_b32 a127, v237
    v_sub_f32 v241, v226, v240
    v_mul_f32 v241, s32, v241
    v_exp_f32 v241, v241
    v_mov_b32 v226, v240
    v_mul_f32 v230, s32, v240
    v_mul_f32 v228, v228, v241
    v_accvgpr_read_b32 v242, a128
    v_mul_f32 v242, v242, v241
    v_accvgpr_write_b32 a128, v242
    v_accvgpr_read_b32 v243, a129
    v_mul_f32 v243, v243, v241
    v_accvgpr_write_b32 a129, v243
    v_accvgpr_read_b32 v244, a130
    v_mul_f32 v244, v244, v241
    v_accvgpr_write_b32 a130, v244
    v_accvgpr_read_b32 v245, a131
    v_mul_f32 v245, v245, v241
    v_accvgpr_write_b32 a131, v245
    v_accvgpr_read_b32 v246, a132
    v_mul_f32 v246, v246, v241
    v_accvgpr_write_b32 a132, v246
    v_accvgpr_read_b32 v247, a133
    v_mul_f32 v247, v247, v241
    v_accvgpr_write_b32 a133, v247
    v_accvgpr_read_b32 v242, a134
    v_mul_f32 v242, v242, v241
    v_accvgpr_write_b32 a134, v242
    v_accvgpr_read_b32 v243, a135
    v_mul_f32 v243, v243, v241
    v_accvgpr_write_b32 a135, v243
    v_accvgpr_read_b32 v244, a136
    v_mul_f32 v244, v244, v241
    v_accvgpr_write_b32 a136, v244
    v_accvgpr_read_b32 v245, a137
    v_mul_f32 v245, v245, v241
    v_accvgpr_write_b32 a137, v245
    v_accvgpr_read_b32 v246, a138
    v_mul_f32 v246, v246, v241
    v_accvgpr_write_b32 a138, v246
    v_accvgpr_read_b32 v247, a139
    v_mul_f32 v247, v247, v241
    v_accvgpr_write_b32 a139, v247
    v_accvgpr_read_b32 v242, a140
    v_mul_f32 v242, v242, v241
    v_accvgpr_write_b32 a140, v242
    v_accvgpr_read_b32 v243, a141
    v_mul_f32 v243, v243, v241
    v_accvgpr_write_b32 a141, v243
    v_accvgpr_read_b32 v244, a142
    v_mul_f32 v244, v244, v241
    v_accvgpr_write_b32 a142, v244
    v_accvgpr_read_b32 v245, a143
    v_mul_f32 v245, v245, v241
    v_accvgpr_write_b32 a143, v245
    v_accvgpr_read_b32 v246, a144
    v_mul_f32 v246, v246, v241
    v_accvgpr_write_b32 a144, v246
    v_accvgpr_read_b32 v247, a145
    v_mul_f32 v247, v247, v241
    v_accvgpr_write_b32 a145, v247
    v_accvgpr_read_b32 v242, a146
    v_mul_f32 v242, v242, v241
    v_accvgpr_write_b32 a146, v242
    v_accvgpr_read_b32 v243, a147
    v_mul_f32 v243, v243, v241
    v_accvgpr_write_b32 a147, v243
    v_accvgpr_read_b32 v244, a148
    v_mul_f32 v244, v244, v241
    v_accvgpr_write_b32 a148, v244
    v_accvgpr_read_b32 v245, a149
    v_mul_f32 v245, v245, v241
    v_accvgpr_write_b32 a149, v245
    v_accvgpr_read_b32 v246, a150
    v_mul_f32 v246, v246, v241
    v_accvgpr_write_b32 a150, v246
    v_accvgpr_read_b32 v247, a151
    v_mul_f32 v247, v247, v241
    v_accvgpr_write_b32 a151, v247
    v_accvgpr_read_b32 v242, a152
    v_mul_f32 v242, v242, v241
    v_accvgpr_write_b32 a152, v242
    v_accvgpr_read_b32 v243, a153
    v_mul_f32 v243, v243, v241
    v_accvgpr_write_b32 a153, v243
    v_accvgpr_read_b32 v244, a154
    v_mul_f32 v244, v244, v241
    v_accvgpr_write_b32 a154, v244
    v_accvgpr_read_b32 v245, a155
    v_mul_f32 v245, v245, v241
    v_accvgpr_write_b32 a155, v245
    v_accvgpr_read_b32 v246, a156
    v_mul_f32 v246, v246, v241
    v_accvgpr_write_b32 a156, v246
    v_accvgpr_read_b32 v247, a157
    v_mul_f32 v247, v247, v241
    v_accvgpr_write_b32 a157, v247
    v_accvgpr_read_b32 v242, a158
    v_mul_f32 v242, v242, v241
    v_accvgpr_write_b32 a158, v242
    v_accvgpr_read_b32 v243, a159
    v_mul_f32 v243, v243, v241
    v_accvgpr_write_b32 a159, v243
    v_accvgpr_read_b32 v244, a160
    v_mul_f32 v244, v244, v241
    v_accvgpr_write_b32 a160, v244
    v_accvgpr_read_b32 v245, a161
    v_mul_f32 v245, v245, v241
    v_accvgpr_write_b32 a161, v245
    v_accvgpr_read_b32 v246, a162
    v_mul_f32 v246, v246, v241
    v_accvgpr_write_b32 a162, v246
    v_accvgpr_read_b32 v247, a163
    v_mul_f32 v247, v247, v241
    v_accvgpr_write_b32 a163, v247
    v_accvgpr_read_b32 v242, a164
    v_mul_f32 v242, v242, v241
    v_accvgpr_write_b32 a164, v242
    v_accvgpr_read_b32 v243, a165
    v_mul_f32 v243, v243, v241
    v_accvgpr_write_b32 a165, v243
    v_accvgpr_read_b32 v244, a166
    v_mul_f32 v244, v244, v241
    v_accvgpr_write_b32 a166, v244
    v_accvgpr_read_b32 v245, a167
    v_mul_f32 v245, v245, v241
    v_accvgpr_write_b32 a167, v245
    v_accvgpr_read_b32 v246, a168
    v_mul_f32 v246, v246, v241
    v_accvgpr_write_b32 a168, v246
    v_accvgpr_read_b32 v247, a169
    v_mul_f32 v247, v247, v241
    v_accvgpr_write_b32 a169, v247
    v_accvgpr_read_b32 v242, a170
    v_mul_f32 v242, v242, v241
    v_accvgpr_write_b32 a170, v242
    v_accvgpr_read_b32 v243, a171
    v_mul_f32 v243, v243, v241
    v_accvgpr_write_b32 a171, v243
    v_accvgpr_read_b32 v244, a172
    v_mul_f32 v244, v244, v241
    v_accvgpr_write_b32 a172, v244
    v_accvgpr_read_b32 v245, a173
    v_mul_f32 v245, v245, v241
    v_accvgpr_write_b32 a173, v245
    v_accvgpr_read_b32 v246, a174
    v_mul_f32 v246, v246, v241
    v_accvgpr_write_b32 a174, v246
    v_accvgpr_read_b32 v247, a175
    v_mul_f32 v247, v247, v241
    v_accvgpr_write_b32 a175, v247
    v_accvgpr_read_b32 v242, a176
    v_mul_f32 v242, v242, v241
    v_accvgpr_write_b32 a176, v242
    v_accvgpr_read_b32 v243, a177
    v_mul_f32 v243, v243, v241
    v_accvgpr_write_b32 a177, v243
    v_accvgpr_read_b32 v244, a178
    v_mul_f32 v244, v244, v241
    v_accvgpr_write_b32 a178, v244
    v_accvgpr_read_b32 v245, a179
    v_mul_f32 v245, v245, v241
    v_accvgpr_write_b32 a179, v245
    v_accvgpr_read_b32 v246, a180
    v_mul_f32 v246, v246, v241
    v_accvgpr_write_b32 a180, v246
    v_accvgpr_read_b32 v247, a181
    v_mul_f32 v247, v247, v241
    v_accvgpr_write_b32 a181, v247
    v_accvgpr_read_b32 v242, a182
    v_mul_f32 v242, v242, v241
    v_accvgpr_write_b32 a182, v242
    v_accvgpr_read_b32 v243, a183
    v_mul_f32 v243, v243, v241
    v_accvgpr_write_b32 a183, v243
    v_accvgpr_read_b32 v244, a184
    v_mul_f32 v244, v244, v241
    v_accvgpr_write_b32 a184, v244
    v_accvgpr_read_b32 v245, a185
    v_mul_f32 v245, v245, v241
    v_accvgpr_write_b32 a185, v245
    v_accvgpr_read_b32 v246, a186
    v_mul_f32 v246, v246, v241
    v_accvgpr_write_b32 a186, v246
    v_accvgpr_read_b32 v247, a187
    v_mul_f32 v247, v247, v241
    v_accvgpr_write_b32 a187, v247
    v_accvgpr_read_b32 v242, a188
    v_mul_f32 v242, v242, v241
    v_accvgpr_write_b32 a188, v242
    v_accvgpr_read_b32 v243, a189
    v_mul_f32 v243, v243, v241
    v_accvgpr_write_b32 a189, v243
    v_accvgpr_read_b32 v244, a190
    v_mul_f32 v244, v244, v241
    v_accvgpr_write_b32 a190, v244
    v_accvgpr_read_b32 v245, a191
    v_mul_f32 v245, v245, v241
    v_accvgpr_write_b32 a191, v245
    s_nop 15
    s_branch L_back2
L_rare3:
    s_nop 15
    s_nop 15
    v_sub_f32 v233, v225, v232
    v_mul_f32 v233, s32, v233
    v_exp_f32 v233, v233
    v_mov_b32 v225, v232
    v_mul_f32 v229, s32, v232
    v_mul_f32 v227, v227, v233
    v_accvgpr_read_b32 v234, a64
    v_mul_f32 v234, v234, v233
    v_accvgpr_write_b32 a64, v234
    v_accvgpr_read_b32 v235, a65
    v_mul_f32 v235, v235, v233
    v_accvgpr_write_b32 a65, v235
    v_accvgpr_read_b32 v236, a66
    v_mul_f32 v236, v236, v233
    v_accvgpr_write_b32 a66, v236
    v_accvgpr_read_b32 v237, a67
    v_mul_f32 v237, v237, v233
    v_accvgpr_write_b32 a67, v237
    v_accvgpr_read_b32 v238, a68
    v_mul_f32 v238, v238, v233
    v_accvgpr_write_b32 a68, v238
    v_accvgpr_read_b32 v239, a69
    v_mul_f32 v239, v239, v233
    v_accvgpr_write_b32 a69, v239
    v_accvgpr_read_b32 v234, a70
    v_mul_f32 v234, v234, v233
    v_accvgpr_write_b32 a70, v234
    v_accvgpr_read_b32 v235, a71
    v_mul_f32 v235, v235, v233
    v_accvgpr_write_b32 a71, v235
    v_accvgpr_read_b32 v236, a72
    v_mul_f32 v236, v236, v233
    v_accvgpr_write_b32 a72, v236
    v_accvgpr_read_b32 v237, a73
    v_mul_f32 v237, v237, v233
    v_accvgpr_write_b32 a73, v237
    v_accvgpr_read_b32 v238, a74
    v_mul_f32 v238, v238, v233
    v_accvgpr_write_b32 a74, v238
    v_accvgpr_read_b32 v239, a75
    v_mul_f32 v239, v239, v233
    v_accvgpr_write_b32 a75, v239
    v_accvgpr_read_b32 v234, a76
    v_mul_f32 v234, v234, v233
    v_accvgpr_write_b32 a76, v234
    v_accvgpr_read_b32 v235, a77
    v_mul_f32 v235, v235, v233
    v_accvgpr_write_b32 a77, v235
    v_accvgpr_read_b32 v236, a78
    v_mul_f32 v236, v236, v233
    v_accvgpr_write_b32 a78, v236
    v_accvgpr_read_b32 v237, a79
    v_mul_f32 v237, v237, v233
    v_accvgpr_write_b32 a79, v237
    v_accvgpr_read_b32 v238, a80
    v_mul_f32 v238, v238, v233
    v_accvgpr_write_b32 a80, v238
    v_accvgpr_read_b32 v239, a81
    v_mul_f32 v239, v239, v233
    v_accvgpr_write_b32 a81, v239
    v_accvgpr_read_b32 v234, a82
    v_mul_f32 v234, v234, v233
    v_accvgpr_write_b32 a82, v234
    v_accvgpr_read_b32 v235, a83
    v_mul_f32 v235, v235, v233
    v_accvgpr_write_b32 a83, v235
    v_accvgpr_read_b32 v236, a84
    v_mul_f32 v236, v236, v233
    v_accvgpr_write_b32 a84, v236
    v_accvgpr_read_b32 v237, a85
    v_mul_f32 v237, v237, v233
    v_accvgpr_write_b32 a85, v237
    v_accvgpr_read_b32 v238, a86
    v_mul_f32 v238, v238, v233
    v_accvgpr_write_b32 a86, v238
    v_accvgpr_read_b32 v239, a87
    v_mul_f32 v239, v239, v233
    v_accvgpr_write_b32 a87, v239
    v_accvgpr_read_b32 v234, a88
    v_mul_f32 v234, v234, v233
    v_accvgpr_write_b32 a88, v234
    v_accvgpr_read_b32 v235, a89
    v_mul_f32 v235, v235, v233
    v_accvgpr_write_b32 a89, v235
    v_accvgpr_read_b32 v236, a90
    v_mul_f32 v236, v236, v233
    v_accvgpr_write_b32 a90, v236
    v_accvgpr_read_b32 v237, a91
    v_mul_f32 v237, v237, v233
    v_accvgpr_write_b32 a91, v237
    v_accvgpr_read_b32 v238, a92
    v_mul_f32 v238, v238, v233
    v_accvgpr_write_b32 a92, v238
    v_accvgpr_read_b32 v239, a93
    v_mul_f32 v239, v239, v233
    v_accvgpr_write_b32 a93, v239
    v_accvgpr_read_b32 v234, a94
    v_mul_f32 v234, v234, v233
    v_accvgpr_write_b32 a94, v234
    v_accvgpr_read_b32 v235, a95
    v_mul_f32 v235, v235, v233
    v_accvgpr_write_b32 a95, v235
    v_accvgpr_read_b32 v236, a96
    v_mul_f32 v236, v236, v233
    v_accvgpr_write_b32 a96, v236
    v_accvgpr_read_b32 v237, a97
    v_mul_f32 v237, v237, v233
    v_accvgpr_write_b32 a97, v237
    v_accvgpr_read_b32 v238, a98
    v_mul_f32 v238, v238, v233
    v_accvgpr_write_b32 a98, v238
    v_accvgpr_read_b32 v239, a99
    v_mul_f32 v239, v239, v233
    v_accvgpr_write_b32 a99, v239
    v_accvgpr_read_b32 v234, a100
    v_mul_f32 v234, v234, v233
    v_accvgpr_write_b32 a100, v234
    v_accvgpr_read_b32 v235, a101
    v_mul_f32 v235, v235, v233
    v_accvgpr_write_b32 a101, v235
    v_accvgpr_read_b32 v236, a102
    v_mul_f32 v236, v236, v233
    v_accvgpr_write_b32 a102, v236
    v_accvgpr_read_b32 v237, a103
    v_mul_f32 v237, v237, v233
    v_accvgpr_write_b32 a103, v237
    v_accvgpr_read_b32 v238, a104
    v_mul_f32 v238, v238, v233
    v_accvgpr_write_b32 a104, v238
    v_accvgpr_read_b32 v239, a105
    v_mul_f32 v239, v239, v233
    v_accvgpr_write_b32 a105, v239
    v_accvgpr_read_b32 v234, a106
    v_mul_f32 v234, v234, v233
    v_accvgpr_write_b32 a106, v234
    v_accvgpr_read_b32 v235, a107
    v_mul_f32 v235, v235, v233
    v_accvgpr_write_b32 a107, v235
    v_accvgpr_read_b32 v236, a108
    v_mul_f32 v236, v236, v233
    v_accvgpr_write_b32 a108, v236
    v_accvgpr_read_b32 v237, a109
    v_mul_f32 v237, v237, v233
    v_accvgpr_write_b32 a109, v237
    v_accvgpr_read_b32 v238, a110
    v_mul_f32 v238, v238, v233
    v_accvgpr_write_b32 a110, v238
    v_accvgpr_read_b32 v239, a111
    v_mul_f32 v239, v239, v233
    v_accvgpr_write_b32 a111, v239
    v_accvgpr_read_b32 v234, a112
    v_mul_f32 v234, v234, v233
    v_accvgpr_write_b32 a112, v234
    v_accvgpr_read_b32 v235, a113
    v_mul_f32 v235, v235, v233
    v_accvgpr_write_b32 a113, v235
    v_accvgpr_read_b32 v236, a114
    v_mul_f32 v236, v236, v233
    v_accvgpr_write_b32 a114, v236
    v_accvgpr_read_b32 v237, a115
    v_mul_f32 v237, v237, v233
    v_accvgpr_write_b32 a115, v237
    v_accvgpr_read_b32 v238, a116
    v_mul_f32 v238, v238, v233
    v_accvgpr_write_b32 a116, v238
    v_accvgpr_read_b32 v239, a117
    v_mul_f32 v239, v239, v233
    v_accvgpr_write_b32 a117, v239
    v_accvgpr_read_b32 v234, a118
    v_mul_f32 v234, v234, v233
    v_accvgpr_write_b32 a118, v234
    v_accvgpr_read_b32 v235, a119
    v_mul_f32 v235, v235, v233
    v_accvgpr_write_b32 a119, v235
    v_accvgpr_read_b32 v236, a120
    v_mul_f32 v236, v236, v233
    v_accvgpr_write_b32 a120, v236
    v_accvgpr_read_b32 v237, a121
    v_mul_f32 v237, v237, v233
    v_accvgpr_write_b32 a121, v237
    v_accvgpr_read_b32 v238, a122
    v_mul_f32 v238, v238, v233
    v_accvgpr_write_b32 a122, v238
    v_accvgpr_read_b32 v239, a123
    v_mul_f32 v239, v239, v233
    v_accvgpr_write_b32 a123, v239
    v_accvgpr_read_b32 v234, a124
    v_mul_f32 v234, v234, v233
    v_accvgpr_write_b32 a124, v234
    v_accvgpr_read_b32 v235, a125
    v_mul_f32 v235, v235, v233
    v_accvgpr_write_b32 a125, v235
    v_accvgpr_read_b32 v236, a126
    v_mul_f32 v236, v236, v233
    v_accvgpr_write_b32 a126, v236
    v_accvgpr_read_b32 v237, a127
    v_mul_f32 v237, v237, v233
    v_accvgpr_write_b32 a127, v237
    v_sub_f32 v241, v226, v240
    v_mul_f32 v241, s32, v241
    v_exp_f32 v241, v241
    v_mov_b32 v226, v240
    v_mul_f32 v230, s32, v240
    v_mul_f32 v228, v228, v241
    v_accvgpr_read_b32 v242, a128
    v_mul_f32 v242, v242, v241
    v_accvgpr_write_b32 a128, v242
    v_accvgpr_read_b32 v243, a129
    v_mul_f32 v243, v243, v241
    v_accvgpr_write_b32 a129, v243
    v_accvgpr_read_b32 v244, a130
    v_mul_f32 v244, v244, v241
    v_accvgpr_write_b32 a130, v244
    v_accvgpr_read_b32 v245, a131
    v_mul_f32 v245, v245, v241
    v_accvgpr_write_b32 a131, v245
    v_accvgpr_read_b32 v246, a132
    v_mul_f32 v246, v246, v241
    v_accvgpr_write_b32 a132, v246
    v_accvgpr_read_b32 v247, a133
    v_mul_f32 v247, v247, v241
    v_accvgpr_write_b32 a133, v247
    v_accvgpr_read_b32 v242, a134
    v_mul_f32 v242, v242, v241
    v_accvgpr_write_b32 a134, v242
    v_accvgpr_read_b32 v243, a135
    v_mul_f32 v243, v243, v241
    v_accvgpr_write_b32 a135, v243
    v_accvgpr_read_b32 v244, a136
    v_mul_f32 v244, v244, v241
    v_accvgpr_write_b32 a136, v244
    v_accvgpr_read_b32 v245, a137
    v_mul_f32 v245, v245, v241
    v_accvgpr_write_b32 a137, v245
    v_accvgpr_read_b32 v246, a138
    v_mul_f32 v246, v246, v241
    v_accvgpr_write_b32 a138, v246
    v_accvgpr_read_b32 v247, a139
    v_mul_f32 v247, v247, v241
    v_accvgpr_write_b32 a139, v247
    v_accvgpr_read_b32 v242, a140
    v_mul_f32 v242, v242, v241
    v_accvgpr_write_b32 a140, v242
    v_accvgpr_read_b32 v243, a141
    v_mul_f32 v243, v243, v241
    v_accvgpr_write_b32 a141, v243
    v_accvgpr_read_b32 v244, a142
    v_mul_f32 v244, v244, v241
    v_accvgpr_write_b32 a142, v244
    v_accvgpr_read_b32 v245, a143
    v_mul_f32 v245, v245, v241
    v_accvgpr_write_b32 a143, v245
    v_accvgpr_read_b32 v246, a144
    v_mul_f32 v246, v246, v241
    v_accvgpr_write_b32 a144, v246
    v_accvgpr_read_b32 v247, a145
    v_mul_f32 v247, v247, v241
    v_accvgpr_write_b32 a145, v247
    v_accvgpr_read_b32 v242, a146
    v_mul_f32 v242, v242, v241
    v_accvgpr_write_b32 a146, v242
    v_accvgpr_read_b32 v243, a147
    v_mul_f32 v243, v243, v241
    v_accvgpr_write_b32 a147, v243
    v_accvgpr_read_b32 v244, a148
    v_mul_f32 v244, v244, v241
    v_accvgpr_write_b32 a148, v244
    v_accvgpr_read_b32 v245, a149
    v_mul_f32 v245, v245, v241
    v_accvgpr_write_b32 a149, v245
    v_accvgpr_read_b32 v246, a150
    v_mul_f32 v246, v246, v241
    v_accvgpr_write_b32 a150, v246
    v_accvgpr_read_b32 v247, a151
    v_mul_f32 v247, v247, v241
    v_accvgpr_write_b32 a151, v247
    v_accvgpr_read_b32 v242, a152
    v_mul_f32 v242, v242, v241
    v_accvgpr_write_b32 a152, v242
    v_accvgpr_read_b32 v243, a153
    v_mul_f32 v243, v243, v241
    v_accvgpr_write_b32 a153, v243
    v_accvgpr_read_b32 v244, a154
    v_mul_f32 v244, v244, v241
    v_accvgpr_write_b32 a154, v244
    v_accvgpr_read_b32 v245, a155
    v_mul_f32 v245, v245, v241
    v_accvgpr_write_b32 a155, v245
    v_accvgpr_read_b32 v246, a156
    v_mul_f32 v246, v246, v241
    v_accvgpr_write_b32 a156, v246
    v_accvgpr_read_b32 v247, a157
    v_mul_f32 v247, v247, v241
    v_accvgpr_write_b32 a157, v247
    v_accvgpr_read_b32 v242, a158
    v_mul_f32 v242, v242, v241
    v_accvgpr_write_b32 a158, v242
    v_accvgpr_read_b32 v243, a159
    v_mul_f32 v243, v243, v241
    v_accvgpr_write_b32 a159, v243
    v_accvgpr_read_b32 v244, a160
    v_mul_f32 v244, v244, v241
    v_accvgpr_write_b32 a160, v244
    v_accvgpr_read_b32 v245, a161
    v_mul_f32 v245, v245, v241
    v_accvgpr_write_b32 a161, v245
    v_accvgpr_read_b32 v246, a162
    v_mul_f32 v246, v246, v241
    v_accvgpr_write_b32 a162, v246
    v_accvgpr_read_b32 v247, a163
    v_mul_f32 v247, v247, v241
    v_accvgpr_write_b32 a163, v247
    v_accvgpr_read_b32 v242, a164
    v_mul_f32 v242, v242, v241
    v_accvgpr_write_b32 a164, v242
    v_accvgpr_read_b32 v243, a165
    v_mul_f32 v243, v243, v241
    v_accvgpr_write_b32 a165, v243
    v_accvgpr_read_b32 v244, a166
    v_mul_f32 v244, v244, v241
    v_accvgpr_write_b32 a166, v244
    v_accvgpr_read_b32 v245, a167
    v_mul_f32 v245, v245, v241
    v_accvgpr_write_b32 a167, v245
    v_accvgpr_read_b32 v246, a168
    v_mul_f32 v246, v246, v241
    v_accvgpr_write_b32 a168, v246
    v_accvgpr_read_b32 v247, a169
    v_mul_f32 v247, v247, v241
    v_accvgpr_write_b32 a169, v247
    v_accvgpr_read_b32 v242, a170
    v_mul_f32 v242, v242, v241
    v_accvgpr_write_b32 a170, v242
    v_accvgpr_read_b32 v243, a171
    v_mul_f32 v243, v243, v241
    v_accvgpr_write_b32 a171, v243
    v_accvgpr_read_b32 v244, a172
    v_mul_f32 v244, v244, v241
    v_accvgpr_write_b32 a172, v244
    v_accvgpr_read_b32 v245, a173
    v_mul_f32 v245, v245, v241
    v_accvgpr_write_b32 a173, v245
    v_accvgpr_read_b32 v246, a174
    v_mul_f32 v246, v246, v241
    v_accvgpr_write_b32 a174, v246
    v_accvgpr_read_b32 v247, a175
    v_mul_f32 v247, v247, v241
    v_accvgpr_write_b32 a175, v247
    v_accvgpr_read_b32 v242, a176
    v_mul_f32 v242, v242, v241
    v_accvgpr_write_b32 a176, v242
    v_accvgpr_read_b32 v243, a177
    v_mul_f32 v243, v243, v241
    v_accvgpr_write_b32 a177, v243
    v_accvgpr_read_b32 v244, a178
    v_mul_f32 v244, v244, v241
    v_accvgpr_write_b32 a178, v244
    v_accvgpr_read_b32 v245, a179
    v_mul_f32 v245, v245, v241
    v_accvgpr_write_b32 a179, v245
    v_accvgpr_read_b32 v246, a180
    v_mul_f32 v246, v246, v241
    v_accvgpr_write_b32 a180, v246
    v_accvgpr_read_b32 v247, a181
    v_mul_f32 v247, v247, v241
    v_accvgpr_write_b32 a181, v247
    v_accvgpr_read_b32 v242, a182
    v_mul_f32 v242, v242, v241
    v_accvgpr_write_b32 a182, v242
    v_accvgpr_read_b32 v243, a183
    v_mul_f32 v243, v243, v241
    v_accvgpr_write_b32 a183, v243
    v_accvgpr_read_b32 v244, a184
    v_mul_f32 v244, v244, v241
    v_accvgpr_write_b32 a184, v244
    v_accvgpr_read_b32 v245, a185
    v_mul_f32 v245, v245, v241
    v_accvgpr_write_b32 a185, v245
    v_accvgpr_read_b32 v246, a186
    v_mul_f32 v246, v246, v241
    v_accvgpr_write_b32 a186, v246
    v_accvgpr_read_b32 v247, a187
    v_mul_f32 v247, v247, v241
    v_accvgpr_write_b32 a187, v247
    v_accvgpr_read_b32 v242, a188
    v_mul_f32 v242, v242, v241
    v_accvgpr_write_b32 a188, v242
    v_accvgpr_read_b32 v243, a189
    v_mul_f32 v243, v243, v241
    v_accvgpr_write_b32 a189, v243
    v_accvgpr_read_b32 v244, a190
    v_mul_f32 v244, v244, v241
    v_accvgpr_write_b32 a190, v244
    v_accvgpr_read_b32 v245, a191
    v_mul_f32 v245, v245, v241
    v_accvgpr_write_b32 a191, v245
    s_nop 15
    s_branch L_back3
.globl oproj_kernel
.p2align 8
.type oproj_kernel,@function
oproj_kernel:
    s_cmp_ge_u32 s2, 256
    s_cbranch_scc1 L_oend
    s_and_b32 s34, s2, 7
    s_lshr_b32 s35, s2, 3
    s_lshr_b32 s37, s35, 3
    s_and_b32 s35, s35, 7
    s_lshr_b32 s36, s34, 2
    s_mul_i32 s29, s36, 40
    s_add_u32 s29, s29, 32
    s_load_dwordx2 s[4:5], s[0:1], s29
    s_load_dwordx2 s[6:7], s[0:1], 96
    s_load_dwordx2 s[8:9], s[0:1], 80
    s_waitcnt lgkmcnt(0)
    s_mul_i32 s38, s34, 480
    s_mul_i32 s29, s37, 120
    s_add_u32 s38, s38, s29
    s_mul_i32 s29, s35, 160
    s_add_u32 s12, s4, s29
    s_addc_u32 s13, s5, 0
    s_mov_b32 s14, 5241760
    s_mov_b32 s15, 131072
    s_lshl_b32 s29, s38, 13
    s_add_u32 s16, s6, s29
    s_addc_u32 s17, s7, 0
    s_mov_b32 s18, 983040
    s_mov_b32 s19, 131072
    s_mul_i32 s29, s36, 1920
    s_sub_u32 s29, s38, s29
    s_mul_i32 s29, s29, 2560
    s_mul_i32 s30, s36, 1280
    s_add_u32 s29, s29, s30
    s_mul_i32 s30, s35, 160
    s_add_u32 s29, s29, s30
    s_add_u32 s20, s8, s29
    s_addc_u32 s21, s9, 0
    s_mov_b32 s22, 304800
    s_mov_b32 s23, 131072
    v_and_b32 v194, 63, v0
    v_lshrrev_b32 v195, 6, v0
    s_nop 0
    v_readfirstlane_b32 s39, v195
    s_nop 0
    s_mul_i32 s31, s39, 20480
    v_lshlrev_b32 v196, 4, v194
    v_add_u32 v196, 0, v196
    v_mul_u32_u24 v197, 52429, v196
    v_lshrrev_b32 v197, 23, v197
    v_mul_u32_u24 v198, 160, v197
    v_sub_u32 v196, v196, v198
    v_mul_u32_u24 v197, 1280, v197
    v_add_u32 v184, v197, v196
    v_lshlrev_b32 v196, 4, v194
    v_add_u32 v196, 1024, v196
    v_mul_u32_u24 v197, 52429, v196
    v_lshrrev_b32 v197, 23, v197
    v_mul_u32_u24 v198, 160, v197
    v_sub_u32 v196, v196, v198
    v_mul_u32_u24 v197, 1280, v197
    v_add_u32 v185, v197, v196
    v_lshlrev_b32 v196, 4, v194
    v_add_u32 v196, 2048, v196
    v_mul_u32_u24 v197, 52429, v196
    v_lshrrev_b32 v197, 23, v197
    v_mul_u32_u24 v198, 160, v197
    v_sub_u32 v196, v196, v198
    v_mul_u32_u24 v197, 1280, v197
    v_add_u32 v186, v197, v196
    v_lshlrev_b32 v196, 4, v194
    v_add_u32 v196, 3072, v196
    v_mul_u32_u24 v197, 52429, v196
    v_lshrrev_b32 v197, 23, v197
    v_mul_u32_u24 v198, 160, v197
    v_sub_u32 v196, v196, v198
    v_mul_u32_u24 v197, 1280, v197
    v_add_u32 v187, v197, v196
    v_lshlrev_b32 v196, 4, v194
    v_add_u32 v196, 4096, v196
    v_mul_u32_u24 v197, 52429, v196
    v_lshrrev_b32 v197, 23, v197
    v_mul_u32_u24 v198, 160, v197
    v_sub_u32 v196, v196, v198
    v_mul_u32_u24 v197, 1280, v197
    v_add_u32 v188, v197, v196
    v_bfe_u32 v196, v194, 3, 1
    v_lshlrev_b32 v196, 16, v196
    v_lshrrev_b32 v197, 4, v194
    v_lshlrev_b32 v197, 7, v197
    v_add_u32 v196, v196, v197
    v_and_b32 v197, 7, v194
    v_lshlrev_b32 v197, 4, v197
    v_add_u32 v189, v196, v197
    v_bfe_u32 v196, v194, 4, 1
    v_lshlrev_b32 v196, 2, v196
    v_bfe_u32 v197, v194, 5, 1
    v_lshlrev_b32 v197, 4, v197
    v_add_u32 v196, v196, v197
    v_bfe_u32 v197, v194, 2, 2
    v_add_u32 v196, v196, v197
    v_mul_u32_u24 v196, 160, v196
    v_and_b32 v197, 3, v194
    v_lshlrev_b32 v197, 3, v197
    v_add_u32 v196, v196, v197
    v_add_u32 v190, s31, v196
    v_lshlrev_b32 v196, 5, v195
    v_and_b32 v197, 15, v194
    v_add_u32 v196, v196, v197
    v_mul_u32_u24 v196, 2560, v196
    v_lshrrev_b32 v197, 4, v194
    v_lshlrev_b32 v197, 3, v197
    v_add_u32 v191, v196, v197
    v_lshlrev_b32 v192, 4, v194
    v_add_u32 v193, 61440, v192
    s_mul_i32 s32, s39, 1310720
    s_lshl_b32 s33, s39, 14
    v_mov_b32 v194, 0
    v_accvgpr_write_b32 a0, v194
    v_accvgpr_write_b32 a1, v194
    v_accvgpr_write_b32 a2, v194
    v_accvgpr_write_b32 a3, v194
    v_accvgpr_write_b32 a4, v194
    v_accvgpr_write_b32 a5, v194
    v_accvgpr_write_b32 a6, v194
    v_accvgpr_write_b32 a7, v194
    v_accvgpr_write_b32 a8, v194
    v_accvgpr_write_b32 a9, v194
    v_accvgpr_write_b32 a10, v194
    v_accvgpr_write_b32 a11, v194
    v_accvgpr_write_b32 a12, v194
    v_accvgpr_write_b32 a13, v194
    v_accvgpr_write_b32 a14, v194
    v_accvgpr_write_b32 a15, v194
    v_accvgpr_write_b32 a16, v194
    v_accvgpr_write_b32 a17, v194
    v_accvgpr_write_b32 a18, v194
    v_accvgpr_write_b32 a19, v194
    v_accvgpr_write_b32 a20, v194
    v_accvgpr_write_b32 a21, v194
    v_accvgpr_write_b32 a22, v194
    v_accvgpr_write_b32 a23, v194
    v_accvgpr_write_b32 a24, v194
    v_accvgpr_write_b32 a25, v194
    v_accvgpr_write_b32 a26, v194
    v_accvgpr_write_b32 a27, v194
    v_accvgpr_write_b32 a28, v194
    v_accvgpr_write_b32 a29, v194
    v_accvgpr_write_b32 a30, v194
    v_accvgpr_write_b32 a31, v194
    v_accvgpr_write_b32 a32, v194
    v_accvgpr_write_b32 a33, v194
    v_accvgpr_write_b32 a34, v194
    v_accvgpr_write_b32 a35, v194
    v_accvgpr_write_b32 a36, v194
    v_accvgpr_write_b32 a37, v194
    v_accvgpr_write_b32 a38, v194
    v_accvgpr_write_b32 a39, v194
    v_accvgpr_write_b32 a40, v194
    v_accvgpr_write_b32 a41, v194
    v_accvgpr_write_b32 a42, v194
    v_accvgpr_write_b32 a43, v194
    v_accvgpr_write_b32 a44, v194
    v_accvgpr_write_b32 a45, v194
    v_accvgpr_write_b32 a46, v194
    v_accvgpr_write_b32 a47, v194
    v_accvgpr_write_b32 a48, v194
    v_accvgpr_write_b32 a49, v194
    v_accvgpr_write_b32 a50, v194
    v_accvgpr_write_b32 a51, v194
    v_accvgpr_write_b32 a52, v194
    v_accvgpr_write_b32 a53, v194
    v_accvgpr_write_b32 a54, v194
    v_accvgpr_write_b32 a55, v194
    v_accvgpr_write_b32 a56, v194
    v_accvgpr_write_b32 a57, v194
    v_accvgpr_write_b32 a58, v194
    v_accvgpr_write_b32 a59, v194
    v_accvgpr_write_b32 a60, v194
    v_accvgpr_write_b32 a61, v194
    v_accvgpr_write_b32 a62, v194
    v_accvgpr_write_b32 a63, v194
    v_accvgpr_write_b32 a64, v194
    v_accvgpr_write_b32 a65, v194
    v_accvgpr_write_b32 a66, v194
    v_accvgpr_write_b32 a67, v194
    v_accvgpr_write_b32 a68, v194
    v_accvgpr_write_b32 a69, v194
    v_accvgpr_write_b32 a70, v194
    v_accvgpr_write_b32 a71, v194
    v_accvgpr_write_b32 a72, v194
    v_accvgpr_write_b32 a73, v194
    v_accvgpr_write_b32 a74, v194
    v_accvgpr_write_b32 a75, v194
    v_accvgpr_write_b32 a76, v194
    v_accvgpr_write_b32 a77, v194
    v_accvgpr_write_b32 a78, v194
    v_accvgpr_write_b32 a79, v194
    v_accvgpr_write_b32 a80, v194
    v_accvgpr_write_b32 a81, v194
    v_accvgpr_write_b32 a82, v194
    v_accvgpr_write_b32 a83, v194
    v_accvgpr_write_b32 a84, v194
    v_accvgpr_write_b32 a85, v194
    v_accvgpr_write_b32 a86, v194
    v_accvgpr_write_b32 a87, v194
    v_accvgpr_write_b32 a88, v194
    v_accvgpr_write_b32 a89, v194
    v_accvgpr_write_b32 a90, v194
    v_accvgpr_write_b32 a91, v194
    v_accvgpr_write_b32 a92, v194
    v_accvgpr_write_b32 a93, v194
    v_accvgpr_write_b32 a94, v194
    v_accvgpr_write_b32 a95, v194
    v_accvgpr_write_b32 a96, v194
    v_accvgpr_write_b32 a97, v194
    v_accvgpr_write_b32 a98, v194
    v_accvgpr_write_b32 a99, v194
    v_accvgpr_write_b32 a100, v194
    v_accvgpr_write_b32 a101, v194
    v_accvgpr_write_b32 a102, v194
    v_accvgpr_write_b32 a103, v194
    v_accvgpr_write_b32 a104, v194
    v_accvgpr_write_b32 a105, v194
    v_accvgpr_write_b32 a106, v194
    v_accvgpr_write_b32 a107, v194
    v_accvgpr_write_b32 a108, v194
    v_accvgpr_write_b32 a109, v194
    v_accvgpr_write_b32 a110, v194
    v_accvgpr_write_b32 a111, v194
    v_accvgpr_write_b32 a112, v194
    v_accvgpr_write_b32 a113, v194
    v_accvgpr_write_b32 a114, v194
    v_accvgpr_write_b32 a115, v194
    v_accvgpr_write_b32 a116, v194
    v_accvgpr_write_b32 a117, v194
    v_accvgpr_write_b32 a118, v194
    v_accvgpr_write_b32 a119, v194
    v_accvgpr_write_b32 a120, v194
    v_accvgpr_write_b32 a121, v194
    v_accvgpr_write_b32 a122, v194
    v_accvgpr_write_b32 a123, v194
    v_accvgpr_write_b32 a124, v194
    v_accvgpr_write_b32 a125, v194
    v_accvgpr_write_b32 a126, v194
    v_accvgpr_write_b32 a127, v194
    v_accvgpr_write_b32 a128, v194
    v_accvgpr_write_b32 a129, v194
    v_accvgpr_write_b32 a130, v194
    v_accvgpr_write_b32 a131, v194
    v_accvgpr_write_b32 a132, v194
    v_accvgpr_write_b32 a133, v194
    v_accvgpr_write_b32 a134, v194
    v_accvgpr_write_b32 a135, v194
    v_accvgpr_write_b32 a136, v194
    v_accvgpr_write_b32 a137, v194
    v_accvgpr_write_b32 a138, v194
    v_accvgpr_write_b32 a139, v194
    v_accvgpr_write_b32 a140, v194
    v_accvgpr_write_b32 a141, v194
    v_accvgpr_write_b32 a142, v194
    v_accvgpr_write_b32 a143, v194
    v_accvgpr_write_b32 a144, v194
    v_accvgpr_write_b32 a145, v194
    v_accvgpr_write_b32 a146, v194
    v_accvgpr_write_b32 a147, v194
    v_accvgpr_write_b32 a148, v194
    v_accvgpr_write_b32 a149, v194
    v_accvgpr_write_b32 a150, v194
    v_accvgpr_write_b32 a151, v194
    v_accvgpr_write_b32 a152, v194
    v_accvgpr_write_b32 a153, v194
    v_accvgpr_write_b32 a154, v194
    v_accvgpr_write_b32 a155, v194
    v_accvgpr_write_b32 a156, v194
    v_accvgpr_write_b32 a157, v194
    v_accvgpr_write_b32 a158, v194
    v_accvgpr_write_b32 a159, v194
    s_add_u32 s29, s31, 0
    s_mov_b32 m0, s29
    s_nop 0
    buffer_load_dwordx4 v184, s[12:15], s32 offen lds
    s_add_u32 s29, s31, 1024
    s_mov_b32 m0, s29
    s_nop 0
    buffer_load_dwordx4 v185, s[12:15], s32 offen lds
    s_add_u32 s29, s31, 2048
    s_mov_b32 m0, s29
    s_nop 0
    buffer_load_dwordx4 v186, s[12:15], s32 offen lds
    s_add_u32 s29, s31, 3072
    s_mov_b32 m0, s29
    s_nop 0
    buffer_load_dwordx4 v187, s[12:15], s32 offen lds
    s_add_u32 s29, s31, 4096
    s_mov_b32 m0, s29
    s_nop 0
    buffer_load_dwordx4 v188, s[12:15], s32 offen lds
    s_add_u32 s32, s32, 40960
    s_add_u32 s29, s31, 5120
    s_mov_b32 m0, s29
    s_nop 0
    buffer_load_dwordx4 v184, s[12:15], s32 offen lds
    s_add_u32 s29, s31, 6144
    s_mov_b32 m0, s29
    s_nop 0
    buffer_load_dwordx4 v185, s[12:15], s32 offen lds
    s_add_u32 s29, s31, 7168
    s_mov_b32 m0, s29
    s_nop 0
    buffer_load_dwordx4 v186, s[12:15], s32 offen lds
    s_add_u32 s29, s31, 8192
    s_mov_b32 m0, s29
    s_nop 0
    buffer_load_dwordx4 v187, s[12:15], s32 offen lds
    s_add_u32 s29, s31, 9216
    s_mov_b32 m0, s29
    s_nop 0
    buffer_load_dwordx4 v188, s[12:15], s32 offen lds
    s_add_u32 s32, s32, 40960
    s_add_u32 s29, s31, 10240
    s_mov_b32 m0, s29
    s_nop 0
    buffer_load_dwordx4 v184, s[12:15], s32 offen lds
    s_add_u32 s29, s31, 11264
    s_mov_b32 m0, s29
    s_nop 0
    buffer_load_dwordx4 v185, s[12:15], s32 offen lds
    s_add_u32 s29, s31, 12288
    s_mov_b32 m0, s29
    s_nop 0
    buffer_load_dwordx4 v186, s[12:15], s32 offen lds
    s_add_u32 s29, s31, 13312
    s_mov_b32 m0, s29
    s_nop 0
    buffer_load_dwordx4 v187, s[12:15], s32 offen lds
    s_add_u32 s29, s31, 14336
    s_mov_b32 m0, s29
    s_nop 0
    buffer_load_dwordx4 v188, s[12:15], s32 offen lds
    s_add_u32 s32, s32, 40960
    s_add_u32 s30, s33, 0
    buffer_load_dwordx4 v[56:59], v189, s[16:19], s30 offen
    s_add_u32 s30, s33, 131072
    buffer_load_dwordx4 v[60:63], v189, s[16:19], s30 offen
    s_add_u32 s30, s33, 262144
    buffer_load_dwordx4 v[64:67], v189, s[16:19], s30 offen
    s_add_u32 s30, s33, 393216
    buffer_load_dwordx4 v[68:71], v189, s[16:19], s30 offen
    s_add_u32 s30, s33, 524288
    buffer_load_dwordx4 v[72:75], v189, s[16:19], s30 offen
    s_add_u32 s30, s33, 655360
    buffer_load_dwordx4 v[76:79], v189, s[16:19], s30 offen
    s_add_u32 s30, s33, 786432
    buffer_load_dwordx4 v[80:83], v189, s[16:19], s30 offen
    s_add_u32 s30, s33, 917504
    buffer_load_dwordx4 v[84:87], v189, s[16:19], s30 offen
    s_add_u32 s33, s33, 512
    s_add_u32 s30, s33, 0
    buffer_load_dwordx4 v[88:91], v189, s[16:19], s30 offen
    s_add_u32 s30, s33, 131072
    buffer_load_dwordx4 v[92:95], v189, s[16:19], s30 offen
    s_add_u32 s30, s33, 262144
    buffer_load_dwordx4 v[96:99], v189, s[16:19], s30 offen
    s_add_u32 s30, s33, 393216
    buffer_load_dwordx4 v[100:103], v189, s[16:19], s30 offen
    s_add_u32 s30, s33, 524288
    buffer_load_dwordx4 v[104:107], v189, s[16:19], s30 offen
    s_add_u32 s30, s33, 655360
    buffer_load_dwordx4 v[108:111], v189, s[16:19], s30 offen
    s_add_u32 s30, s33, 786432
    buffer_load_dwordx4 v[112:115], v189, s[16:19], s30 offen
    s_add_u32 s30, s33, 917504
    buffer_load_dwordx4 v[116:119], v189, s[16:19], s30 offen
    s_add_u32 s33, s33, 512
    s_add_u32 s30, s33, 0
    buffer_load_dwordx4 v[120:123], v189, s[16:19], s30 offen
    s_add_u32 s30, s33, 131072
    buffer_load_dwordx4 v[124:127], v189, s[16:19], s30 offen
    s_add_u32 s30, s33, 262144
    buffer_load_dwordx4 v[128:131], v189, s[16:19], s30 offen
    s_add_u32 s30, s33, 393216
    buffer_load_dwordx4 v[132:135], v189, s[16:19], s30 offen
    s_add_u32 s30, s33, 524288
    buffer_load_dwordx4 v[136:139], v189, s[16:19], s30 offen
    s_add_u32 s30, s33, 655360
    buffer_load_dwordx4 v[140:143], v189, s[16:19], s30 offen
    s_add_u32 s30, s33, 786432
    buffer_load_dwordx4 v[144:147], v189, s[16:19], s30 offen
    s_add_u32 s30, s33, 917504
    buffer_load_dwordx4 v[148:151], v189, s[16:19], s30 offen
    s_add_u32 s33, s33, 512
    s_waitcnt vmcnt(34)
    ds_read_b64_tr_b16 v[16:17], v190 offset:0
    ds_read_b64_tr_b16 v[18:19], v190 offset:1280
    ds_read_b64_tr_b16 v[20:21], v190 offset:32
    ds_read_b64_tr_b16 v[22:23], v190 offset:1312
    ds_read_b64_tr_b16 v[24:25], v190 offset:64
    ds_read_b64_tr_b16 v[26:27], v190 offset:1344
    ds_read_b64_tr_b16 v[28:29], v190 offset:96
    ds_read_b64_tr_b16 v[30:31], v190 offset:1376
    ds_read_b64_tr_b16 v[32:33], v190 offset:128
    ds_read_b64_tr_b16 v[34:35], v190 offset:1408
    s_mov_b32 s28, 0
L_oloop:
    s_waitcnt vmcnt(23) lgkmcnt(8)
    v_mfma_f32_16x16x32_bf16 a[0:3], v[16:19], v[56:59], a[0:3]
    s_add_u32 s29, s31, 15360
    s_waitcnt vmcnt(22)
    v_mfma_f32_16x16x32_bf16 a[20:23], v[16:19], v[60:63], a[20:23]
    s_mov_b32 m0, s29
    s_nop 0
    buffer_load_dwordx4 v184, s[12:15], s32 offen lds
    s_waitcnt vmcnt(22)
    v_mfma_f32_16x16x32_bf16 a[40:43], v[16:19], v[64:67], a[40:43]
    s_add_u32 s29, s31, 16384
    s_waitcnt vmcnt(21)
    v_mfma_f32_16x16x32_bf16 a[60:63], v[16:19], v[68:71], a[60:63]
    s_mov_b32 m0, s29
    s_nop 0
    buffer_load_dwordx4 v185, s[12:15], s32 offen lds
    s_waitcnt vmcnt(21)
    v_mfma_f32_16x16x32_bf16 a[80:83], v[16:19], v[72:75], a[80:83]
    s_add_u32 s29, s31, 17408
    s_mov_b32 m0, s29
    s_waitcnt vmcnt(20)
    v_mfma_f32_16x16x32_bf16 a[100:103], v[16:19], v[76:79], a[100:103]
    buffer_load_dwordx4 v186, s[12:15], s32 offen lds
    s_waitcnt vmcnt(20)
    v_mfma_f32_16x16x32_bf16 a[120:123], v[16:19], v[80:83], a[120:123]
    s_add_u32 s29, s31, 18432
    s_mov_b32 m0, s29
    s_waitcnt vmcnt(19)
    v_mfma_f32_16x16x32_bf16 a[140:143], v[16:19], v[84:87], a[140:143]
    buffer_load_dwordx4 v187, s[12:15], s32 offen lds
    s_add_u32 s29, s31, 19456
    s_waitcnt lgkmcnt(6)
    v_mfma_f32_16x16x32_bf16 a[4:7], v[20:23], v[56:59], a[4:7]
    s_mov_b32 m0, s29
    v_mfma_f32_16x16x32_bf16 a[24:27], v[20:23], v[60:63], a[24:27]
    buffer_load_dwordx4 v188, s[12:15], s32 offen lds
    s_add_u32 s32, s32, 40960
    v_mfma_f32_16x16x32_bf16 a[44:47], v[20:23], v[64:67], a[44:47]
    s_add_u32 s30, s33, 0
    buffer_load_dwordx4 v[152:155], v189, s[16:19], s30 offen
    v_mfma_f32_16x16x32_bf16 a[64:67], v[20:23], v[68:71], a[64:67]
    s_add_u32 s30, s33, 131072
    v_mfma_f32_16x16x32_bf16 a[84:87], v[20:23], v[72:75], a[84:87]
    buffer_load_dwordx4 v[156:159], v189, s[16:19], s30 offen
    s_add_u32 s30, s33, 262144
    v_mfma_f32_16x16x32_bf16 a[104:107], v[20:23], v[76:79], a[104:107]
    buffer_load_dwordx4 v[160:163], v189, s[16:19], s30 offen
    s_add_u32 s30, s33, 393216
    v_mfma_f32_16x16x32_bf16 a[124:127], v[20:23], v[80:83], a[124:127]
    buffer_load_dwordx4 v[164:167], v189, s[16:19], s30 offen
    v_mfma_f32_16x16x32_bf16 a[144:147], v[20:23], v[84:87], a[144:147]
    s_add_u32 s30, s33, 524288
    buffer_load_dwordx4 v[168:171], v189, s[16:19], s30 offen
    s_waitcnt lgkmcnt(4)
    v_mfma_f32_16x16x32_bf16 a[8:11], v[24:27], v[56:59], a[8:11]
    s_add_u32 s30, s33, 655360
    buffer_load_dwordx4 v[172:175], v189, s[16:19], s30 offen
    v_mfma_f32_16x16x32_bf16 a[28:31], v[24:27], v[60:63], a[28:31]
    s_add_u32 s30, s33, 786432
    v_mfma_f32_16x16x32_bf16 a[48:51], v[24:27], v[64:67], a[48:51]
    buffer_load_dwordx4 v[176:179], v189, s[16:19], s30 offen
    s_add_u32 s30, s33, 917504
    v_mfma_f32_16x16x32_bf16 a[68:71], v[24:27], v[68:71], a[68:71]
    buffer_load_dwordx4 v[180:183], v189, s[16:19], s30 offen
    s_add_u32 s33, s33, 512
    v_mfma_f32_16x16x32_bf16 a[88:91], v[24:27], v[72:75], a[88:91]
    s_waitcnt vmcnt(34)
    v_mfma_f32_16x16x32_bf16 a[108:111], v[24:27], v[76:79], a[108:111]
    ds_read_b64_tr_b16 v[36:37], v190 offset:5120
    ds_read_b64_tr_b16 v[38:39], v190 offset:6400
    v_mfma_f32_16x16x32_bf16 a[128:131], v[24:27], v[80:83], a[128:131]
    ds_read_b64_tr_b16 v[40:41], v190 offset:5152
    ds_read_b64_tr_b16 v[42:43], v190 offset:6432
    v_mfma_f32_16x16x32_bf16 a[148:151], v[24:27], v[84:87], a[148:151]
    ds_read_b64_tr_b16 v[44:45], v190 offset:5184
    ds_read_b64_tr_b16 v[46:47], v190 offset:6464
    s_waitcnt lgkmcnt(8)
    v_mfma_f32_16x16x32_bf16 a[12:15], v[28:31], v[56:59], a[12:15]
    ds_read_b64_tr_b16 v[48:49], v190 offset:5216
    ds_read_b64_tr_b16 v[50:51], v190 offset:6496
    v_mfma_f32_16x16x32_bf16 a[32:35], v[28:31], v[60:63], a[32:35]
    ds_read_b64_tr_b16 v[52:53], v190 offset:5248
    ds_read_b64_tr_b16 v[54:55], v190 offset:6528
    v_mfma_f32_16x16x32_bf16 a[52:55], v[28:31], v[64:67], a[52:55]
    v_mfma_f32_16x16x32_bf16 a[72:75], v[28:31], v[68:71], a[72:75]
    v_mfma_f32_16x16x32_bf16 a[92:95], v[28:31], v[72:75], a[92:95]
    v_mfma_f32_16x16x32_bf16 a[112:115], v[28:31], v[76:79], a[112:115]
    v_mfma_f32_16x16x32_bf16 a[132:135], v[28:31], v[80:83], a[132:135]
    v_mfma_f32_16x16x32_bf16 a[152:155], v[28:31], v[84:87], a[152:155]
    s_waitcnt lgkmcnt(10)
    v_mfma_f32_16x16x32_bf16 a[16:19], v[32:35], v[56:59], a[16:19]
    v_mfma_f32_16x16x32_bf16 a[36:39], v[32:35], v[60:63], a[36:39]
    v_mfma_f32_16x16x32_bf16 a[56:59], v[32:35], v[64:67], a[56:59]
    v_mfma_f32_16x16x32_bf16 a[76:79], v[32:35], v[68:71], a[76:79]
    v_mfma_f32_16x16x32_bf16 a[96:99], v[32:35], v[72:75], a[96:99]
    v_mfma_f32_16x16x32_bf16 a[116:119], v[32:35], v[76:79], a[116:119]
    v_mfma_f32_16x16x32_bf16 a[136:139], v[32:35], v[80:83], a[136:139]
    v_mfma_f32_16x16x32_bf16 a[156:159], v[32:35], v[84:87], a[156:159]
    s_waitcnt vmcnt(28) lgkmcnt(8)
    v_mfma_f32_16x16x32_bf16 a[0:3], v[36:39], v[88:91], a[0:3]
    s_add_u32 s29, s31, 0
    s_waitcnt vmcnt(27)
    v_mfma_f32_16x16x32_bf16 a[20:23], v[36:39], v[92:95], a[20:23]
    s_mov_b32 m0, s29
    s_nop 0
    buffer_load_dwordx4 v184, s[12:15], s32 offen lds
    s_waitcnt vmcnt(27)
    v_mfma_f32_16x16x32_bf16 a[40:43], v[36:39], v[96:99], a[40:43]
    s_add_u32 s29, s31, 1024
    s_waitcnt vmcnt(26)
    v_mfma_f32_16x16x32_bf16 a[60:63], v[36:39], v[100:103], a[60:63]
    s_mov_b32 m0, s29
    s_nop 0
    buffer_load_dwordx4 v185, s[12:15], s32 offen lds
    s_waitcnt vmcnt(26)
    v_mfma_f32_16x16x32_bf16 a[80:83], v[36:39], v[104:107], a[80:83]
    s_add_u32 s29, s31, 2048
    s_mov_b32 m0, s29
    s_waitcnt vmcnt(25)
    v_mfma_f32_16x16x32_bf16 a[100:103], v[36:39], v[108:111], a[100:103]
    buffer_load_dwordx4 v186, s[12:15], s32 offen lds
    s_waitcnt vmcnt(25)
    v_mfma_f32_16x16x32_bf16 a[120:123], v[36:39], v[112:115], a[120:123]
    s_add_u32 s29, s31, 3072
    s_mov_b32 m0, s29
    s_waitcnt vmcnt(24)
    v_mfma_f32_16x16x32_bf16 a[140:143], v[36:39], v[116:119], a[140:143]
    buffer_load_dwordx4 v187, s[12:15], s32 offen lds
    s_add_u32 s29, s31, 4096
    s_waitcnt lgkmcnt(6)
    v_mfma_f32_16x16x32_bf16 a[4:7], v[40:43], v[88:91], a[4:7]
    s_mov_b32 m0, s29
    v_mfma_f32_16x16x32_bf16 a[24:27], v[40:43], v[92:95], a[24:27]
    buffer_load_dwordx4 v188, s[12:15], s32 offen lds
    s_add_u32 s32, s32, 40960
    v_mfma_f32_16x16x32_bf16 a[44:47], v[40:43], v[96:99], a[44:47]
    s_add_u32 s30, s33, 0
    buffer_load_dwordx4 v[56:59], v189, s[16:19], s30 offen
    v_mfma_f32_16x16x32_bf16 a[64:67], v[40:43], v[100:103], a[64:67]
    s_add_u32 s30, s33, 131072
    v_mfma_f32_16x16x32_bf16 a[84:87], v[40:43], v[104:107], a[84:87]
    buffer_load_dwordx4 v[60:63], v189, s[16:19], s30 offen
    s_add_u32 s30, s33, 262144
    v_mfma_f32_16x16x32_bf16 a[104:107], v[40:43], v[108:111], a[104:107]
    buffer_load_dwordx4 v[64:67], v189, s[16:19], s30 offen
    s_add_u32 s30, s33, 393216
    v_mfma_f32_16x16x32_bf16 a[124:127], v[40:43], v[112:115], a[124:127]
    buffer_load_dwordx4 v[68:71], v189, s[16:19], s30 offen
    v_mfma_f32_16x16x32_bf16 a[144:147], v[40:43], v[116:119], a[144:147]
    s_add_u32 s30, s33, 524288
    buffer_load_dwordx4 v[72:75], v189, s[16:19], s30 offen
    s_waitcnt lgkmcnt(4)
    v_mfma_f32_16x16x32_bf16 a[8:11], v[44:47], v[88:91], a[8:11]
    s_add_u32 s30, s33, 655360
    buffer_load_dwordx4 v[76:79], v189, s[16:19], s30 offen
    v_mfma_f32_16x16x32_bf16 a[28:31], v[44:47], v[92:95], a[28:31]
    s_add_u32 s30, s33, 786432
    v_mfma_f32_16x16x32_bf16 a[48:51], v[44:47], v[96:99], a[48:51]
    buffer_load_dwordx4 v[80:83], v189, s[16:19], s30 offen
    s_add_u32 s30, s33, 917504
    v_mfma_f32_16x16x32_bf16 a[68:71], v[44:47], v[100:103], a[68:71]
    buffer_load_dwordx4 v[84:87], v189, s[16:19], s30 offen
    s_add_u32 s33, s33, 512
    v_mfma_f32_16x16x32_bf16 a[88:91], v[44:47], v[104:107], a[88:91]
    s_waitcnt vmcnt(34)
    v_mfma_f32_16x16x32_bf16 a[108:111], v[44:47], v[108:111], a[108:111]
    ds_read_b64_tr_b16 v[16:17], v190 offset:10240
    ds_read_b64_tr_b16 v[18:19], v190 offset:11520
    v_mfma_f32_16x16x32_bf16 a[128:131], v[44:47], v[112:115], a[128:131]
    ds_read_b64_tr_b16 v[20:21], v190 offset:10272
    ds_read_b64_tr_b16 v[22:23], v190 offset:11552
    v_mfma_f32_16x16x32_bf16 a[148:151], v[44:47], v[116:119], a[148:151]
    ds_read_b64_tr_b16 v[24:25], v190 offset:10304
    ds_read_b64_tr_b16 v[26:27], v190 offset:11584
    s_waitcnt lgkmcnt(8)
    v_mfma_f32_16x16x32_bf16 a[12:15], v[48:51], v[88:91], a[12:15]
    ds_read_b64_tr_b16 v[28:29], v190 offset:10336
    ds_read_b64_tr_b16 v[30:31], v190 offset:11616
    v_mfma_f32_16x16x32_bf16 a[32:35], v[48:51], v[92:95], a[32:35]
    ds_read_b64_tr_b16 v[32:33], v190 offset:10368
    ds_read_b64_tr_b16 v[34:35], v190 offset:11648
    v_mfma_f32_16x16x32_bf16 a[52:55], v[48:51], v[96:99], a[52:55]
    v_mfma_f32_16x16x32_bf16 a[72:75], v[48:51], v[100:103], a[72:75]
    v_mfma_f32_16x16x32_bf16 a[92:95], v[48:51], v[104:107], a[92:95]
    v_mfma_f32_16x16x32_bf16 a[112:115], v[48:51], v[108:111], a[112:115]
    v_mfma_f32_16x16x32_bf16 a[132:135], v[48:51], v[112:115], a[132:135]
    v_mfma_f32_16x16x32_bf16 a[152:155], v[48:51], v[116:119], a[152:155]
    s_waitcnt lgkmcnt(10)
    v_mfma_f32_16x16x32_bf16 a[16:19], v[52:55], v[88:91], a[16:19]
    v_mfma_f32_16x16x32_bf16 a[36:39], v[52:55], v[92:95], a[36:39]
    v_mfma_f32_16x16x32_bf16 a[56:59], v[52:55], v[96:99], a[56:59]
    v_mfma_f32_16x16x32_bf16 a[76:79], v[52:55], v[100:103], a[76:79]
    v_mfma_f32_16x16x32_bf16 a[96:99], v[52:55], v[104:107], a[96:99]
    v_mfma_f32_16x16x32_bf16 a[116:119], v[52:55], v[108:111], a[116:119]
    v_mfma_f32_16x16x32_bf16 a[136:139], v[52:55], v[112:115], a[136:139]
    v_mfma_f32_16x16x32_bf16 a[156:159], v[52:55], v[116:119], a[156:159]
    s_waitcnt vmcnt(33) lgkmcnt(8)
    v_mfma_f32_16x16x32_bf16 a[0:3], v[16:19], v[120:123], a[0:3]
    s_add_u32 s29, s31, 5120
    s_waitcnt vmcnt(32)
    v_mfma_f32_16x16x32_bf16 a[20:23], v[16:19], v[124:127], a[20:23]
    s_mov_b32 m0, s29
    s_nop 0
    buffer_load_dwordx4 v184, s[12:15], s32 offen lds
    s_waitcnt vmcnt(32)
    v_mfma_f32_16x16x32_bf16 a[40:43], v[16:19], v[128:131], a[40:43]
    s_add_u32 s29, s31, 6144
    s_waitcnt vmcnt(31)
    v_mfma_f32_16x16x32_bf16 a[60:63], v[16:19], v[132:135], a[60:63]
    s_mov_b32 m0, s29
    s_nop 0
    buffer_load_dwordx4 v185, s[12:15], s32 offen lds
    s_waitcnt vmcnt(31)
    v_mfma_f32_16x16x32_bf16 a[80:83], v[16:19], v[136:139], a[80:83]
    s_add_u32 s29, s31, 7168
    s_mov_b32 m0, s29
    s_waitcnt vmcnt(30)
    v_mfma_f32_16x16x32_bf16 a[100:103], v[16:19], v[140:143], a[100:103]
    buffer_load_dwordx4 v186, s[12:15], s32 offen lds
    s_waitcnt vmcnt(30)
    v_mfma_f32_16x16x32_bf16 a[120:123], v[16:19], v[144:147], a[120:123]
    s_add_u32 s29, s31, 8192
    s_mov_b32 m0, s29
    s_waitcnt vmcnt(29)
    v_mfma_f32_16x16x32_bf16 a[140:143], v[16:19], v[148:151], a[140:143]
    buffer_load_dwordx4 v187, s[12:15], s32 offen lds
    s_add_u32 s29, s31, 9216
    s_waitcnt lgkmcnt(6)
    v_mfma_f32_16x16x32_bf16 a[4:7], v[20:23], v[120:123], a[4:7]
    s_mov_b32 m0, s29
    v_mfma_f32_16x16x32_bf16 a[24:27], v[20:23], v[124:127], a[24:27]
    buffer_load_dwordx4 v188, s[12:15], s32 offen lds
    s_add_u32 s32, s32, 40960
    v_mfma_f32_16x16x32_bf16 a[44:47], v[20:23], v[128:131], a[44:47]
    s_add_u32 s30, s33, 0
    buffer_load_dwordx4 v[88:91], v189, s[16:19], s30 offen
    v_mfma_f32_16x16x32_bf16 a[64:67], v[20:23], v[132:135], a[64:67]
    s_add_u32 s30, s33, 131072
    v_mfma_f32_16x16x32_bf16 a[84:87], v[20:23], v[136:139], a[84:87]
    buffer_load_dwordx4 v[92:95], v189, s[16:19], s30 offen
    s_add_u32 s30, s33, 262144
    v_mfma_f32_16x16x32_bf16 a[104:107], v[20:23], v[140:143], a[104:107]
    buffer_load_dwordx4 v[96:99], v189, s[16:19], s30 offen
    s_add_u32 s30, s33, 393216
    v_mfma_f32_16x16x32_bf16 a[124:127], v[20:23], v[144:147], a[124:127]
    buffer_load_dwordx4 v[100:103], v189, s[16:19], s30 offen
    v_mfma_f32_16x16x32_bf16 a[144:147], v[20:23], v[148:151], a[144:147]
    s_add_u32 s30, s33, 524288
    buffer_load_dwordx4 v[104:107], v189, s[16:19], s30 offen
    s_waitcnt lgkmcnt(4)
    v_mfma_f32_16x16x32_bf16 a[8:11], v[24:27], v[120:123], a[8:11]
    s_add_u32 s30, s33, 655360
    buffer_load_dwordx4 v[108:111], v189, s[16:19], s30 offen
    v_mfma_f32_16x16x32_bf16 a[28:31], v[24:27], v[124:127], a[28:31]
    s_add_u32 s30, s33, 786432
    v_mfma_f32_16x16x32_bf16 a[48:51], v[24:27], v[128:131], a[48:51]
    buffer_load_dwordx4 v[112:115], v189, s[16:19], s30 offen
    s_add_u32 s30, s33, 917504
    v_mfma_f32_16x16x32_bf16 a[68:71], v[24:27], v[132:135], a[68:71]
    buffer_load_dwordx4 v[116:119], v189, s[16:19], s30 offen
    s_add_u32 s33, s33, 512
    v_mfma_f32_16x16x32_bf16 a[88:91], v[24:27], v[136:139], a[88:91]
    s_waitcnt vmcnt(34)
    v_mfma_f32_16x16x32_bf16 a[108:111], v[24:27], v[140:143], a[108:111]
    ds_read_b64_tr_b16 v[36:37], v190 offset:15360
    ds_read_b64_tr_b16 v[38:39], v190 offset:16640
    v_mfma_f32_16x16x32_bf16 a[128:131], v[24:27], v[144:147], a[128:131]
    ds_read_b64_tr_b16 v[40:41], v190 offset:15392
    ds_read_b64_tr_b16 v[42:43], v190 offset:16672
    v_mfma_f32_16x16x32_bf16 a[148:151], v[24:27], v[148:151], a[148:151]
    ds_read_b64_tr_b16 v[44:45], v190 offset:15424
    ds_read_b64_tr_b16 v[46:47], v190 offset:16704
    s_waitcnt lgkmcnt(8)
    v_mfma_f32_16x16x32_bf16 a[12:15], v[28:31], v[120:123], a[12:15]
    ds_read_b64_tr_b16 v[48:49], v190 offset:15456
    ds_read_b64_tr_b16 v[50:51], v190 offset:16736
    v_mfma_f32_16x16x32_bf16 a[32:35], v[28:31], v[124:127], a[32:35]
    ds_read_b64_tr_b16 v[52:53], v190 offset:15488
    ds_read_b64_tr_b16 v[54:55], v190 offset:16768
    v_mfma_f32_16x16x32_bf16 a[52:55], v[28:31], v[128:131], a[52:55]
    v_mfma_f32_16x16x32_bf16 a[72:75], v[28:31], v[132:135], a[72:75]
    v_mfma_f32_16x16x32_bf16 a[92:95], v[28:31], v[136:139], a[92:95]
    v_mfma_f32_16x16x32_bf16 a[112:115], v[28:31], v[140:143], a[112:115]
    v_mfma_f32_16x16x32_bf16 a[132:135], v[28:31], v[144:147], a[132:135]
    v_mfma_f32_16x16x32_bf16 a[152:155], v[28:31], v[148:151], a[152:155]
    s_waitcnt lgkmcnt(10)
    v_mfma_f32_16x16x32_bf16 a[16:19], v[32:35], v[120:123], a[16:19]
    v_mfma_f32_16x16x32_bf16 a[36:39], v[32:35], v[124:127], a[36:39]
    v_mfma_f32_16x16x32_bf16 a[56:59], v[32:35], v[128:131], a[56:59]
    v_mfma_f32_16x16x32_bf16 a[76:79], v[32:35], v[132:135], a[76:79]
    v_mfma_f32_16x16x32_bf16 a[96:99], v[32:35], v[136:139], a[96:99]
    v_mfma_f32_16x16x32_bf16 a[116:119], v[32:35], v[140:143], a[116:119]
    v_mfma_f32_16x16x32_bf16 a[136:139], v[32:35], v[144:147], a[136:139]
    v_mfma_f32_16x16x32_bf16 a[156:159], v[32:35], v[148:151], a[156:159]
    s_waitcnt vmcnt(33) lgkmcnt(8)
    v_mfma_f32_16x16x32_bf16 a[0:3], v[36:39], v[152:155], a[0:3]
    s_add_u32 s29, s31, 10240
    s_waitcnt vmcnt(32)
    v_mfma_f32_16x16x32_bf16 a[20:23], v[36:39], v[156:159], a[20:23]
    s_mov_b32 m0, s29
    s_nop 0
    buffer_load_dwordx4 v184, s[12:15], s32 offen lds
    s_waitcnt vmcnt(32)
    v_mfma_f32_16x16x32_bf16 a[40:43], v[36:39], v[160:163], a[40:43]
    s_add_u32 s29, s31, 11264
    s_waitcnt vmcnt(31)
    v_mfma_f32_16x16x32_bf16 a[60:63], v[36:39], v[164:167], a[60:63]
    s_mov_b32 m0, s29
    s_nop 0
    buffer_load_dwordx4 v185, s[12:15], s32 offen lds
    s_waitcnt vmcnt(31)
    v_mfma_f32_16x16x32_bf16 a[80:83], v[36:39], v[168:171], a[80:83]
    s_add_u32 s29, s31, 12288
    s_mov_b32 m0, s29
    s_waitcnt vmcnt(30)
    v_mfma_f32_16x16x32_bf16 a[100:103], v[36:39], v[172:175], a[100:103]
    buffer_load_dwordx4 v186, s[12:15], s32 offen lds
    s_waitcnt vmcnt(30)
    v_mfma_f32_16x16x32_bf16 a[120:123], v[36:39], v[176:179], a[120:123]
    s_add_u32 s29, s31, 13312
    s_mov_b32 m0, s29
    s_waitcnt vmcnt(29)
    v_mfma_f32_16x16x32_bf16 a[140:143], v[36:39], v[180:183], a[140:143]
    buffer_load_dwordx4 v187, s[12:15], s32 offen lds
    s_add_u32 s29, s31, 14336
    s_waitcnt lgkmcnt(6)
    v_mfma_f32_16x16x32_bf16 a[4:7], v[40:43], v[152:155], a[4:7]
    s_mov_b32 m0, s29
    v_mfma_f32_16x16x32_bf16 a[24:27], v[40:43], v[156:159], a[24:27]
    buffer_load_dwordx4 v188, s[12:15], s32 offen lds
    s_add_u32 s32, s32, 40960
    v_mfma_f32_16x16x32_bf16 a[44:47], v[40:43], v[160:163], a[44:47]
    s_add_u32 s30, s33, 0
    buffer_load_dwordx4 v[120:123], v189, s[16:19], s30 offen
    v_mfma_f32_16x16x32_bf16 a[64:67], v[40:43], v[164:167], a[64:67]
    s_add_u32 s30, s33, 131072
    v_mfma_f32_16x16x32_bf16 a[84:87], v[40:43], v[168:171], a[84:87]
    buffer_load_dwordx4 v[124:127], v189, s[16:19], s30 offen
    s_add_u32 s30, s33, 262144
    v_mfma_f32_16x16x32_bf16 a[104:107], v[40:43], v[172:175], a[104:107]
    buffer_load_dwordx4 v[128:131], v189, s[16:19], s30 offen
    s_add_u32 s30, s33, 393216
    v_mfma_f32_16x16x32_bf16 a[124:127], v[40:43], v[176:179], a[124:127]
    buffer_load_dwordx4 v[132:135], v189, s[16:19], s30 offen
    v_mfma_f32_16x16x32_bf16 a[144:147], v[40:43], v[180:183], a[144:147]
    s_add_u32 s30, s33, 524288
    buffer_load_dwordx4 v[136:139], v189, s[16:19], s30 offen
    s_waitcnt lgkmcnt(4)
    v_mfma_f32_16x16x32_bf16 a[8:11], v[44:47], v[152:155], a[8:11]
    s_add_u32 s30, s33, 655360
    buffer_load_dwordx4 v[140:143], v189, s[16:19], s30 offen
    v_mfma_f32_16x16x32_bf16 a[28:31], v[44:47], v[156:159], a[28:31]
    s_add_u32 s30, s33, 786432
    v_mfma_f32_16x16x32_bf16 a[48:51], v[44:47], v[160:163], a[48:51]
    buffer_load_dwordx4 v[144:147], v189, s[16:19], s30 offen
    s_add_u32 s30, s33, 917504
    v_mfma_f32_16x16x32_bf16 a[68:71], v[44:47], v[164:167], a[68:71]
    buffer_load_dwordx4 v[148:151], v189, s[16:19], s30 offen
    s_add_u32 s33, s33, 512
    v_mfma_f32_16x16x32_bf16 a[88:91], v[44:47], v[168:171], a[88:91]
    s_waitcnt vmcnt(34)
    v_mfma_f32_16x16x32_bf16 a[108:111], v[44:47], v[172:175], a[108:111]
    ds_read_b64_tr_b16 v[16:17], v190 offset:0
    ds_read_b64_tr_b16 v[18:19], v190 offset:1280
    v_mfma_f32_16x16x32_bf16 a[128:131], v[44:47], v[176:179], a[128:131]
    ds_read_b64_tr_b16 v[20:21], v190 offset:32
    ds_read_b64_tr_b16 v[22:23], v190 offset:1312
    v_mfma_f32_16x16x32_bf16 a[148:151], v[44:47], v[180:183], a[148:151]
    ds_read_b64_tr_b16 v[24:25], v190 offset:64
    ds_read_b64_tr_b16 v[26:27], v190 offset:1344
    s_waitcnt lgkmcnt(8)
    v_mfma_f32_16x16x32_bf16 a[12:15], v[48:51], v[152:155], a[12:15]
    ds_read_b64_tr_b16 v[28:29], v190 offset:96
    ds_read_b64_tr_b16 v[30:31], v190 offset:1376
    v_mfma_f32_16x16x32_bf16 a[32:35], v[48:51], v[156:159], a[32:35]
    ds_read_b64_tr_b16 v[32:33], v190 offset:128
    ds_read_b64_tr_b16 v[34:35], v190 offset:1408
    v_mfma_f32_16x16x32_bf16 a[52:55], v[48:51], v[160:163], a[52:55]
    v_mfma_f32_16x16x32_bf16 a[72:75], v[48:51], v[164:167], a[72:75]
    v_mfma_f32_16x16x32_bf16 a[92:95], v[48:51], v[168:171], a[92:95]
    v_mfma_f32_16x16x32_bf16 a[112:115], v[48:51], v[172:175], a[112:115]
    v_mfma_f32_16x16x32_bf16 a[132:135], v[48:51], v[176:179], a[132:135]
    v_mfma_f32_16x16x32_bf16 a[152:155], v[48:51], v[180:183], a[152:155]
    s_waitcnt lgkmcnt(10)
    v_mfma_f32_16x16x32_bf16 a[16:19], v[52:55], v[152:155], a[16:19]
    v_mfma_f32_16x16x32_bf16 a[36:39], v[52:55], v[156:159], a[36:39]
    v_mfma_f32_16x16x32_bf16 a[56:59], v[52:55], v[160:163], a[56:59]
    v_mfma_f32_16x16x32_bf16 a[76:79], v[52:55], v[164:167], a[76:79]
    v_mfma_f32_16x16x32_bf16 a[96:99], v[52:55], v[168:171], a[96:99]
    v_mfma_f32_16x16x32_bf16 a[116:119], v[52:55], v[172:175], a[116:119]
    v_mfma_f32_16x16x32_bf16 a[136:139], v[52:55], v[176:179], a[136:139]
    v_mfma_f32_16x16x32_bf16 a[156:159], v[52:55], v[180:183], a[156:159]
    s_add_u32 s28, s28, 1
    s_cmp_lt_u32 s28, 7
    s_cbranch_scc1 L_oloop
    s_waitcnt vmcnt(33) lgkmcnt(8)
    v_mfma_f32_16x16x32_bf16 a[0:3], v[16:19], v[56:59], a[0:3]
    s_add_u32 s29, s31, 15360
    s_waitcnt vmcnt(32)
    v_mfma_f32_16x16x32_bf16 a[20:23], v[16:19], v[60:63], a[20:23]
    s_mov_b32 m0, s29
    s_nop 0
    buffer_load_dwordx4 v184, s[12:15], s32 offen lds
    s_waitcnt vmcnt(32)
    v_mfma_f32_16x16x32_bf16 a[40:43], v[16:19], v[64:67], a[40:43]
    s_add_u32 s29, s31, 16384
    s_waitcnt vmcnt(31)
    v_mfma_f32_16x16x32_bf16 a[60:63], v[16:19], v[68:71], a[60:63]
    s_mov_b32 m0, s29
    s_nop 0
    buffer_load_dwordx4 v185, s[12:15], s32 offen lds
    s_waitcnt vmcnt(31)
    v_mfma_f32_16x16x32_bf16 a[80:83], v[16:19], v[72:75], a[80:83]
    s_add_u32 s29, s31, 17408
    s_mov_b32 m0, s29
    s_waitcnt vmcnt(30)
    v_mfma_f32_16x16x32_bf16 a[100:103], v[16:19], v[76:79], a[100:103]
    buffer_load_dwordx4 v186, s[12:15], s32 offen lds
    s_waitcnt vmcnt(30)
    v_mfma_f32_16x16x32_bf16 a[120:123], v[16:19], v[80:83], a[120:123]
    s_add_u32 s29, s31, 18432
    s_mov_b32 m0, s29
    s_waitcnt vmcnt(29)
    v_mfma_f32_16x16x32_bf16 a[140:143], v[16:19], v[84:87], a[140:143]
    buffer_load_dwordx4 v187, s[12:15], s32 offen lds
    s_add_u32 s29, s31, 19456
    s_waitcnt lgkmcnt(6)
    v_mfma_f32_16x16x32_bf16 a[4:7], v[20:23], v[56:59], a[4:7]
    s_mov_b32 m0, s29
    v_mfma_f32_16x16x32_bf16 a[24:27], v[20:23], v[60:63], a[24:27]
    buffer_load_dwordx4 v188, s[12:15], s32 offen lds
    s_add_u32 s32, s32, 40960
    v_mfma_f32_16x16x32_bf16 a[44:47], v[20:23], v[64:67], a[44:47]
    s_add_u32 s30, s33, 0
    buffer_load_dwordx4 v[152:155], v189, s[16:19], s30 offen
    v_mfma_f32_16x16x32_bf16 a[64:67], v[20:23], v[68:71], a[64:67]
    s_add_u32 s30, s33, 131072
    v_mfma_f32_16x16x32_bf16 a[84:87], v[20:23], v[72:75], a[84:87]
    buffer_load_dwordx4 v[156:159], v189, s[16:19], s30 offen
    s_add_u32 s30, s33, 262144
    v_mfma_f32_16x16x32_bf16 a[104:107], v[20:23], v[76:79], a[104:107]
    buffer_load_dwordx4 v[160:163], v189, s[16:19], s30 offen
    s_add_u32 s30, s33, 393216
    v_mfma_f32_16x16x32_bf16 a[124:127], v[20:23], v[80:83], a[124:127]
    buffer_load_dwordx4 v[164:167], v189, s[16:19], s30 offen
    v_mfma_f32_16x16x32_bf16 a[144:147], v[20:23], v[84:87], a[144:147]
    s_add_u32 s30, s33, 524288
    buffer_load_dwordx4 v[168:171], v189, s[16:19], s30 offen
    s_waitcnt lgkmcnt(4)
    v_mfma_f32_16x16x32_bf16 a[8:11], v[24:27], v[56:59], a[8:11]
    s_add_u32 s30, s33, 655360
    buffer_load_dwordx4 v[172:175], v189, s[16:19], s30 offen
    v_mfma_f32_16x16x32_bf16 a[28:31], v[24:27], v[60:63], a[28:31]
    s_add_u32 s30, s33, 786432
    v_mfma_f32_16x16x32_bf16 a[48:51], v[24:27], v[64:67], a[48:51]
    buffer_load_dwordx4 v[176:179], v189, s[16:19], s30 offen
    s_add_u32 s30, s33, 917504
    v_mfma_f32_16x16x32_bf16 a[68:71], v[24:27], v[68:71], a[68:71]
    buffer_load_dwordx4 v[180:183], v189, s[16:19], s30 offen
    s_add_u32 s33, s33, 512
    v_mfma_f32_16x16x32_bf16 a[88:91], v[24:27], v[72:75], a[88:91]
    s_waitcnt vmcnt(34)
    v_mfma_f32_16x16x32_bf16 a[108:111], v[24:27], v[76:79], a[108:111]
    ds_read_b64_tr_b16 v[36:37], v190 offset:5120
    ds_read_b64_tr_b16 v[38:39], v190 offset:6400
    v_mfma_f32_16x16x32_bf16 a[128:131], v[24:27], v[80:83], a[128:131]
    ds_read_b64_tr_b16 v[40:41], v190 offset:5152
    ds_read_b64_tr_b16 v[42:43], v190 offset:6432
    v_mfma_f32_16x16x32_bf16 a[148:151], v[24:27], v[84:87], a[148:151]
    ds_read_b64_tr_b16 v[44:45], v190 offset:5184
    ds_read_b64_tr_b16 v[46:47], v190 offset:6464
    s_waitcnt lgkmcnt(8)
    v_mfma_f32_16x16x32_bf16 a[12:15], v[28:31], v[56:59], a[12:15]
    ds_read_b64_tr_b16 v[48:49], v190 offset:5216
    ds_read_b64_tr_b16 v[50:51], v190 offset:6496
    v_mfma_f32_16x16x32_bf16 a[32:35], v[28:31], v[60:63], a[32:35]
    ds_read_b64_tr_b16 v[52:53], v190 offset:5248
    ds_read_b64_tr_b16 v[54:55], v190 offset:6528
    v_mfma_f32_16x16x32_bf16 a[52:55], v[28:31], v[64:67], a[52:55]
    v_mfma_f32_16x16x32_bf16 a[72:75], v[28:31], v[68:71], a[72:75]
    v_mfma_f32_16x16x32_bf16 a[92:95], v[28:31], v[72:75], a[92:95]
    v_mfma_f32_16x16x32_bf16 a[112:115], v[28:31], v[76:79], a[112:115]
    v_mfma_f32_16x16x32_bf16 a[132:135], v[28:31], v[80:83], a[132:135]
    v_mfma_f32_16x16x32_bf16 a[152:155], v[28:31], v[84:87], a[152:155]
    s_waitcnt lgkmcnt(10)
    v_mfma_f32_16x16x32_bf16 a[16:19], v[32:35], v[56:59], a[16:19]
    v_mfma_f32_16x16x32_bf16 a[36:39], v[32:35], v[60:63], a[36:39]
    v_mfma_f32_16x16x32_bf16 a[56:59], v[32:35], v[64:67], a[56:59]
    v_mfma_f32_16x16x32_bf16 a[76:79], v[32:35], v[68:71], a[76:79]
    v_mfma_f32_16x16x32_bf16 a[96:99], v[32:35], v[72:75], a[96:99]
    v_mfma_f32_16x16x32_bf16 a[116:119], v[32:35], v[76:79], a[116:119]
    v_mfma_f32_16x16x32_bf16 a[136:139], v[32:35], v[80:83], a[136:139]
    v_mfma_f32_16x16x32_bf16 a[156:159], v[32:35], v[84:87], a[156:159]
    s_waitcnt vmcnt(33) lgkmcnt(8)
    v_mfma_f32_16x16x32_bf16 a[0:3], v[36:39], v[88:91], a[0:3]
    s_waitcnt vmcnt(32)
    v_mfma_f32_16x16x32_bf16 a[20:23], v[36:39], v[92:95], a[20:23]
    s_waitcnt vmcnt(31)
    v_mfma_f32_16x16x32_bf16 a[40:43], v[36:39], v[96:99], a[40:43]
    s_waitcnt vmcnt(30)
    v_mfma_f32_16x16x32_bf16 a[60:63], v[36:39], v[100:103], a[60:63]
    s_waitcnt vmcnt(29)
    v_mfma_f32_16x16x32_bf16 a[80:83], v[36:39], v[104:107], a[80:83]
    s_waitcnt vmcnt(28)
    v_mfma_f32_16x16x32_bf16 a[100:103], v[36:39], v[108:111], a[100:103]
    s_waitcnt vmcnt(27)
    v_mfma_f32_16x16x32_bf16 a[120:123], v[36:39], v[112:115], a[120:123]
    s_waitcnt vmcnt(26)
    v_mfma_f32_16x16x32_bf16 a[140:143], v[36:39], v[116:119], a[140:143]
    s_waitcnt lgkmcnt(6)
    v_mfma_f32_16x16x32_bf16 a[4:7], v[40:43], v[88:91], a[4:7]
    v_mfma_f32_16x16x32_bf16 a[24:27], v[40:43], v[92:95], a[24:27]
    v_mfma_f32_16x16x32_bf16 a[44:47], v[40:43], v[96:99], a[44:47]
    v_mfma_f32_16x16x32_bf16 a[64:67], v[40:43], v[100:103], a[64:67]
    v_mfma_f32_16x16x32_bf16 a[84:87], v[40:43], v[104:107], a[84:87]
    v_mfma_f32_16x16x32_bf16 a[104:107], v[40:43], v[108:111], a[104:107]
    v_mfma_f32_16x16x32_bf16 a[124:127], v[40:43], v[112:115], a[124:127]
    v_mfma_f32_16x16x32_bf16 a[144:147], v[40:43], v[116:119], a[144:147]
    s_waitcnt lgkmcnt(4)
    v_mfma_f32_16x16x32_bf16 a[8:11], v[44:47], v[88:91], a[8:11]
    v_mfma_f32_16x16x32_bf16 a[28:31], v[44:47], v[92:95], a[28:31]
    v_mfma_f32_16x16x32_bf16 a[48:51], v[44:47], v[96:99], a[48:51]
    v_mfma_f32_16x16x32_bf16 a[68:71], v[44:47], v[100:103], a[68:71]
    v_mfma_f32_16x16x32_bf16 a[88:91], v[44:47], v[104:107], a[88:91]
    s_waitcnt vmcnt(21)
    v_mfma_f32_16x16x32_bf16 a[108:111], v[44:47], v[108:111], a[108:111]
    ds_read_b64_tr_b16 v[16:17], v190 offset:10240
    ds_read_b64_tr_b16 v[18:19], v190 offset:11520
    v_mfma_f32_16x16x32_bf16 a[128:131], v[44:47], v[112:115], a[128:131]
    ds_read_b64_tr_b16 v[20:21], v190 offset:10272
    ds_read_b64_tr_b16 v[22:23], v190 offset:11552
    v_mfma_f32_16x16x32_bf16 a[148:151], v[44:47], v[116:119], a[148:151]
    ds_read_b64_tr_b16 v[24:25], v190 offset:10304
    ds_read_b64_tr_b16 v[26:27], v190 offset:11584
    s_waitcnt lgkmcnt(8)
    v_mfma_f32_16x16x32_bf16 a[12:15], v[48:51], v[88:91], a[12:15]
    ds_read_b64_tr_b16 v[28:29], v190 offset:10336
    ds_read_b64_tr_b16 v[30:31], v190 offset:11616
    v_mfma_f32_16x16x32_bf16 a[32:35], v[48:51], v[92:95], a[32:35]
    ds_read_b64_tr_b16 v[32:33], v190 offset:10368
    ds_read_b64_tr_b16 v[34:35], v190 offset:11648
    v_mfma_f32_16x16x32_bf16 a[52:55], v[48:51], v[96:99], a[52:55]
    v_mfma_f32_16x16x32_bf16 a[72:75], v[48:51], v[100:103], a[72:75]
    v_mfma_f32_16x16x32_bf16 a[92:95], v[48:51], v[104:107], a[92:95]
    v_mfma_f32_16x16x32_bf16 a[112:115], v[48:51], v[108:111], a[112:115]
    v_mfma_f32_16x16x32_bf16 a[132:135], v[48:51], v[112:115], a[132:135]
    v_mfma_f32_16x16x32_bf16 a[152:155], v[48:51], v[116:119], a[152:155]
    s_waitcnt lgkmcnt(10)
    v_mfma_f32_16x16x32_bf16 a[16:19], v[52:55], v[88:91], a[16:19]
    v_mfma_f32_16x16x32_bf16 a[36:39], v[52:55], v[92:95], a[36:39]
    v_mfma_f32_16x16x32_bf16 a[56:59], v[52:55], v[96:99], a[56:59]
    v_mfma_f32_16x16x32_bf16 a[76:79], v[52:55], v[100:103], a[76:79]
    v_mfma_f32_16x16x32_bf16 a[96:99], v[52:55], v[104:107], a[96:99]
    v_mfma_f32_16x16x32_bf16 a[116:119], v[52:55], v[108:111], a[116:119]
    v_mfma_f32_16x16x32_bf16 a[136:139], v[52:55], v[112:115], a[136:139]
    v_mfma_f32_16x16x32_bf16 a[156:159], v[52:55], v[116:119], a[156:159]
    s_waitcnt vmcnt(20) lgkmcnt(8)
    v_mfma_f32_16x16x32_bf16 a[0:3], v[16:19], v[120:123], a[0:3]
    s_waitcnt vmcnt(19)
    v_mfma_f32_16x16x32_bf16 a[20:23], v[16:19], v[124:127], a[20:23]
    s_waitcnt vmcnt(18)
    v_mfma_f32_16x16x32_bf16 a[40:43], v[16:19], v[128:131], a[40:43]
    s_waitcnt vmcnt(17)
    v_mfma_f32_16x16x32_bf16 a[60:63], v[16:19], v[132:135], a[60:63]
    s_waitcnt vmcnt(16)
    v_mfma_f32_16x16x32_bf16 a[80:83], v[16:19], v[136:139], a[80:83]
    s_waitcnt vmcnt(15)
    v_mfma_f32_16x16x32_bf16 a[100:103], v[16:19], v[140:143], a[100:103]
    s_waitcnt vmcnt(14)
    v_mfma_f32_16x16x32_bf16 a[120:123], v[16:19], v[144:147], a[120:123]
    s_waitcnt vmcnt(13)
    v_mfma_f32_16x16x32_bf16 a[140:143], v[16:19], v[148:151], a[140:143]
    s_waitcnt lgkmcnt(6)
    v_mfma_f32_16x16x32_bf16 a[4:7], v[20:23], v[120:123], a[4:7]
    v_mfma_f32_16x16x32_bf16 a[24:27], v[20:23], v[124:127], a[24:27]
    v_mfma_f32_16x16x32_bf16 a[44:47], v[20:23], v[128:131], a[44:47]
    v_mfma_f32_16x16x32_bf16 a[64:67], v[20:23], v[132:135], a[64:67]
    v_mfma_f32_16x16x32_bf16 a[84:87], v[20:23], v[136:139], a[84:87]
    v_mfma_f32_16x16x32_bf16 a[104:107], v[20:23], v[140:143], a[104:107]
    v_mfma_f32_16x16x32_bf16 a[124:127], v[20:23], v[144:147], a[124:127]
    v_mfma_f32_16x16x32_bf16 a[144:147], v[20:23], v[148:151], a[144:147]
    s_waitcnt lgkmcnt(4)
    v_mfma_f32_16x16x32_bf16 a[8:11], v[24:27], v[120:123], a[8:11]
    v_mfma_f32_16x16x32_bf16 a[28:31], v[24:27], v[124:127], a[28:31]
    v_mfma_f32_16x16x32_bf16 a[48:51], v[24:27], v[128:131], a[48:51]
    v_mfma_f32_16x16x32_bf16 a[68:71], v[24:27], v[132:135], a[68:71]
    v_mfma_f32_16x16x32_bf16 a[88:91], v[24:27], v[136:139], a[88:91]
    s_waitcnt vmcnt(8)
    v_mfma_f32_16x16x32_bf16 a[108:111], v[24:27], v[140:143], a[108:111]
    ds_read_b64_tr_b16 v[36:37], v190 offset:15360
    ds_read_b64_tr_b16 v[38:39], v190 offset:16640
    v_mfma_f32_16x16x32_bf16 a[128:131], v[24:27], v[144:147], a[128:131]
    ds_read_b64_tr_b16 v[40:41], v190 offset:15392
    ds_read_b64_tr_b16 v[42:43], v190 offset:16672
    v_mfma_f32_16x16x32_bf16 a[148:151], v[24:27], v[148:151], a[148:151]
    ds_read_b64_tr_b16 v[44:45], v190 offset:15424
    ds_read_b64_tr_b16 v[46:47], v190 offset:16704
    s_waitcnt lgkmcnt(8)
    v_mfma_f32_16x16x32_bf16 a[12:15], v[28:31], v[120:123], a[12:15]
    ds_read_b64_tr_b16 v[48:49], v190 offset:15456
    ds_read_b64_tr_b16 v[50:51], v190 offset:16736
    v_mfma_f32_16x16x32_bf16 a[32:35], v[28:31], v[124:127], a[32:35]
    ds_read_b64_tr_b16 v[52:53], v190 offset:15488
    ds_read_b64_tr_b16 v[54:55], v190 offset:16768
    v_mfma_f32_16x16x32_bf16 a[52:55], v[28:31], v[128:131], a[52:55]
    v_mfma_f32_16x16x32_bf16 a[72:75], v[28:31], v[132:135], a[72:75]
    v_mfma_f32_16x16x32_bf16 a[92:95], v[28:31], v[136:139], a[92:95]
    v_mfma_f32_16x16x32_bf16 a[112:115], v[28:31], v[140:143], a[112:115]
    v_mfma_f32_16x16x32_bf16 a[132:135], v[28:31], v[144:147], a[132:135]
    v_mfma_f32_16x16x32_bf16 a[152:155], v[28:31], v[148:151], a[152:155]
    s_waitcnt lgkmcnt(10)
    v_mfma_f32_16x16x32_bf16 a[16:19], v[32:35], v[120:123], a[16:19]
    v_mfma_f32_16x16x32_bf16 a[36:39], v[32:35], v[124:127], a[36:39]
    v_mfma_f32_16x16x32_bf16 a[56:59], v[32:35], v[128:131], a[56:59]
    v_mfma_f32_16x16x32_bf16 a[76:79], v[32:35], v[132:135], a[76:79]
    v_mfma_f32_16x16x32_bf16 a[96:99], v[32:35], v[136:139], a[96:99]
    v_mfma_f32_16x16x32_bf16 a[116:119], v[32:35], v[140:143], a[116:119]
    v_mfma_f32_16x16x32_bf16 a[136:139], v[32:35], v[144:147], a[136:139]
    v_mfma_f32_16x16x32_bf16 a[156:159], v[32:35], v[148:151], a[156:159]
    s_waitcnt vmcnt(7) lgkmcnt(8)
    v_mfma_f32_16x16x32_bf16 a[0:3], v[36:39], v[152:155], a[0:3]
    s_waitcnt vmcnt(6)
    v_mfma_f32_16x16x32_bf16 a[20:23], v[36:39], v[156:159], a[20:23]
    s_waitcnt vmcnt(5)
    v_mfma_f32_16x16x32_bf16 a[40:43], v[36:39], v[160:163], a[40:43]
    s_waitcnt vmcnt(4)
    v_mfma_f32_16x16x32_bf16 a[60:63], v[36:39], v[164:167], a[60:63]
    s_waitcnt vmcnt(3)
    v_mfma_f32_16x16x32_bf16 a[80:83], v[36:39], v[168:171], a[80:83]
    s_waitcnt vmcnt(2)
    v_mfma_f32_16x16x32_bf16 a[100:103], v[36:39], v[172:175], a[100:103]
    s_waitcnt vmcnt(1)
    v_mfma_f32_16x16x32_bf16 a[120:123], v[36:39], v[176:179], a[120:123]
    s_waitcnt vmcnt(0)
    v_mfma_f32_16x16x32_bf16 a[140:143], v[36:39], v[180:183], a[140:143]
    s_waitcnt lgkmcnt(6)
    v_mfma_f32_16x16x32_bf16 a[4:7], v[40:43], v[152:155], a[4:7]
    v_mfma_f32_16x16x32_bf16 a[24:27], v[40:43], v[156:159], a[24:27]
    v_mfma_f32_16x16x32_bf16 a[44:47], v[40:43], v[160:163], a[44:47]
    v_mfma_f32_16x16x32_bf16 a[64:67], v[40:43], v[164:167], a[64:67]
    v_mfma_f32_16x16x32_bf16 a[84:87], v[40:43], v[168:171], a[84:87]
    v_mfma_f32_16x16x32_bf16 a[104:107], v[40:43], v[172:175], a[104:107]
    v_mfma_f32_16x16x32_bf16 a[124:127], v[40:43], v[176:179], a[124:127]
    v_mfma_f32_16x16x32_bf16 a[144:147], v[40:43], v[180:183], a[144:147]
    s_waitcnt lgkmcnt(4)
    v_mfma_f32_16x16x32_bf16 a[8:11], v[44:47], v[152:155], a[8:11]
    v_mfma_f32_16x16x32_bf16 a[28:31], v[44:47], v[156:159], a[28:31]
    v_mfma_f32_16x16x32_bf16 a[48:51], v[44:47], v[160:163], a[48:51]
    v_mfma_f32_16x16x32_bf16 a[68:71], v[44:47], v[164:167], a[68:71]
    v_mfma_f32_16x16x32_bf16 a[88:91], v[44:47], v[168:171], a[88:91]
    v_mfma_f32_16x16x32_bf16 a[108:111], v[44:47], v[172:175], a[108:111]
    v_mfma_f32_16x16x32_bf16 a[128:131], v[44:47], v[176:179], a[128:131]
    v_mfma_f32_16x16x32_bf16 a[148:151], v[44:47], v[180:183], a[148:151]
    s_waitcnt lgkmcnt(2)
    v_mfma_f32_16x16x32_bf16 a[12:15], v[48:51], v[152:155], a[12:15]
    v_mfma_f32_16x16x32_bf16 a[32:35], v[48:51], v[156:159], a[32:35]
    v_mfma_f32_16x16x32_bf16 a[52:55], v[48:51], v[160:163], a[52:55]
    v_mfma_f32_16x16x32_bf16 a[72:75], v[48:51], v[164:167], a[72:75]
    v_mfma_f32_16x16x32_bf16 a[92:95], v[48:51], v[168:171], a[92:95]
    v_mfma_f32_16x16x32_bf16 a[112:115], v[48:51], v[172:175], a[112:115]
    v_mfma_f32_16x16x32_bf16 a[132:135], v[48:51], v[176:179], a[132:135]
    v_mfma_f32_16x16x32_bf16 a[152:155], v[48:51], v[180:183], a[152:155]
    s_waitcnt lgkmcnt(0)
    v_mfma_f32_16x16x32_bf16 a[16:19], v[52:55], v[152:155], a[16:19]
    v_mfma_f32_16x16x32_bf16 a[36:39], v[52:55], v[156:159], a[36:39]
    v_mfma_f32_16x16x32_bf16 a[56:59], v[52:55], v[160:163], a[56:59]
    v_mfma_f32_16x16x32_bf16 a[76:79], v[52:55], v[164:167], a[76:79]
    v_mfma_f32_16x16x32_bf16 a[96:99], v[52:55], v[168:171], a[96:99]
    v_mfma_f32_16x16x32_bf16 a[116:119], v[52:55], v[172:175], a[116:119]
    v_mfma_f32_16x16x32_bf16 a[136:139], v[52:55], v[176:179], a[136:139]
    v_mfma_f32_16x16x32_bf16 a[156:159], v[52:55], v[180:183], a[156:159]
    s_barrier
    s_cmp_lg_u32 s39, 0
    s_cbranch_scc1 L_red0
    v_accvgpr_read_b32 v204, a40
    v_accvgpr_read_b32 v205, a41
    v_accvgpr_read_b32 v206, a42
    v_accvgpr_read_b32 v207, a43
    ds_write_b128 v192, v[204:207] offset:51200
    v_accvgpr_read_b32 v208, a44
    v_accvgpr_read_b32 v209, a45
    v_accvgpr_read_b32 v210, a46
    v_accvgpr_read_b32 v211, a47
    ds_write_b128 v192, v[208:211] offset:52224
    v_accvgpr_read_b32 v212, a48
    v_accvgpr_read_b32 v213, a49
    v_accvgpr_read_b32 v214, a50
    v_accvgpr_read_b32 v215, a51
    ds_write_b128 v192, v[212:215] offset:53248
    v_accvgpr_read_b32 v216, a52
    v_accvgpr_read_b32 v217, a53
    v_accvgpr_read_b32 v218, a54
    v_accvgpr_read_b32 v219, a55
    ds_write_b128 v192, v[216:219] offset:54272
    v_accvgpr_read_b32 v220, a56
    v_accvgpr_read_b32 v221, a57
    v_accvgpr_read_b32 v222, a58
    v_accvgpr_read_b32 v223, a59
    ds_write_b128 v192, v[220:223] offset:55296
    v_accvgpr_read_b32 v204, a60
    v_accvgpr_read_b32 v205, a61
    v_accvgpr_read_b32 v206, a62
    v_accvgpr_read_b32 v207, a63
    ds_write_b128 v192, v[204:207] offset:56320
    v_accvgpr_read_b32 v208, a64
    v_accvgpr_read_b32 v209, a65
    v_accvgpr_read_b32 v210, a66
    v_accvgpr_read_b32 v211, a67
    ds_write_b128 v192, v[208:211] offset:57344
    v_accvgpr_read_b32 v212, a68
    v_accvgpr_read_b32 v213, a69
    v_accvgpr_read_b32 v214, a70
    v_accvgpr_read_b32 v215, a71
    ds_write_b128 v192, v[212:215] offset:58368
    v_accvgpr_read_b32 v216, a72
    v_accvgpr_read_b32 v217, a73
    v_accvgpr_read_b32 v218, a74
    v_accvgpr_read_b32 v219, a75
    ds_write_b128 v192, v[216:219] offset:59392
    v_accvgpr_read_b32 v220, a76
    v_accvgpr_read_b32 v221, a77
    v_accvgpr_read_b32 v222, a78
    v_accvgpr_read_b32 v223, a79
    ds_write_b128 v192, v[220:223] offset:60416
    v_accvgpr_read_b32 v204, a80
    v_accvgpr_read_b32 v205, a81
    v_accvgpr_read_b32 v206, a82
    v_accvgpr_read_b32 v207, a83
    ds_write_b128 v193, v[204:207] offset:10240
    v_accvgpr_read_b32 v208, a84
    v_accvgpr_read_b32 v209, a85
    v_accvgpr_read_b32 v210, a86
    v_accvgpr_read_b32 v211, a87
    ds_write_b128 v193, v[208:211] offset:11264
    v_accvgpr_read_b32 v212, a88
    v_accvgpr_read_b32 v213, a89
    v_accvgpr_read_b32 v214, a90
    v_accvgpr_read_b32 v215, a91
    ds_write_b128 v193, v[212:215] offset:12288
    v_accvgpr_read_b32 v216, a92
    v_accvgpr_read_b32 v217, a93
    v_accvgpr_read_b32 v218, a94
    v_accvgpr_read_b32 v219, a95
    ds_write_b128 v193, v[216:219] offset:13312
    v_accvgpr_read_b32 v220, a96
    v_accvgpr_read_b32 v221, a97
    v_accvgpr_read_b32 v222, a98
    v_accvgpr_read_b32 v223, a99
    ds_write_b128 v193, v[220:223] offset:14336
    v_accvgpr_read_b32 v204, a100
    v_accvgpr_read_b32 v205, a101
    v_accvgpr_read_b32 v206, a102
    v_accvgpr_read_b32 v207, a103
    ds_write_b128 v193, v[204:207] offset:15360
    v_accvgpr_read_b32 v208, a104
    v_accvgpr_read_b32 v209, a105
    v_accvgpr_read_b32 v210, a106
    v_accvgpr_read_b32 v211, a107
    ds_write_b128 v193, v[208:211] offset:16384
    v_accvgpr_read_b32 v212, a108
    v_accvgpr_read_b32 v213, a109
    v_accvgpr_read_b32 v214, a110
    v_accvgpr_read_b32 v215, a111
    ds_write_b128 v193, v[212:215] offset:17408
    v_accvgpr_read_b32 v216, a112
    v_accvgpr_read_b32 v217, a113
    v_accvgpr_read_b32 v218, a114
    v_accvgpr_read_b32 v219, a115
    ds_write_b128 v193, v[216:219] offset:18432
    v_accvgpr_read_b32 v220, a116
    v_accvgpr_read_b32 v221, a117
    v_accvgpr_read_b32 v222, a118
    v_accvgpr_read_b32 v223, a119
    ds_write_b128 v193, v[220:223] offset:19456
    v_accvgpr_read_b32 v204, a120
    v_accvgpr_read_b32 v205, a121
    v_accvgpr_read_b32 v206, a122
    v_accvgpr_read_b32 v207, a123
    ds_write_b128 v193, v[204:207] offset:30720
    v_accvgpr_read_b32 v208, a124
    v_accvgpr_read_b32 v209, a125
    v_accvgpr_read_b32 v210, a126
    v_accvgpr_read_b32 v211, a127
    ds_write_b128 v193, v[208:211] offset:31744
    v_accvgpr_read_b32 v212, a128
    v_accvgpr_read_b32 v213, a129
    v_accvgpr_read_b32 v214, a130
    v_accvgpr_read_b32 v215, a131
    ds_write_b128 v193, v[212:215] offset:32768
    v_accvgpr_read_b32 v216, a132
    v_accvgpr_read_b32 v217, a133
    v_accvgpr_read_b32 v218, a134
    v_accvgpr_read_b32 v219, a135
    ds_write_b128 v193, v[216:219] offset:33792
    v_accvgpr_read_b32 v220, a136
    v_accvgpr_read_b32 v221, a137
    v_accvgpr_read_b32 v222, a138
    v_accvgpr_read_b32 v223, a139
    ds_write_b128 v193, v[220:223] offset:34816
    v_accvgpr_read_b32 v204, a140
    v_accvgpr_read_b32 v205, a141
    v_accvgpr_read_b32 v206, a142
    v_accvgpr_read_b32 v207, a143
    ds_write_b128 v193, v[204:207] offset:35840
    v_accvgpr_read_b32 v208, a144
    v_accvgpr_read_b32 v209, a145
    v_accvgpr_read_b32 v210, a146
    v_accvgpr_read_b32 v211, a147
    ds_write_b128 v193, v[208:211] offset:36864
    v_accvgpr_read_b32 v212, a148
    v_accvgpr_read_b32 v213, a149
    v_accvgpr_read_b32 v214, a150
    v_accvgpr_read_b32 v215, a151
    ds_write_b128 v193, v[212:215] offset:37888
    v_accvgpr_read_b32 v216, a152
    v_accvgpr_read_b32 v217, a153
    v_accvgpr_read_b32 v218, a154
    v_accvgpr_read_b32 v219, a155
    ds_write_b128 v193, v[216:219] offset:38912
    v_accvgpr_read_b32 v220, a156
    v_accvgpr_read_b32 v221, a157
    v_accvgpr_read_b32 v222, a158
    v_accvgpr_read_b32 v223, a159
    ds_write_b128 v193, v[220:223] offset:39936
    v_accvgpr_read_b32 v204, a0
    v_accvgpr_read_b32 v205, a1
    v_accvgpr_read_b32 v206, a2
    v_accvgpr_read_b32 v207, a3
    v_accvgpr_read_b32 v208, a4
    v_accvgpr_read_b32 v209, a5
    v_accvgpr_read_b32 v210, a6
    v_accvgpr_read_b32 v211, a7
    v_accvgpr_read_b32 v212, a8
    v_accvgpr_read_b32 v213, a9
    v_accvgpr_read_b32 v214, a10
    v_accvgpr_read_b32 v215, a11
    v_accvgpr_read_b32 v216, a12
    v_accvgpr_read_b32 v217, a13
    v_accvgpr_read_b32 v218, a14
    v_accvgpr_read_b32 v219, a15
    v_accvgpr_read_b32 v220, a16
    v_accvgpr_read_b32 v221, a17
    v_accvgpr_read_b32 v222, a18
    v_accvgpr_read_b32 v223, a19
    v_accvgpr_read_b32 v224, a20
    v_accvgpr_read_b32 v225, a21
    v_accvgpr_read_b32 v226, a22
    v_accvgpr_read_b32 v227, a23
    v_accvgpr_read_b32 v228, a24
    v_accvgpr_read_b32 v229, a25
    v_accvgpr_read_b32 v230, a26
    v_accvgpr_read_b32 v231, a27
    v_accvgpr_read_b32 v232, a28
    v_accvgpr_read_b32 v233, a29
    v_accvgpr_read_b32 v234, a30
    v_accvgpr_read_b32 v235, a31
    v_accvgpr_read_b32 v236, a32
    v_accvgpr_read_b32 v237, a33
    v_accvgpr_read_b32 v238, a34
    v_accvgpr_read_b32 v239, a35
    v_accvgpr_read_b32 v240, a36
    v_accvgpr_read_b32 v241, a37
    v_accvgpr_read_b32 v242, a38
    v_accvgpr_read_b32 v243, a39
L_red0:
    s_cmp_lg_u32 s39, 1
    s_cbranch_scc1 L_red1
    v_accvgpr_read_b32 v204, a80
    v_accvgpr_read_b32 v205, a81
    v_accvgpr_read_b32 v206, a82
    v_accvgpr_read_b32 v207, a83
    ds_write_b128 v193, v[204:207] offset:20480
    v_accvgpr_read_b32 v208, a84
    v_accvgpr_read_b32 v209, a85
    v_accvgpr_read_b32 v210, a86
    v_accvgpr_read_b32 v211, a87
    ds_write_b128 v193, v[208:211] offset:21504
    v_accvgpr_read_b32 v212, a88
    v_accvgpr_read_b32 v213, a89
    v_accvgpr_read_b32 v214, a90
    v_accvgpr_read_b32 v215, a91
    ds_write_b128 v193, v[212:215] offset:22528
    v_accvgpr_read_b32 v216, a92
    v_accvgpr_read_b32 v217, a93
    v_accvgpr_read_b32 v218, a94
    v_accvgpr_read_b32 v219, a95
    ds_write_b128 v193, v[216:219] offset:23552
    v_accvgpr_read_b32 v220, a96
    v_accvgpr_read_b32 v221, a97
    v_accvgpr_read_b32 v222, a98
    v_accvgpr_read_b32 v223, a99
    ds_write_b128 v193, v[220:223] offset:24576
    v_accvgpr_read_b32 v204, a100
    v_accvgpr_read_b32 v205, a101
    v_accvgpr_read_b32 v206, a102
    v_accvgpr_read_b32 v207, a103
    ds_write_b128 v193, v[204:207] offset:25600
    v_accvgpr_read_b32 v208, a104
    v_accvgpr_read_b32 v209, a105
    v_accvgpr_read_b32 v210, a106
    v_accvgpr_read_b32 v211, a107
    ds_write_b128 v193, v[208:211] offset:26624
    v_accvgpr_read_b32 v212, a108
    v_accvgpr_read_b32 v213, a109
    v_accvgpr_read_b32 v214, a110
    v_accvgpr_read_b32 v215, a111
    ds_write_b128 v193, v[212:215] offset:27648
    v_accvgpr_read_b32 v216, a112
    v_accvgpr_read_b32 v217, a113
    v_accvgpr_read_b32 v218, a114
    v_accvgpr_read_b32 v219, a115
    ds_write_b128 v193, v[216:219] offset:28672
    v_accvgpr_read_b32 v220, a116
    v_accvgpr_read_b32 v221, a117
    v_accvgpr_read_b32 v222, a118
    v_accvgpr_read_b32 v223, a119
    ds_write_b128 v193, v[220:223] offset:29696
    v_accvgpr_read_b32 v204, a120
    v_accvgpr_read_b32 v205, a121
    v_accvgpr_read_b32 v206, a122
    v_accvgpr_read_b32 v207, a123
    ds_write_b128 v193, v[204:207] offset:40960
    v_accvgpr_read_b32 v208, a124
    v_accvgpr_read_b32 v209, a125
    v_accvgpr_read_b32 v210, a126
    v_accvgpr_read_b32 v211, a127
    ds_write_b128 v193, v[208:211] offset:41984
    v_accvgpr_read_b32 v212, a128
    v_accvgpr_read_b32 v213, a129
    v_accvgpr_read_b32 v214, a130
    v_accvgpr_read_b32 v215, a131
    ds_write_b128 v193, v[212:215] offset:43008
    v_accvgpr_read_b32 v216, a132
    v_accvgpr_read_b32 v217, a133
    v_accvgpr_read_b32 v218, a134
    v_accvgpr_read_b32 v219, a135
    ds_write_b128 v193, v[216:219] offset:44032
    v_accvgpr_read_b32 v220, a136
    v_accvgpr_read_b32 v221, a137
    v_accvgpr_read_b32 v222, a138
    v_accvgpr_read_b32 v223, a139
    ds_write_b128 v193, v[220:223] offset:45056
    v_accvgpr_read_b32 v204, a140
    v_accvgpr_read_b32 v205, a141
    v_accvgpr_read_b32 v206, a142
    v_accvgpr_read_b32 v207, a143
    ds_write_b128 v193, v[204:207] offset:46080
    v_accvgpr_read_b32 v208, a144
    v_accvgpr_read_b32 v209, a145
    v_accvgpr_read_b32 v210, a146
    v_accvgpr_read_b32 v211, a147
    ds_write_b128 v193, v[208:211] offset:47104
    v_accvgpr_read_b32 v212, a148
    v_accvgpr_read_b32 v213, a149
    v_accvgpr_read_b32 v214, a150
    v_accvgpr_read_b32 v215, a151
    ds_write_b128 v193, v[212:215] offset:48128
    v_accvgpr_read_b32 v216, a152
    v_accvgpr_read_b32 v217, a153
    v_accvgpr_read_b32 v218, a154
    v_accvgpr_read_b32 v219, a155
    ds_write_b128 v193, v[216:219] offset:49152
    v_accvgpr_read_b32 v220, a156
    v_accvgpr_read_b32 v221, a157
    v_accvgpr_read_b32 v222, a158
    v_accvgpr_read_b32 v223, a159
    ds_write_b128 v193, v[220:223] offset:50176
    v_accvgpr_read_b32 v204, a0
    v_accvgpr_read_b32 v205, a1
    v_accvgpr_read_b32 v206, a2
    v_accvgpr_read_b32 v207, a3
    ds_write_b128 v192, v[204:207] offset:0
    v_accvgpr_read_b32 v208, a4
    v_accvgpr_read_b32 v209, a5
    v_accvgpr_read_b32 v210, a6
    v_accvgpr_read_b32 v211, a7
    ds_write_b128 v192, v[208:211] offset:1024
    v_accvgpr_read_b32 v212, a8
    v_accvgpr_read_b32 v213, a9
    v_accvgpr_read_b32 v214, a10
    v_accvgpr_read_b32 v215, a11
    ds_write_b128 v192, v[212:215] offset:2048
    v_accvgpr_read_b32 v216, a12
    v_accvgpr_read_b32 v217, a13
    v_accvgpr_read_b32 v218, a14
    v_accvgpr_read_b32 v219, a15
    ds_write_b128 v192, v[216:219] offset:3072
    v_accvgpr_read_b32 v220, a16
    v_accvgpr_read_b32 v221, a17
    v_accvgpr_read_b32 v222, a18
    v_accvgpr_read_b32 v223, a19
    ds_write_b128 v192, v[220:223] offset:4096
    v_accvgpr_read_b32 v204, a20
    v_accvgpr_read_b32 v205, a21
    v_accvgpr_read_b32 v206, a22
    v_accvgpr_read_b32 v207, a23
    ds_write_b128 v192, v[204:207] offset:5120
    v_accvgpr_read_b32 v208, a24
    v_accvgpr_read_b32 v209, a25
    v_accvgpr_read_b32 v210, a26
    v_accvgpr_read_b32 v211, a27
    ds_write_b128 v192, v[208:211] offset:6144
    v_accvgpr_read_b32 v212, a28
    v_accvgpr_read_b32 v213, a29
    v_accvgpr_read_b32 v214, a30
    v_accvgpr_read_b32 v215, a31
    ds_write_b128 v192, v[212:215] offset:7168
    v_accvgpr_read_b32 v216, a32
    v_accvgpr_read_b32 v217, a33
    v_accvgpr_read_b32 v218, a34
    v_accvgpr_read_b32 v219, a35
    ds_write_b128 v192, v[216:219] offset:8192
    v_accvgpr_read_b32 v220, a36
    v_accvgpr_read_b32 v221, a37
    v_accvgpr_read_b32 v222, a38
    v_accvgpr_read_b32 v223, a39
    ds_write_b128 v192, v[220:223] offset:9216
    v_accvgpr_read_b32 v204, a40
    v_accvgpr_read_b32 v205, a41
    v_accvgpr_read_b32 v206, a42
    v_accvgpr_read_b32 v207, a43
    v_accvgpr_read_b32 v208, a44
    v_accvgpr_read_b32 v209, a45
    v_accvgpr_read_b32 v210, a46
    v_accvgpr_read_b32 v211, a47
    v_accvgpr_read_b32 v212, a48
    v_accvgpr_read_b32 v213, a49
    v_accvgpr_read_b32 v214, a50
    v_accvgpr_read_b32 v215, a51
    v_accvgpr_read_b32 v216, a52
    v_accvgpr_read_b32 v217, a53
    v_accvgpr_read_b32 v218, a54
    v_accvgpr_read_b32 v219, a55
    v_accvgpr_read_b32 v220, a56
    v_accvgpr_read_b32 v221, a57
    v_accvgpr_read_b32 v222, a58
    v_accvgpr_read_b32 v223, a59
    v_accvgpr_read_b32 v224, a60
    v_accvgpr_read_b32 v225, a61
    v_accvgpr_read_b32 v226, a62
    v_accvgpr_read_b32 v227, a63
    v_accvgpr_read_b32 v228, a64
    v_accvgpr_read_b32 v229, a65
    v_accvgpr_read_b32 v230, a66
    v_accvgpr_read_b32 v231, a67
    v_accvgpr_read_b32 v232, a68
    v_accvgpr_read_b32 v233, a69
    v_accvgpr_read_b32 v234, a70
    v_accvgpr_read_b32 v235, a71
    v_accvgpr_read_b32 v236, a72
    v_accvgpr_read_b32 v237, a73
    v_accvgpr_read_b32 v238, a74
    v_accvgpr_read_b32 v239, a75
    v_accvgpr_read_b32 v240, a76
    v_accvgpr_read_b32 v241, a77
    v_accvgpr_read_b32 v242, a78
    v_accvgpr_read_b32 v243, a79
L_red1:
    s_cmp_lg_u32 s39, 2
    s_cbranch_scc1 L_red2
    v_accvgpr_read_b32 v204, a120
    v_accvgpr_read_b32 v205, a121
    v_accvgpr_read_b32 v206, a122
    v_accvgpr_read_b32 v207, a123
    ds_write_b128 v193, v[204:207] offset:51200
    v_accvgpr_read_b32 v208, a124
    v_accvgpr_read_b32 v209, a125
    v_accvgpr_read_b32 v210, a126
    v_accvgpr_read_b32 v211, a127
    ds_write_b128 v193, v[208:211] offset:52224
    v_accvgpr_read_b32 v212, a128
    v_accvgpr_read_b32 v213, a129
    v_accvgpr_read_b32 v214, a130
    v_accvgpr_read_b32 v215, a131
    ds_write_b128 v193, v[212:215] offset:53248
    v_accvgpr_read_b32 v216, a132
    v_accvgpr_read_b32 v217, a133
    v_accvgpr_read_b32 v218, a134
    v_accvgpr_read_b32 v219, a135
    ds_write_b128 v193, v[216:219] offset:54272
    v_accvgpr_read_b32 v220, a136
    v_accvgpr_read_b32 v221, a137
    v_accvgpr_read_b32 v222, a138
    v_accvgpr_read_b32 v223, a139
    ds_write_b128 v193, v[220:223] offset:55296
    v_accvgpr_read_b32 v204, a140
    v_accvgpr_read_b32 v205, a141
    v_accvgpr_read_b32 v206, a142
    v_accvgpr_read_b32 v207, a143
    ds_write_b128 v193, v[204:207] offset:56320
    v_accvgpr_read_b32 v208, a144
    v_accvgpr_read_b32 v209, a145
    v_accvgpr_read_b32 v210, a146
    v_accvgpr_read_b32 v211, a147
    ds_write_b128 v193, v[208:211] offset:57344
    v_accvgpr_read_b32 v212, a148
    v_accvgpr_read_b32 v213, a149
    v_accvgpr_read_b32 v214, a150
    v_accvgpr_read_b32 v215, a151
    ds_write_b128 v193, v[212:215] offset:58368
    v_accvgpr_read_b32 v216, a152
    v_accvgpr_read_b32 v217, a153
    v_accvgpr_read_b32 v218, a154
    v_accvgpr_read_b32 v219, a155
    ds_write_b128 v193, v[216:219] offset:59392
    v_accvgpr_read_b32 v220, a156
    v_accvgpr_read_b32 v221, a157
    v_accvgpr_read_b32 v222, a158
    v_accvgpr_read_b32 v223, a159
    ds_write_b128 v193, v[220:223] offset:60416
    v_accvgpr_read_b32 v204, a0
    v_accvgpr_read_b32 v205, a1
    v_accvgpr_read_b32 v206, a2
    v_accvgpr_read_b32 v207, a3
    ds_write_b128 v192, v[204:207] offset:10240
    v_accvgpr_read_b32 v208, a4
    v_accvgpr_read_b32 v209, a5
    v_accvgpr_read_b32 v210, a6
    v_accvgpr_read_b32 v211, a7
    ds_write_b128 v192, v[208:211] offset:11264
    v_accvgpr_read_b32 v212, a8
    v_accvgpr_read_b32 v213, a9
    v_accvgpr_read_b32 v214, a10
    v_accvgpr_read_b32 v215, a11
    ds_write_b128 v192, v[212:215] offset:12288
    v_accvgpr_read_b32 v216, a12
    v_accvgpr_read_b32 v217, a13
    v_accvgpr_read_b32 v218, a14
    v_accvgpr_read_b32 v219, a15
    ds_write_b128 v192, v[216:219] offset:13312
    v_accvgpr_read_b32 v220, a16
    v_accvgpr_read_b32 v221, a17
    v_accvgpr_read_b32 v222, a18
    v_accvgpr_read_b32 v223, a19
    ds_write_b128 v192, v[220:223] offset:14336
    v_accvgpr_read_b32 v204, a20
    v_accvgpr_read_b32 v205, a21
    v_accvgpr_read_b32 v206, a22
    v_accvgpr_read_b32 v207, a23
    ds_write_b128 v192, v[204:207] offset:15360
    v_accvgpr_read_b32 v208, a24
    v_accvgpr_read_b32 v209, a25
    v_accvgpr_read_b32 v210, a26
    v_accvgpr_read_b32 v211, a27
    ds_write_b128 v192, v[208:211] offset:16384
    v_accvgpr_read_b32 v212, a28
    v_accvgpr_read_b32 v213, a29
    v_accvgpr_read_b32 v214, a30
    v_accvgpr_read_b32 v215, a31
    ds_write_b128 v192, v[212:215] offset:17408
    v_accvgpr_read_b32 v216, a32
    v_accvgpr_read_b32 v217, a33
    v_accvgpr_read_b32 v218, a34
    v_accvgpr_read_b32 v219, a35
    ds_write_b128 v192, v[216:219] offset:18432
    v_accvgpr_read_b32 v220, a36
    v_accvgpr_read_b32 v221, a37
    v_accvgpr_read_b32 v222, a38
    v_accvgpr_read_b32 v223, a39
    ds_write_b128 v192, v[220:223] offset:19456
    v_accvgpr_read_b32 v204, a40
    v_accvgpr_read_b32 v205, a41
    v_accvgpr_read_b32 v206, a42
    v_accvgpr_read_b32 v207, a43
    ds_write_b128 v192, v[204:207] offset:30720
    v_accvgpr_read_b32 v208, a44
    v_accvgpr_read_b32 v209, a45
    v_accvgpr_read_b32 v210, a46
    v_accvgpr_read_b32 v211, a47
    ds_write_b128 v192, v[208:211] offset:31744
    v_accvgpr_read_b32 v212, a48
    v_accvgpr_read_b32 v213, a49
    v_accvgpr_read_b32 v214, a50
    v_accvgpr_read_b32 v215, a51
    ds_write_b128 v192, v[212:215] offset:32768
    v_accvgpr_read_b32 v216, a52
    v_accvgpr_read_b32 v217, a53
    v_accvgpr_read_b32 v218, a54
    v_accvgpr_read_b32 v219, a55
    ds_write_b128 v192, v[216:219] offset:33792
    v_accvgpr_read_b32 v220, a56
    v_accvgpr_read_b32 v221, a57
    v_accvgpr_read_b32 v222, a58
    v_accvgpr_read_b32 v223, a59
    ds_write_b128 v192, v[220:223] offset:34816
    v_accvgpr_read_b32 v204, a60
    v_accvgpr_read_b32 v205, a61
    v_accvgpr_read_b32 v206, a62
    v_accvgpr_read_b32 v207, a63
    ds_write_b128 v192, v[204:207] offset:35840
    v_accvgpr_read_b32 v208, a64
    v_accvgpr_read_b32 v209, a65
    v_accvgpr_read_b32 v210, a66
    v_accvgpr_read_b32 v211, a67
    ds_write_b128 v192, v[208:211] offset:36864
    v_accvgpr_read_b32 v212, a68
    v_accvgpr_read_b32 v213, a69
    v_accvgpr_read_b32 v214, a70
    v_accvgpr_read_b32 v215, a71
    ds_write_b128 v192, v[212:215] offset:37888
    v_accvgpr_read_b32 v216, a72
    v_accvgpr_read_b32 v217, a73
    v_accvgpr_read_b32 v218, a74
    v_accvgpr_read_b32 v219, a75
    ds_write_b128 v192, v[216:219] offset:38912
    v_accvgpr_read_b32 v220, a76
    v_accvgpr_read_b32 v221, a77
    v_accvgpr_read_b32 v222, a78
    v_accvgpr_read_b32 v223, a79
    ds_write_b128 v192, v[220:223] offset:39936
    v_accvgpr_read_b32 v204, a80
    v_accvgpr_read_b32 v205, a81
    v_accvgpr_read_b32 v206, a82
    v_accvgpr_read_b32 v207, a83
    v_accvgpr_read_b32 v208, a84
    v_accvgpr_read_b32 v209, a85
    v_accvgpr_read_b32 v210, a86
    v_accvgpr_read_b32 v211, a87
    v_accvgpr_read_b32 v212, a88
    v_accvgpr_read_b32 v213, a89
    v_accvgpr_read_b32 v214, a90
    v_accvgpr_read_b32 v215, a91
    v_accvgpr_read_b32 v216, a92
    v_accvgpr_read_b32 v217, a93
    v_accvgpr_read_b32 v218, a94
    v_accvgpr_read_b32 v219, a95
    v_accvgpr_read_b32 v220, a96
    v_accvgpr_read_b32 v221, a97
    v_accvgpr_read_b32 v222, a98
    v_accvgpr_read_b32 v223, a99
    v_accvgpr_read_b32 v224, a100
    v_accvgpr_read_b32 v225, a101
    v_accvgpr_read_b32 v226, a102
    v_accvgpr_read_b32 v227, a103
    v_accvgpr_read_b32 v228, a104
    v_accvgpr_read_b32 v229, a105
    v_accvgpr_read_b32 v230, a106
    v_accvgpr_read_b32 v231, a107
    v_accvgpr_read_b32 v232, a108
    v_accvgpr_read_b32 v233, a109
    v_accvgpr_read_b32 v234, a110
    v_accvgpr_read_b32 v235, a111
    v_accvgpr_read_b32 v236, a112
    v_accvgpr_read_b32 v237, a113
    v_accvgpr_read_b32 v238, a114
    v_accvgpr_read_b32 v239, a115
    v_accvgpr_read_b32 v240, a116
    v_accvgpr_read_b32 v241, a117
    v_accvgpr_read_b32 v242, a118
    v_accvgpr_read_b32 v243, a119
L_red2:
    s_cmp_lg_u32 s39, 3
    s_cbranch_scc1 L_red3
    v_accvgpr_read_b32 v204, a0
    v_accvgpr_read_b32 v205, a1
    v_accvgpr_read_b32 v206, a2
    v_accvgpr_read_b32 v207, a3
    ds_write_b128 v192, v[204:207] offset:20480
    v_accvgpr_read_b32 v208, a4
    v_accvgpr_read_b32 v209, a5
    v_accvgpr_read_b32 v210, a6
    v_accvgpr_read_b32 v211, a7
    ds_write_b128 v192, v[208:211] offset:21504
    v_accvgpr_read_b32 v212, a8
    v_accvgpr_read_b32 v213, a9
    v_accvgpr_read_b32 v214, a10
    v_accvgpr_read_b32 v215, a11
    ds_write_b128 v192, v[212:215] offset:22528
    v_accvgpr_read_b32 v216, a12
    v_accvgpr_read_b32 v217, a13
    v_accvgpr_read_b32 v218, a14
    v_accvgpr_read_b32 v219, a15
    ds_write_b128 v192, v[216:219] offset:23552
    v_accvgpr_read_b32 v220, a16
    v_accvgpr_read_b32 v221, a17
    v_accvgpr_read_b32 v222, a18
    v_accvgpr_read_b32 v223, a19
    ds_write_b128 v192, v[220:223] offset:24576
    v_accvgpr_read_b32 v204, a20
    v_accvgpr_read_b32 v205, a21
    v_accvgpr_read_b32 v206, a22
    v_accvgpr_read_b32 v207, a23
    ds_write_b128 v192, v[204:207] offset:25600
    v_accvgpr_read_b32 v208, a24
    v_accvgpr_read_b32 v209, a25
    v_accvgpr_read_b32 v210, a26
    v_accvgpr_read_b32 v211, a27
    ds_write_b128 v192, v[208:211] offset:26624
    v_accvgpr_read_b32 v212, a28
    v_accvgpr_read_b32 v213, a29
    v_accvgpr_read_b32 v214, a30
    v_accvgpr_read_b32 v215, a31
    ds_write_b128 v192, v[212:215] offset:27648
    v_accvgpr_read_b32 v216, a32
    v_accvgpr_read_b32 v217, a33
    v_accvgpr_read_b32 v218, a34
    v_accvgpr_read_b32 v219, a35
    ds_write_b128 v192, v[216:219] offset:28672
    v_accvgpr_read_b32 v220, a36
    v_accvgpr_read_b32 v221, a37
    v_accvgpr_read_b32 v222, a38
    v_accvgpr_read_b32 v223, a39
    ds_write_b128 v192, v[220:223] offset:29696
    v_accvgpr_read_b32 v204, a40
    v_accvgpr_read_b32 v205, a41
    v_accvgpr_read_b32 v206, a42
    v_accvgpr_read_b32 v207, a43
    ds_write_b128 v192, v[204:207] offset:40960
    v_accvgpr_read_b32 v208, a44
    v_accvgpr_read_b32 v209, a45
    v_accvgpr_read_b32 v210, a46
    v_accvgpr_read_b32 v211, a47
    ds_write_b128 v192, v[208:211] offset:41984
    v_accvgpr_read_b32 v212, a48
    v_accvgpr_read_b32 v213, a49
    v_accvgpr_read_b32 v214, a50
    v_accvgpr_read_b32 v215, a51
    ds_write_b128 v192, v[212:215] offset:43008
    v_accvgpr_read_b32 v216, a52
    v_accvgpr_read_b32 v217, a53
    v_accvgpr_read_b32 v218, a54
    v_accvgpr_read_b32 v219, a55
    ds_write_b128 v192, v[216:219] offset:44032
    v_accvgpr_read_b32 v220, a56
    v_accvgpr_read_b32 v221, a57
    v_accvgpr_read_b32 v222, a58
    v_accvgpr_read_b32 v223, a59
    ds_write_b128 v192, v[220:223] offset:45056
    v_accvgpr_read_b32 v204, a60
    v_accvgpr_read_b32 v205, a61
    v_accvgpr_read_b32 v206, a62
    v_accvgpr_read_b32 v207, a63
    ds_write_b128 v192, v[204:207] offset:46080
    v_accvgpr_read_b32 v208, a64
    v_accvgpr_read_b32 v209, a65
    v_accvgpr_read_b32 v210, a66
    v_accvgpr_read_b32 v211, a67
    ds_write_b128 v192, v[208:211] offset:47104
    v_accvgpr_read_b32 v212, a68
    v_accvgpr_read_b32 v213, a69
    v_accvgpr_read_b32 v214, a70
    v_accvgpr_read_b32 v215, a71
    ds_write_b128 v192, v[212:215] offset:48128
    v_accvgpr_read_b32 v216, a72
    v_accvgpr_read_b32 v217, a73
    v_accvgpr_read_b32 v218, a74
    v_accvgpr_read_b32 v219, a75
    ds_write_b128 v192, v[216:219] offset:49152
    v_accvgpr_read_b32 v220, a76
    v_accvgpr_read_b32 v221, a77
    v_accvgpr_read_b32 v222, a78
    v_accvgpr_read_b32 v223, a79
    ds_write_b128 v192, v[220:223] offset:50176
    v_accvgpr_read_b32 v204, a80
    v_accvgpr_read_b32 v205, a81
    v_accvgpr_read_b32 v206, a82
    v_accvgpr_read_b32 v207, a83
    ds_write_b128 v193, v[204:207] offset:0
    v_accvgpr_read_b32 v208, a84
    v_accvgpr_read_b32 v209, a85
    v_accvgpr_read_b32 v210, a86
    v_accvgpr_read_b32 v211, a87
    ds_write_b128 v193, v[208:211] offset:1024
    v_accvgpr_read_b32 v212, a88
    v_accvgpr_read_b32 v213, a89
    v_accvgpr_read_b32 v214, a90
    v_accvgpr_read_b32 v215, a91
    ds_write_b128 v193, v[212:215] offset:2048
    v_accvgpr_read_b32 v216, a92
    v_accvgpr_read_b32 v217, a93
    v_accvgpr_read_b32 v218, a94
    v_accvgpr_read_b32 v219, a95
    ds_write_b128 v193, v[216:219] offset:3072
    v_accvgpr_read_b32 v220, a96
    v_accvgpr_read_b32 v221, a97
    v_accvgpr_read_b32 v222, a98
    v_accvgpr_read_b32 v223, a99
    ds_write_b128 v193, v[220:223] offset:4096
    v_accvgpr_read_b32 v204, a100
    v_accvgpr_read_b32 v205, a101
    v_accvgpr_read_b32 v206, a102
    v_accvgpr_read_b32 v207, a103
    ds_write_b128 v193, v[204:207] offset:5120
    v_accvgpr_read_b32 v208, a104
    v_accvgpr_read_b32 v209, a105
    v_accvgpr_read_b32 v210, a106
    v_accvgpr_read_b32 v211, a107
    ds_write_b128 v193, v[208:211] offset:6144
    v_accvgpr_read_b32 v212, a108
    v_accvgpr_read_b32 v213, a109
    v_accvgpr_read_b32 v214, a110
    v_accvgpr_read_b32 v215, a111
    ds_write_b128 v193, v[212:215] offset:7168
    v_accvgpr_read_b32 v216, a112
    v_accvgpr_read_b32 v217, a113
    v_accvgpr_read_b32 v218, a114
    v_accvgpr_read_b32 v219, a115
    ds_write_b128 v193, v[216:219] offset:8192
    v_accvgpr_read_b32 v220, a116
    v_accvgpr_read_b32 v221, a117
    v_accvgpr_read_b32 v222, a118
    v_accvgpr_read_b32 v223, a119
    ds_write_b128 v193, v[220:223] offset:9216
    v_accvgpr_read_b32 v204, a120
    v_accvgpr_read_b32 v205, a121
    v_accvgpr_read_b32 v206, a122
    v_accvgpr_read_b32 v207, a123
    v_accvgpr_read_b32 v208, a124
    v_accvgpr_read_b32 v209, a125
    v_accvgpr_read_b32 v210, a126
    v_accvgpr_read_b32 v211, a127
    v_accvgpr_read_b32 v212, a128
    v_accvgpr_read_b32 v213, a129
    v_accvgpr_read_b32 v214, a130
    v_accvgpr_read_b32 v215, a131
    v_accvgpr_read_b32 v216, a132
    v_accvgpr_read_b32 v217, a133
    v_accvgpr_read_b32 v218, a134
    v_accvgpr_read_b32 v219, a135
    v_accvgpr_read_b32 v220, a136
    v_accvgpr_read_b32 v221, a137
    v_accvgpr_read_b32 v222, a138
    v_accvgpr_read_b32 v223, a139
    v_accvgpr_read_b32 v224, a140
    v_accvgpr_read_b32 v225, a141
    v_accvgpr_read_b32 v226, a142
    v_accvgpr_read_b32 v227, a143
    v_accvgpr_read_b32 v228, a144
    v_accvgpr_read_b32 v229, a145
    v_accvgpr_read_b32 v230, a146
    v_accvgpr_read_b32 v231, a147
    v_accvgpr_read_b32 v232, a148
    v_accvgpr_read_b32 v233, a149
    v_accvgpr_read_b32 v234, a150
    v_accvgpr_read_b32 v235, a151
    v_accvgpr_read_b32 v236, a152
    v_accvgpr_read_b32 v237, a153
    v_accvgpr_read_b32 v238, a154
    v_accvgpr_read_b32 v239, a155
    v_accvgpr_read_b32 v240, a156
    v_accvgpr_read_b32 v241, a157
    v_accvgpr_read_b32 v242, a158
    v_accvgpr_read_b32 v243, a159
L_red3:
    s_waitcnt lgkmcnt(0)
    s_barrier
    s_mul_i32 s29, s39, 30720
    v_add_u32 v192, s29, v192
    ds_read_b128 v[56:59], v192 offset:0
    ds_read_b128 v[60:63], v192 offset:1024
    ds_read_b128 v[64:67], v192 offset:2048
    ds_read_b128 v[68:71], v192 offset:3072
    ds_read_b128 v[72:75], v192 offset:4096
    ds_read_b128 v[76:79], v192 offset:5120
    ds_read_b128 v[80:83], v192 offset:6144
    ds_read_b128 v[84:87], v192 offset:7168
    ds_read_b128 v[88:91], v192 offset:8192
    ds_read_b128 v[92:95], v192 offset:9216
    s_waitcnt lgkmcnt(9)
    v_add_f32 v204, v204, v56
    v_add_f32 v205, v205, v57
    v_add_f32 v206, v206, v58
    v_add_f32 v207, v207, v59
    s_waitcnt lgkmcnt(8)
    v_add_f32 v208, v208, v60
    v_add_f32 v209, v209, v61
    v_add_f32 v210, v210, v62
    v_add_f32 v211, v211, v63
    s_waitcnt lgkmcnt(7)
    v_add_f32 v212, v212, v64
    v_add_f32 v213, v213, v65
    v_add_f32 v214, v214, v66
    v_add_f32 v215, v215, v67
    s_waitcnt lgkmcnt(6)
    v_add_f32 v216, v216, v68
    v_add_f32 v217, v217, v69
    v_add_f32 v218, v218, v70
    v_add_f32 v219, v219, v71
    s_waitcnt lgkmcnt(5)
    v_add_f32 v220, v220, v72
    v_add_f32 v221, v221, v73
    v_add_f32 v222, v222, v74
    v_add_f32 v223, v223, v75
    s_waitcnt lgkmcnt(4)
    v_add_f32 v224, v224, v76
    v_add_f32 v225, v225, v77
    v_add_f32 v226, v226, v78
    v_add_f32 v227, v227, v79
    s_waitcnt lgkmcnt(3)
    v_add_f32 v228, v228, v80
    v_add_f32 v229, v229, v81
    v_add_f32 v230, v230, v82
    v_add_f32 v231, v231, v83
    s_waitcnt lgkmcnt(2)
    v_add_f32 v232, v232, v84
    v_add_f32 v233, v233, v85
    v_add_f32 v234, v234, v86
    v_add_f32 v235, v235, v87
    s_waitcnt lgkmcnt(1)
    v_add_f32 v236, v236, v88
    v_add_f32 v237, v237, v89
    v_add_f32 v238, v238, v90
    v_add_f32 v239, v239, v91
    s_waitcnt lgkmcnt(0)
    v_add_f32 v240, v240, v92
    v_add_f32 v241, v241, v93
    v_add_f32 v242, v242, v94
    v_add_f32 v243, v243, v95
    ds_read_b128 v[120:123], v192 offset:10240
    ds_read_b128 v[124:127], v192 offset:11264
    ds_read_b128 v[128:131], v192 offset:12288
    ds_read_b128 v[132:135], v192 offset:13312
    ds_read_b128 v[136:139], v192 offset:14336
    ds_read_b128 v[140:143], v192 offset:15360
    ds_read_b128 v[144:147], v192 offset:16384
    ds_read_b128 v[148:151], v192 offset:17408
    ds_read_b128 v[152:155], v192 offset:18432
    ds_read_b128 v[156:159], v192 offset:19456
    s_waitcnt lgkmcnt(9)
    v_add_f32 v204, v204, v120
    v_add_f32 v205, v205, v121
    v_add_f32 v206, v206, v122
    v_add_f32 v207, v207, v123
    s_waitcnt lgkmcnt(8)
    v_add_f32 v208, v208, v124
    v_add_f32 v209, v209, v125
    v_add_f32 v210, v210, v126
    v_add_f32 v211, v211, v127
    s_waitcnt lgkmcnt(7)
    v_add_f32 v212, v212, v128
    v_add_f32 v213, v213, v129
    v_add_f32 v214, v214, v130
    v_add_f32 v215, v215, v131
    s_waitcnt lgkmcnt(6)
    v_add_f32 v216, v216, v132
    v_add_f32 v217, v217, v133
    v_add_f32 v218, v218, v134
    v_add_f32 v219, v219, v135
    s_waitcnt lgkmcnt(5)
    v_add_f32 v220, v220, v136
    v_add_f32 v221, v221, v137
    v_add_f32 v222, v222, v138
    v_add_f32 v223, v223, v139
    s_waitcnt lgkmcnt(4)
    v_add_f32 v224, v224, v140
    v_add_f32 v225, v225, v141
    v_add_f32 v226, v226, v142
    v_add_f32 v227, v227, v143
    s_waitcnt lgkmcnt(3)
    v_add_f32 v228, v228, v144
    v_add_f32 v229, v229, v145
    v_add_f32 v230, v230, v146
    v_add_f32 v231, v231, v147
    s_waitcnt lgkmcnt(2)
    v_add_f32 v232, v232, v148
    v_add_f32 v233, v233, v149
    v_add_f32 v234, v234, v150
    v_add_f32 v235, v235, v151
    s_waitcnt lgkmcnt(1)
    v_add_f32 v236, v236, v152
    v_add_f32 v237, v237, v153
    v_add_f32 v238, v238, v154
    v_add_f32 v239, v239, v155
    s_waitcnt lgkmcnt(0)
    v_add_f32 v240, v240, v156
    v_add_f32 v241, v241, v157
    v_add_f32 v242, v242, v158
    v_add_f32 v243, v243, v159
    ds_read_b128 v[56:59], v192 offset:20480
    ds_read_b128 v[60:63], v192 offset:21504
    ds_read_b128 v[64:67], v192 offset:22528
    ds_read_b128 v[68:71], v192 offset:23552
    ds_read_b128 v[72:75], v192 offset:24576
    ds_read_b128 v[76:79], v192 offset:25600
    ds_read_b128 v[80:83], v192 offset:26624
    ds_read_b128 v[84:87], v192 offset:27648
    ds_read_b128 v[88:91], v192 offset:28672
    ds_read_b128 v[92:95], v192 offset:29696
    s_waitcnt lgkmcnt(9)
    v_add_f32 v204, v204, v56
    v_add_f32 v205, v205, v57
    v_add_f32 v206, v206, v58
    v_add_f32 v207, v207, v59
    s_waitcnt lgkmcnt(8)
    v_add_f32 v208, v208, v60
    v_add_f32 v209, v209, v61
    v_add_f32 v210, v210, v62
    v_add_f32 v211, v211, v63
    s_waitcnt lgkmcnt(7)
    v_add_f32 v212, v212, v64
    v_add_f32 v213, v213, v65
    v_add_f32 v214, v214, v66
    v_add_f32 v215, v215, v67
    s_waitcnt lgkmcnt(6)
    v_add_f32 v216, v216, v68
    v_add_f32 v217, v217, v69
    v_add_f32 v218, v218, v70
    v_add_f32 v219, v219, v71
    s_waitcnt lgkmcnt(5)
    v_add_f32 v220, v220, v72
    v_add_f32 v221, v221, v73
    v_add_f32 v222, v222, v74
    v_add_f32 v223, v223, v75
    s_waitcnt lgkmcnt(4)
    v_add_f32 v224, v224, v76
    v_add_f32 v225, v225, v77
    v_add_f32 v226, v226, v78
    v_add_f32 v227, v227, v79
    s_waitcnt lgkmcnt(3)
    v_add_f32 v228, v228, v80
    v_add_f32 v229, v229, v81
    v_add_f32 v230, v230, v82
    v_add_f32 v231, v231, v83
    s_waitcnt lgkmcnt(2)
    v_add_f32 v232, v232, v84
    v_add_f32 v233, v233, v85
    v_add_f32 v234, v234, v86
    v_add_f32 v235, v235, v87
    s_waitcnt lgkmcnt(1)
    v_add_f32 v236, v236, v88
    v_add_f32 v237, v237, v89
    v_add_f32 v238, v238, v90
    v_add_f32 v239, v239, v91
    s_waitcnt lgkmcnt(0)
    v_add_f32 v240, v240, v92
    v_add_f32 v241, v241, v93
    v_add_f32 v242, v242, v94
    v_add_f32 v243, v243, v95
    v_cvt_pk_bf16_f32 v16, v204, v205
    v_cvt_pk_bf16_f32 v17, v206, v207
    s_mov_b32 s29, 0
    buffer_store_dwordx2 v[16:17], v191, s[20:23], s29 offen offset:0
    v_cvt_pk_bf16_f32 v18, v208, v209
    v_cvt_pk_bf16_f32 v19, v210, v211
    s_mov_b32 s29, 0
    buffer_store_dwordx2 v[18:19], v191, s[20:23], s29 offen offset:32
    v_cvt_pk_bf16_f32 v20, v212, v213
    v_cvt_pk_bf16_f32 v21, v214, v215
    s_mov_b32 s29, 0
    buffer_store_dwordx2 v[20:21], v191, s[20:23], s29 offen offset:64
    v_cvt_pk_bf16_f32 v22, v216, v217
    v_cvt_pk_bf16_f32 v23, v218, v219
    s_mov_b32 s29, 0
    buffer_store_dwordx2 v[22:23], v191, s[20:23], s29 offen offset:96
    v_cvt_pk_bf16_f32 v24, v220, v221
    v_cvt_pk_bf16_f32 v25, v222, v223
    s_mov_b32 s29, 0
    buffer_store_dwordx2 v[24:25], v191, s[20:23], s29 offen offset:128
    v_cvt_pk_bf16_f32 v26, v224, v225
    v_cvt_pk_bf16_f32 v27, v226, v227
    s_mov_b32 s29, 40960
    buffer_store_dwordx2 v[26:27], v191, s[20:23], s29 offen offset:0
    v_cvt_pk_bf16_f32 v28, v228, v229
    v_cvt_pk_bf16_f32 v29, v230, v231
    s_mov_b32 s29, 40960
    buffer_store_dwordx2 v[28:29], v191, s[20:23], s29 offen offset:32
    v_cvt_pk_bf16_f32 v30, v232, v233
    v_cvt_pk_bf16_f32 v31, v234, v235
    s_mov_b32 s29, 40960
    buffer_store_dwordx2 v[30:31], v191, s[20:23], s29 offen offset:64
    v_cvt_pk_bf16_f32 v32, v236, v237
    v_cvt_pk_bf16_f32 v33, v238, v239
    s_mov_b32 s29, 40960
    buffer_store_dwordx2 v[32:33], v191, s[20:23], s29 offen offset:96
    v_cvt_pk_bf16_f32 v34, v240, v241
    v_cvt_pk_bf16_f32 v35, v242, v243
    s_mov_b32 s29, 40960
    buffer_store_dwordx2 v[34:35], v191, s[20:23], s29 offen offset:128
    s_waitcnt vmcnt(0)
L_oend:
    s_endpgm
.section .rodata,"a"
.p2align 6
.amdhsa_kernel attn_kernel
  .amdhsa_next_free_vgpr 440
  .amdhsa_next_free_sgpr 102
  .amdhsa_accum_offset 248
  .amdhsa_group_segment_fixed_size 0
  .amdhsa_kernarg_size 104
  .amdhsa_user_sgpr_count 2
  .amdhsa_user_sgpr_kernarg_segment_ptr 1
  .amdhsa_system_sgpr_workgroup_id_x 1
.end_amdhsa_kernel
.p2align 6
.amdhsa_kernel oproj_kernel
  .amdhsa_next_free_vgpr 408
  .amdhsa_next_free_sgpr 102
  .amdhsa_accum_offset 248
  .amdhsa_group_segment_fixed_size 0
  .amdhsa_kernarg_size 104
  .amdhsa_user_sgpr_count 2
  .amdhsa_user_sgpr_kernarg_segment_ptr 1
  .amdhsa_system_sgpr_workgroup_id_x 1
.end_amdhsa_kernel
```
